```python
import torch

def _softmax(x, axis=-1):
    return torch.softmax(x, dim=axis)
def _gelu(x):
    return torch.nn.functional.gelu(x, approximate="tanh")
def _silu(x):
    return torch.nn.functional.silu(x)
def _sigmoid(x):
    return torch.sigmoid(x)
def _layernorm(x, axis=-1, eps=1e-5):
    m = x.mean(dim=axis, keepdim=True)
    v = x.var(dim=axis, keepdim=True, unbiased=False)
    return (x - m) / torch.sqrt(v + eps)
def _scatter_add(tgt, idx, src, axis=0):
    return tgt.clone().index_add_(axis, idx, src)
def _segment_sum(src, seg, n):
    out = torch.zeros((n,) + src.shape[1:], dtype=src.dtype)
    return out.index_add_(0, seg, src)
def _pad(x, pw):
    flat = tuple(v for pair in reversed(pw) for v in pair)
    return torch.nn.functional.pad(x, flat)

kernel_name = 'concat_heads__mha_block_cached__gqa_block_cached__near_ridge'

def setup_inputs():

    _w = (lambda a: (lambda t: t.to(torch.bfloat16) if t.is_floating_point() else t)(torch.as_tensor(a)))
    def _A_setup():
        B, Sq, D = 8, 128, 448
        H, Sk, Dh = 16, 512, 256
        return {
            "x": _w((lambda *s: torch.randn(*s, dtype=torch.bfloat16) * 0.8)(B, Sq, D)),
            "k_cache": _w((lambda *s: torch.randn(*s, dtype=torch.bfloat16) * 0.8)(B, H, Sk, Dh)),
            "v_cache": _w((lambda *s: torch.randn(*s, dtype=torch.bfloat16) * 0.05)(B, H, Sk, Dh)),
            "wq": _w((lambda *s: torch.randn(*s, dtype=torch.bfloat16) * 0.8)(D, H * Dh) * (D ** -0.5)),
            "wo": _w((lambda *s: torch.randn(*s, dtype=torch.bfloat16) * 0.05)(H * Dh, D) * ((H * Dh) ** -0.5)),
        }
    _A_in = _A_setup()

    def _B_setup():
        B, Sq, D = 8, 128, 448
        Hq, Hkv, Sk, Dh = 16, 16, 512, 256
        assert Hq % Hkv == 0, (Hq, Hkv)
        return {
            "x": _w((lambda *s: torch.randn(*s, dtype=torch.bfloat16) * 0.8)(B, Sq, D)),
            "k_cache": _w((lambda *s: torch.randn(*s, dtype=torch.bfloat16) * 0.8)(B, Hkv, Sk, Dh)),
            "v_cache": _w((lambda *s: torch.randn(*s, dtype=torch.bfloat16) * 0.05)(B, Hkv, Sk, Dh)),
            "wq": _w((lambda *s: torch.randn(*s, dtype=torch.bfloat16) * 0.8)(D, Hq * Dh) * (D ** -0.5)),
            "wo": _w((lambda *s: torch.randn(*s, dtype=torch.bfloat16) * 0.05)(Hq * Dh, D) * ((Hq * Dh) ** -0.5)),
        }
    _B_in = _B_setup()

    return {
        "A_x": _A_in["x"],
        "A_k_cache": _A_in["k_cache"],
        "A_v_cache": _A_in["v_cache"],
        "A_wq": _A_in["wq"],
        "A_wo": _A_in["wo"],
        "B_x": _B_in["x"],
        "B_k_cache": _B_in["k_cache"],
        "B_v_cache": _B_in["v_cache"],
        "B_wq": _B_in["wq"],
        "B_wo": _B_in["wo"],
    }

def reference(A_x, A_k_cache, A_v_cache, A_wq, A_wo, B_x, B_k_cache, B_v_cache, B_wq, B_wo):
    def _A_ref(x, k_cache, v_cache, wq, wo):
        B, Sq, D = x.shape
        H, Dh = 16, 256
        q = (lambda x, *d: x.permute(*d))((x @ wq).reshape(B, Sq, H, Dh), 0, 2, 1, 3)
        scores = torch.einsum("bhqd,bhkd->bhqk", q, k_cache) * (Dh ** -0.5)
        p = _softmax(scores, axis=-1)
        o = torch.einsum("bhqk,bhkd->bhqd", p, v_cache)
        return (lambda x, *d: x.permute(*d))(o, 0, 2, 1, 3).reshape(B, Sq, H * Dh) @ wo

    def _B_ref(x, k_cache, v_cache, wq, wo):
        B, Sq, D = x.shape
        Hq, Dh = 16, 256
        Hkv = k_cache.shape[1]
        rep = Hq // Hkv
        q = (lambda x, *d: x.permute(*d))((x @ wq).reshape(B, Sq, Hq, Dh), 0, 2, 1, 3)
        k = (lambda x, n, axis: torch.repeat_interleave(x, n, dim=axis))(k_cache, rep, axis=1)
        v = (lambda x, n, axis: torch.repeat_interleave(x, n, dim=axis))(v_cache, rep, axis=1)
        scores = torch.einsum("bhqd,bhkd->bhqk", q, k) * (Dh ** -0.5)
        p = _softmax(scores, axis=-1)
        o = torch.einsum("bhqk,bhkd->bhqd", p, v)
        return (lambda x, *d: x.permute(*d))(o, 0, 2, 1, 3).reshape(B, Sq, Hq * Dh) @ wo

    a = _A_ref(A_x, A_k_cache, A_v_cache, A_wq, A_wo)
    b = _B_ref(B_x, B_k_cache, B_v_cache, B_wq, B_wo)
    return torch.concatenate([a, b], axis=-1)
```

```asm
; @launch kernel=attn_kernel grid=(256,1,1) block=(512,1,1) lds=163840
.amdgcn_target "amdgcn-amd-amdhsa--gfx950"
.text
.globl attn_kernel
.p2align 8
.type attn_kernel,@function
attn_kernel:
  s_load_dwordx16 s[36:51], s[0:1], 0
  s_load_dwordx8 s[52:59], s[0:1], 64
  s_load_dwordx2 s[12:13], s[0:1], 96
  s_cmp_ge_u32 s2, 256
  s_cbranch_scc1 L_done
  v_lshrrev_b32 v1, 6, v0
  v_and_b32 v2, 63, v0
  s_and_b32 s3, s2, 7
  s_lshr_b32 s4, s2, 3
  v_readfirstlane_b32 s14, v1
  s_lshr_b32 s5, s3, 2
  s_and_b32 s6, s3, 3
  s_lshl_b32 s6, s6, 2
  s_and_b32 s11, s4, 3
  s_add_u32 s6, s6, s11
  s_lshr_b32 s7, s4, 2
  s_lshl_b32 s9, s11, 1
  s_add_u32 s9, s9, s7
  s_sub_u32 s10, s9, 7
  s_cmp_ge_u32 s9, 7
  s_cselect_b32 s9, s10, s9
  s_mov_b32 s10, s9
  s_cmp_eq_u32 s7, 7
  s_cselect_b32 s10, 0, s7
  s_mov_b32 s61, 0
  s_cmp_lt_u32 s14, 4
  s_cbranch_scc1 L_main
  s_setprio 3
  v_and_b32 v1, 3, v1
  v_lshrrev_b32 v5, 3, v2
  v_and_b32 v6, 7, v2
  v_lshrrev_b32 v8, 4, v2
  v_lshlrev_b32 v9, 5, v1
  v_add_u32 v9, v9, v5
  v_mul_u32_u24 v7, 896, v9
  v_xor_b32 v9, v8, v6
  v_lshlrev_b32 v9, 4, v9
  v_add_u32 v16, v7, v9
  v_xor_b32 v9, 64, v9
  v_add_u32 v17, v7, v9
  v_add_u32 v17, 6144, v17
  v_add_u32 v18, 12288, v16
  v_add_u32 v19, 12288, v17
  v_lshrrev_b32 v3, 5, v2
  v_and_b32 v4, 31, v2
  v_lshlrev_b32 v9, 3, v1
  v_add_u32 v10, v9, v3
  v_lshlrev_b32 v11, 13, v10
  v_lshlrev_b32 v9, 1, v3
  v_xor_b32 v9, v9, v4
  v_lshl_add_u32 v20, v9, 4, v11
  v_add_u32 v21, 15360, v20
  v_add_u32 v22, 30720, v20
  v_add_u32 v23, 30720, v21
  s_and_b32 s15, s14, 3
  s_mul_i32 s60, s15, 4224
  s_lshl_b32 s15, s15, 12
  s_lshl_b32 s66, s9, 7
  s_waitcnt lgkmcnt(0)
  s_cmp_eq_u32 s5, 0
  s_cselect_b32 s16, s36, s46
  s_cselect_b32 s17, s37, s47
  s_mov_b32 s19, 0x20000
  s_cselect_b32 s28, s42, s52
  s_cselect_b32 s29, s43, s53
  s_mov_b32 s31, 0x20000
  s_mul_i32 s8, s7, 114688
  s_add_u32 s16, s16, s8
  s_addc_u32 s17, s17, 0
  s_mov_b32 s18, 114688
  s_lshl_b32 s8, s6, 9
  s_add_u32 s28, s28, s8
  s_addc_u32 s29, s29, 0
  s_sub_u32 s30, 3670016, s8
  s_add_u32 m0, s15, 4096
  s_mov_b32 s68, s66
  buffer_load_dwordx4 v16, s[16:19], s68 offen offset:0 lds
  buffer_load_dwordx4 v17, s[16:19], s68 offen offset:1024 lds
  buffer_load_dwordx4 v18, s[16:19], s68 offen offset:2048 lds
  buffer_load_dwordx4 v19, s[16:19], s68 offen offset:3072 lds
  s_add_u32 m0, s60, 20992
  s_mov_b32 s66, s68
  s_lshl_b32 s69, s66, 12
  buffer_load_dwordx4 v20, s[28:31], s69 offen offset:0 lds
  s_add_u32 m0, s60, 21056
  s_nop 0
  buffer_load_dwordx4 v21, s[28:31], s69 offen offset:1024 lds
  buffer_load_dwordx4 v22, s[28:31], s69 offen offset:2048 lds
  s_add_u32 m0, s60, 21120
  s_nop 0
  buffer_load_dwordx4 v23, s[28:31], s69 offen offset:3072 lds
  s_cmp_eq_u32 s5, 0
  s_cselect_b32 s20, s38, s48
  s_cselect_b32 s21, s39, s49
  s_mov_b32 s23, 0x20000
  s_cselect_b32 s24, s40, s50
  s_cselect_b32 s25, s41, s51
  s_mov_b32 s27, 0x20000
  s_cselect_b32 s32, s44, s54
  s_cselect_b32 s33, s45, s55
  s_mov_b32 s35, 0x20000
  s_lshl_b32 s8, s7, 4
  s_add_u32 s8, s8, s6
  s_lshl_b32 s8, s8, 18
  s_add_u32 s20, s20, s8
  s_addc_u32 s21, s21, 0
  s_add_u32 s24, s24, s8
  s_addc_u32 s25, s25, 0
  s_mov_b32 s22, 262144
  s_mov_b32 s26, 262144
  s_mul_i32 s8, s6, 229376
  s_add_u32 s32, s32, s8
  s_addc_u32 s33, s33, 0
  s_mov_b32 s34, 229376
  v_lshlrev_b32 v11, 9, v10
  v_xor_b32 v9, v3, v4
  v_lshlrev_b32 v9, 4, v9
  v_add_u32 v24, v9, v11
  v_lshlrev_b32 v12, 6, v1
  v_add_u32 v12, v12, v2
  v_min_u32 v13, 47, v2
  v_mul_u32_u24 v9, 48, v1
  v_add_u32 v13, v13, v9
  v_lshrrev_b32 v9, 2, v13
  v_lshlrev_b32 v9, 16, v9
  v_and_b32 v11, 3, v13
  v_lshlrev_b32 v11, 7, v11
  v_add_u32 v41, v9, v11
  v_and_b32 v9, 31, v13
  v_lshrrev_b32 v11, 5, v13
  v_lshlrev_b32 v11, 7, v11
  v_mul_u32_u24 v9, 896, v9
  v_add_u32 v42, v9, v11
  v_min_u32 v43, 223, v12
  v_lshlrev_b32 v43, 7, v43
  v_and_b32 v9, 15, v2
  v_lshlrev_b32 v11, 2, v8
  v_xor_b32 v9, v9, v11
  v_lshlrev_b32 v9, 4, v9
  v_lshlrev_b32 v11, 4, v1
  v_add_u32 v11, v11, v8
  v_lshlrev_b32 v11, 9, v11
  v_add_u32 v28, v9, v11
  v_add_u32 v29, 1024, v28
  v_add_u32 v30, 2048, v28
  v_add_u32 v31, 3072, v28
  v_and_b32 v9, 1, v8
  v_lshlrev_b32 v9, 2, v9
  v_xor_b32 v9, v9, v6
  v_lshlrev_b32 v9, 4, v9
  v_add_u32 v32, v7, v9
  v_add_u32 v33, 6144, v32
  v_add_u32 v34, 12288, v32
  v_add_u32 v35, 18432, v32
  v_lshlrev_b32 v9, 4, v2
  v_add_u32 v25, s60, v9
  v_add_u32 v45, s15, v9
  v_add_u32 v26, 49152, v25
  v_add_u32 v46, 49152, v45
  v_add_u32 v27, 98304, v25
  v_add_u32 v47, 98304, v45
  s_lshl_b32 s67, s10, 7
  s_getpc_b64 s[70:71]
L_hpc:
  v_and_b32 v14, 15, v2
  v_lshl_add_u32 v14, v1, 4, v14
  s_lshl_b32 s3, s11, 6
  v_add_u32 v14, s3, v14
  v_lshlrev_b32 v14, 7, v14
  s_add_u32 m0, s60, 37888
  s_lshl_b32 s69, s66, 12
  s_add_u32 s69, s69, 262144
  buffer_load_dwordx4 v20, s[28:31], s69 offen offset:0 lds
  s_add_u32 m0, s60, 37952
  s_nop 0
  buffer_load_dwordx4 v21, s[28:31], s69 offen offset:1024 lds
  buffer_load_dwordx4 v22, s[28:31], s69 offen offset:2048 lds
  s_add_u32 m0, s60, 38016
  s_nop 0
  buffer_load_dwordx4 v23, s[28:31], s69 offen offset:3072 lds
  s_waitcnt vmcnt(8)
  s_barrier
  s_add_u32 m0, s15, 54784
  s_mov_b32 s68, s66
  s_add_u32 s68, s68, 128
  s_cmp_eq_u32 s68, 896
  s_cselect_b32 s68, 0, s68
  buffer_load_dwordx4 v16, s[16:19], s68 offen offset:0 lds
  buffer_load_dwordx4 v17, s[16:19], s68 offen offset:1024 lds
  buffer_load_dwordx4 v18, s[16:19], s68 offen offset:2048 lds
  buffer_load_dwordx4 v19, s[16:19], s68 offen offset:3072 lds
  s_waitcnt vmcnt(8)
  s_barrier
  s_add_u32 m0, s60, 71680
  s_mov_b32 s66, s68
  s_lshl_b32 s69, s66, 12
  buffer_load_dwordx4 v20, s[28:31], s69 offen offset:0 lds
  s_add_u32 m0, s60, 71744
  s_nop 0
  buffer_load_dwordx4 v21, s[28:31], s69 offen offset:1024 lds
  buffer_load_dwordx4 v22, s[28:31], s69 offen offset:2048 lds
  s_add_u32 m0, s60, 71808
  s_nop 0
  buffer_load_dwordx4 v23, s[28:31], s69 offen offset:3072 lds
  s_add_u32 m0, s60, 88576
  s_lshl_b32 s69, s66, 12
  s_add_u32 s69, s69, 262144
  buffer_load_dwordx4 v20, s[28:31], s69 offen offset:0 lds
  s_add_u32 m0, s60, 88640
  s_nop 0
  buffer_load_dwordx4 v21, s[28:31], s69 offen offset:1024 lds
  buffer_load_dwordx4 v22, s[28:31], s69 offen offset:2048 lds
  s_add_u32 m0, s60, 88704
  s_nop 0
  buffer_load_dwordx4 v23, s[28:31], s69 offen offset:3072 lds
  s_waitcnt vmcnt(12)
  s_barrier
  s_add_u32 m0, s15, 105472
  s_mov_b32 s68, s66
  s_add_u32 s68, s68, 128
  s_cmp_eq_u32 s68, 896
  s_cselect_b32 s68, 0, s68
  buffer_load_dwordx4 v16, s[16:19], s68 offen offset:0 lds
  buffer_load_dwordx4 v17, s[16:19], s68 offen offset:1024 lds
  buffer_load_dwordx4 v18, s[16:19], s68 offen offset:2048 lds
  buffer_load_dwordx4 v19, s[16:19], s68 offen offset:3072 lds
  s_add_u32 m0, s60, 122368
  s_mov_b32 s69, 0
  buffer_load_dwordx4 v24, s[20:23], s69 offen offset:0 nt lds
  s_add_u32 m0, s60, 122400
  s_nop 0
  buffer_load_dwordx4 v24, s[20:23], s69 offen offset:1024 nt lds
  s_add_u32 m0, s60, 122432
  s_nop 0
  buffer_load_dwordx4 v24, s[20:23], s69 offen offset:2048 nt lds
  s_add_u32 m0, s60, 122464
  s_nop 0
  buffer_load_dwordx4 v24, s[20:23], s69 offen offset:3072 nt lds
  s_waitcnt vmcnt(16)
  s_barrier
  s_add_u32 m0, s60, 139264
  s_mov_b32 s66, s68
  s_lshl_b32 s69, s66, 12
  buffer_load_dwordx4 v20, s[28:31], s69 offen offset:0 lds
  s_add_u32 m0, s60, 139328
  s_nop 0
  buffer_load_dwordx4 v21, s[28:31], s69 offen offset:1024 lds
  buffer_load_dwordx4 v22, s[28:31], s69 offen offset:2048 lds
  s_add_u32 m0, s60, 139392
  s_nop 0
  buffer_load_dwordx4 v23, s[28:31], s69 offen offset:3072 lds
  s_waitcnt vmcnt(16)
  s_barrier
  s_add_u32 m0, s60, 4096
  s_lshl_b32 s69, s66, 12
  s_add_u32 s69, s69, 262144
  buffer_load_dwordx4 v20, s[28:31], s69 offen offset:0 lds
  s_add_u32 m0, s60, 4160
  s_nop 0
  buffer_load_dwordx4 v21, s[28:31], s69 offen offset:1024 lds
  buffer_load_dwordx4 v22, s[28:31], s69 offen offset:2048 lds
  s_add_u32 m0, s60, 4224
  s_nop 0
  buffer_load_dwordx4 v23, s[28:31], s69 offen offset:3072 lds
  s_add_u32 m0, s15, 20992
  s_mov_b32 s68, s66
  s_add_u32 s68, s68, 128
  s_cmp_eq_u32 s68, 896
  s_cselect_b32 s68, 0, s68
  buffer_load_dwordx4 v16, s[16:19], s68 offen offset:0 lds
  buffer_load_dwordx4 v17, s[16:19], s68 offen offset:1024 lds
  buffer_load_dwordx4 v18, s[16:19], s68 offen offset:2048 lds
  buffer_load_dwordx4 v19, s[16:19], s68 offen offset:3072 lds
  s_waitcnt vmcnt(20)
  s_barrier
  s_add_u32 m0, s60, 54784
  s_mov_b32 s66, s68
  s_lshl_b32 s69, s66, 12
  buffer_load_dwordx4 v20, s[28:31], s69 offen offset:0 lds
  s_add_u32 m0, s60, 54848
  s_nop 0
  buffer_load_dwordx4 v21, s[28:31], s69 offen offset:1024 lds
  buffer_load_dwordx4 v22, s[28:31], s69 offen offset:2048 lds
  s_add_u32 m0, s60, 54912
  s_nop 0
  buffer_load_dwordx4 v23, s[28:31], s69 offen offset:3072 lds
  s_waitcnt vmcnt(20)
  s_barrier
  s_add_u32 m0, s60, 37888
  s_lshl_b32 s69, s66, 12
  s_add_u32 s69, s69, 262144
  buffer_load_dwordx4 v20, s[28:31], s69 offen offset:0 lds
  s_add_u32 m0, s60, 37952
  s_nop 0
  buffer_load_dwordx4 v21, s[28:31], s69 offen offset:1024 lds
  buffer_load_dwordx4 v22, s[28:31], s69 offen offset:2048 lds
  s_add_u32 m0, s60, 38016
  s_nop 0
  buffer_load_dwordx4 v23, s[28:31], s69 offen offset:3072 lds
  s_waitcnt vmcnt(16)
  s_barrier
  s_add_u32 m0, s15, 71680
  s_mov_b32 s68, s66
  s_add_u32 s68, s68, 128
  s_cmp_eq_u32 s68, 896
  s_cselect_b32 s68, 0, s68
  buffer_load_dwordx4 v16, s[16:19], s68 offen offset:0 lds
  buffer_load_dwordx4 v17, s[16:19], s68 offen offset:1024 lds
  buffer_load_dwordx4 v18, s[16:19], s68 offen offset:2048 lds
  buffer_load_dwordx4 v19, s[16:19], s68 offen offset:3072 lds
  s_waitcnt vmcnt(12)
  s_barrier
  s_add_u32 m0, s60, 105472
  s_mov_b32 s69, 16384
  buffer_load_dwordx4 v24, s[20:23], s69 offen offset:0 nt lds
  s_add_u32 m0, s60, 105504
  s_nop 0
  buffer_load_dwordx4 v24, s[20:23], s69 offen offset:1024 nt lds
  s_add_u32 m0, s60, 105536
  s_nop 0
  buffer_load_dwordx4 v24, s[20:23], s69 offen offset:2048 nt lds
  s_add_u32 m0, s60, 105568
  s_nop 0
  buffer_load_dwordx4 v24, s[20:23], s69 offen offset:3072 nt lds
  s_add_u32 m0, s60, 88576
  s_mov_b32 s66, s68
  s_lshl_b32 s69, s66, 12
  buffer_load_dwordx4 v20, s[28:31], s69 offen offset:0 lds
  s_add_u32 m0, s60, 88640
  s_nop 0
  buffer_load_dwordx4 v21, s[28:31], s69 offen offset:1024 lds
  buffer_load_dwordx4 v22, s[28:31], s69 offen offset:2048 lds
  s_add_u32 m0, s60, 88704
  s_nop 0
  buffer_load_dwordx4 v23, s[28:31], s69 offen offset:3072 lds
  s_waitcnt vmcnt(16)
  s_barrier
  s_add_u32 m0, s60, 139264
  s_lshl_b32 s69, s66, 12
  s_add_u32 s69, s69, 262144
  buffer_load_dwordx4 v20, s[28:31], s69 offen offset:0 lds
  s_add_u32 m0, s60, 139328
  s_nop 0
  buffer_load_dwordx4 v21, s[28:31], s69 offen offset:1024 lds
  buffer_load_dwordx4 v22, s[28:31], s69 offen offset:2048 lds
  s_add_u32 m0, s60, 139392
  s_nop 0
  buffer_load_dwordx4 v23, s[28:31], s69 offen offset:3072 lds
  s_waitcnt vmcnt(12)
  s_barrier
  s_add_u32 m0, s15, 20992
  s_mov_b32 s68, s66
  s_add_u32 s68, s68, 128
  s_cmp_eq_u32 s68, 896
  s_cselect_b32 s68, 0, s68
  buffer_load_dwordx4 v16, s[16:19], s68 offen offset:0 lds
  buffer_load_dwordx4 v17, s[16:19], s68 offen offset:1024 lds
  buffer_load_dwordx4 v18, s[16:19], s68 offen offset:2048 lds
  buffer_load_dwordx4 v19, s[16:19], s68 offen offset:3072 lds
  s_add_u32 m0, s60, 4096
  s_mov_b32 s66, s68
  s_lshl_b32 s69, s66, 12
  buffer_load_dwordx4 v20, s[28:31], s69 offen offset:0 lds
  s_add_u32 m0, s60, 4160
  s_nop 0
  buffer_load_dwordx4 v21, s[28:31], s69 offen offset:1024 lds
  buffer_load_dwordx4 v22, s[28:31], s69 offen offset:2048 lds
  s_add_u32 m0, s60, 4224
  s_nop 0
  buffer_load_dwordx4 v23, s[28:31], s69 offen offset:3072 lds
  s_waitcnt vmcnt(12)
  s_barrier
  s_add_u32 m0, s60, 54784
  s_mov_b32 s69, 32768
  buffer_load_dwordx4 v24, s[20:23], s69 offen offset:0 nt lds
  s_add_u32 m0, s60, 54816
  s_nop 0
  buffer_load_dwordx4 v24, s[20:23], s69 offen offset:1024 nt lds
  s_add_u32 m0, s60, 54848
  s_nop 0
  buffer_load_dwordx4 v24, s[20:23], s69 offen offset:2048 nt lds
  s_add_u32 m0, s60, 54880
  s_nop 0
  buffer_load_dwordx4 v24, s[20:23], s69 offen offset:3072 nt lds
  s_waitcnt vmcnt(8)
  s_barrier
  s_add_u32 m0, s60, 71680
  s_lshl_b32 s69, s66, 12
  s_add_u32 s69, s69, 262144
  buffer_load_dwordx4 v20, s[28:31], s69 offen offset:0 lds
  s_add_u32 m0, s60, 71744
  s_nop 0
  buffer_load_dwordx4 v21, s[28:31], s69 offen offset:1024 lds
  buffer_load_dwordx4 v22, s[28:31], s69 offen offset:2048 lds
  s_add_u32 m0, s60, 71808
  s_nop 0
  buffer_load_dwordx4 v23, s[28:31], s69 offen offset:3072 lds
  s_add_u32 m0, s15, 37888
  s_mov_b32 s68, s66
  s_add_u32 s68, s68, 128
  s_cmp_eq_u32 s68, 896
  s_cselect_b32 s68, 0, s68
  buffer_load_dwordx4 v16, s[16:19], s68 offen offset:0 lds
  buffer_load_dwordx4 v17, s[16:19], s68 offen offset:1024 lds
  buffer_load_dwordx4 v18, s[16:19], s68 offen offset:2048 lds
  buffer_load_dwordx4 v19, s[16:19], s68 offen offset:3072 lds
  s_waitcnt vmcnt(12)
  s_barrier
  s_add_u32 m0, s60, 88576
  s_mov_b32 s66, s68
  s_lshl_b32 s69, s66, 12
  buffer_load_dwordx4 v20, s[28:31], s69 offen offset:0 lds
  s_add_u32 m0, s60, 88640
  s_nop 0
  buffer_load_dwordx4 v21, s[28:31], s69 offen offset:1024 lds
  buffer_load_dwordx4 v22, s[28:31], s69 offen offset:2048 lds
  s_add_u32 m0, s60, 88704
  s_nop 0
  buffer_load_dwordx4 v23, s[28:31], s69 offen offset:3072 lds
  s_waitcnt vmcnt(4)
  s_barrier
  s_add_u32 m0, s60, 20992
  s_lshl_b32 s69, s66, 12
  s_add_u32 s69, s69, 262144
  buffer_load_dwordx4 v20, s[28:31], s69 offen offset:0 lds
  s_add_u32 m0, s60, 21056
  s_nop 0
  buffer_load_dwordx4 v21, s[28:31], s69 offen offset:1024 lds
  buffer_load_dwordx4 v22, s[28:31], s69 offen offset:2048 lds
  s_add_u32 m0, s60, 21120
  s_nop 0
  buffer_load_dwordx4 v23, s[28:31], s69 offen offset:3072 lds
  s_add_u32 m0, s60, 139264
  s_mov_b32 s69, 49152
  buffer_load_dwordx4 v24, s[20:23], s69 offen offset:0 nt lds
  s_add_u32 m0, s60, 139296
  s_nop 0
  buffer_load_dwordx4 v24, s[20:23], s69 offen offset:1024 nt lds
  s_add_u32 m0, s60, 139328
  s_nop 0
  buffer_load_dwordx4 v24, s[20:23], s69 offen offset:2048 nt lds
  s_add_u32 m0, s60, 139360
  s_nop 0
  buffer_load_dwordx4 v24, s[20:23], s69 offen offset:3072 nt lds
  s_waitcnt vmcnt(8)
  s_barrier
  s_add_u32 m0, s60, 4096
  s_mov_b32 s69, 65536
  buffer_load_dwordx4 v24, s[20:23], s69 offen offset:0 nt lds
  s_add_u32 m0, s60, 4128
  s_nop 0
  buffer_load_dwordx4 v24, s[20:23], s69 offen offset:1024 nt lds
  s_add_u32 m0, s60, 4160
  s_nop 0
  buffer_load_dwordx4 v24, s[20:23], s69 offen offset:2048 nt lds
  s_add_u32 m0, s60, 4192
  s_nop 0
  buffer_load_dwordx4 v24, s[20:23], s69 offen offset:3072 nt lds
  s_waitcnt vmcnt(8)
  s_barrier
  s_barrier
  s_waitcnt vmcnt(4)
  s_add_u32 m0, s60, 37888
  s_mov_b32 s69, 81920
  buffer_load_dwordx4 v24, s[20:23], s69 offen offset:0 nt lds
  s_waitcnt vmcnt(4)
  s_add_u32 m0, s60, 37920
  s_nop 0
  buffer_load_dwordx4 v24, s[20:23], s69 offen offset:1024 nt lds
  s_waitcnt vmcnt(4)
  s_add_u32 m0, s60, 37952
  s_nop 0
  buffer_load_dwordx4 v24, s[20:23], s69 offen offset:2048 nt lds
  s_waitcnt vmcnt(4)
  s_add_u32 m0, s60, 37984
  s_nop 0
  buffer_load_dwordx4 v24, s[20:23], s69 offen offset:3072 nt lds
  s_barrier
  s_barrier
  s_waitcnt vmcnt(4)
  s_add_u32 m0, s60, 71680
  s_mov_b32 s69, 98304
  buffer_load_dwordx4 v24, s[20:23], s69 offen offset:0 nt lds
  s_waitcnt vmcnt(4)
  s_add_u32 m0, s60, 71712
  s_nop 0
  buffer_load_dwordx4 v24, s[20:23], s69 offen offset:1024 nt lds
  s_waitcnt vmcnt(4)
  s_add_u32 m0, s60, 71744
  s_nop 0
  buffer_load_dwordx4 v24, s[20:23], s69 offen offset:2048 nt lds
  s_waitcnt vmcnt(4)
  s_add_u32 m0, s60, 71776
  s_nop 0
  buffer_load_dwordx4 v24, s[20:23], s69 offen offset:3072 nt lds
  s_barrier
  s_waitcnt vmcnt(4)
  s_add_u32 m0, s60, 88576
  s_mov_b32 s69, 114688
  buffer_load_dwordx4 v24, s[20:23], s69 offen offset:0 nt lds
  s_waitcnt vmcnt(4)
  s_add_u32 m0, s60, 88608
  s_nop 0
  buffer_load_dwordx4 v24, s[20:23], s69 offen offset:1024 nt lds
  s_waitcnt vmcnt(4)
  s_add_u32 m0, s60, 88640
  s_nop 0
  buffer_load_dwordx4 v24, s[20:23], s69 offen offset:2048 nt lds
  s_waitcnt vmcnt(4)
  s_add_u32 m0, s60, 88672
  s_nop 0
  buffer_load_dwordx4 v24, s[20:23], s69 offen offset:3072 nt lds
  s_barrier
  s_barrier
  s_waitcnt vmcnt(4)
  s_add_u32 m0, s60, 20992
  s_mov_b32 s69, 131072
  buffer_load_dwordx4 v24, s[20:23], s69 offen offset:0 nt lds
  s_waitcnt vmcnt(4)
  s_add_u32 m0, s60, 21024
  s_nop 0
  buffer_load_dwordx4 v24, s[20:23], s69 offen offset:1024 nt lds
  s_waitcnt vmcnt(4)
  s_add_u32 m0, s60, 21056
  s_nop 0
  buffer_load_dwordx4 v24, s[20:23], s69 offen offset:2048 nt lds
  s_waitcnt vmcnt(4)
  s_add_u32 m0, s60, 21088
  s_nop 0
  buffer_load_dwordx4 v24, s[20:23], s69 offen offset:3072 nt lds
  s_barrier
  s_waitcnt vmcnt(4)
  s_add_u32 m0, s60, 122368
  s_mov_b32 s69, 147456
  buffer_load_dwordx4 v24, s[20:23], s69 offen offset:0 nt lds
  s_waitcnt vmcnt(4)
  s_add_u32 m0, s60, 122400
  s_nop 0
  buffer_load_dwordx4 v24, s[20:23], s69 offen offset:1024 nt lds
  s_waitcnt vmcnt(4)
  s_add_u32 m0, s60, 122432
  s_nop 0
  buffer_load_dwordx4 v24, s[20:23], s69 offen offset:2048 nt lds
  s_waitcnt vmcnt(4)
  s_add_u32 m0, s60, 122464
  s_nop 0
  buffer_load_dwordx4 v24, s[20:23], s69 offen offset:3072 nt lds
  s_barrier
  s_waitcnt vmcnt(4)
  s_barrier
  s_add_u32 m0, s60, 105472
  s_mov_b32 s69, 163840
  buffer_load_dwordx4 v24, s[20:23], s69 offen offset:0 nt lds
  s_waitcnt vmcnt(4)
  s_add_u32 m0, s60, 105504
  s_nop 0
  buffer_load_dwordx4 v24, s[20:23], s69 offen offset:1024 nt lds
  s_waitcnt vmcnt(4)
  s_add_u32 m0, s60, 105536
  s_nop 0
  buffer_load_dwordx4 v24, s[20:23], s69 offen offset:2048 nt lds
  s_waitcnt vmcnt(4)
  s_add_u32 m0, s60, 105568
  s_nop 0
  buffer_load_dwordx4 v24, s[20:23], s69 offen offset:3072 nt lds
  s_waitcnt vmcnt(4)
  s_barrier
  s_add_u32 m0, s60, 54784
  s_mov_b32 s69, 180224
  buffer_load_dwordx4 v24, s[20:23], s69 offen offset:0 nt lds
  s_waitcnt vmcnt(4)
  s_add_u32 m0, s60, 54816
  s_nop 0
  buffer_load_dwordx4 v24, s[20:23], s69 offen offset:1024 nt lds
  s_waitcnt vmcnt(4)
  s_add_u32 m0, s60, 54848
  s_nop 0
  buffer_load_dwordx4 v24, s[20:23], s69 offen offset:2048 nt lds
  s_waitcnt vmcnt(4)
  s_add_u32 m0, s60, 54880
  s_nop 0
  buffer_load_dwordx4 v24, s[20:23], s69 offen offset:3072 nt lds
  s_waitcnt vmcnt(4)
  s_barrier
  s_add_u32 m0, s60, 139264
  s_mov_b32 s69, 196608
  buffer_load_dwordx4 v24, s[20:23], s69 offen offset:0 nt lds
  s_waitcnt vmcnt(4)
  s_add_u32 m0, s60, 139296
  s_nop 0
  buffer_load_dwordx4 v24, s[20:23], s69 offen offset:1024 nt lds
  s_waitcnt vmcnt(4)
  s_add_u32 m0, s60, 139328
  s_nop 0
  buffer_load_dwordx4 v24, s[20:23], s69 offen offset:2048 nt lds
  s_waitcnt vmcnt(4)
  s_add_u32 m0, s60, 139360
  s_nop 0
  buffer_load_dwordx4 v24, s[20:23], s69 offen offset:3072 nt lds
  s_waitcnt vmcnt(4)
  s_barrier
  s_add_u32 m0, s60, 4096
  s_mov_b32 s69, 212992
  buffer_load_dwordx4 v24, s[20:23], s69 offen offset:0 nt lds
  s_waitcnt vmcnt(4)
  s_add_u32 m0, s60, 4128
  s_nop 0
  buffer_load_dwordx4 v24, s[20:23], s69 offen offset:1024 nt lds
  s_waitcnt vmcnt(4)
  s_add_u32 m0, s60, 4160
  s_nop 0
  buffer_load_dwordx4 v24, s[20:23], s69 offen offset:2048 nt lds
  s_waitcnt vmcnt(4)
  s_add_u32 m0, s60, 4192
  s_nop 0
  buffer_load_dwordx4 v24, s[20:23], s69 offen offset:3072 nt lds
  s_waitcnt vmcnt(4)
  s_barrier
  v_add_u32 v13, L_hpc-L_hpc+0, v14
  v_min_u32 v13, L_rdone-L_hpc, v13
  global_load_dword v44, v13, s[70:71]
  v_add_u32 v13, L_hpc-L_hpc+32768, v14
  v_min_u32 v13, L_rdone-L_hpc, v13
  global_load_dword v44, v13, s[70:71]
  s_waitcnt vmcnt(4)
  s_add_u32 m0, s60, 37888
  s_mov_b32 s69, 229376
  buffer_load_dwordx4 v24, s[20:23], s69 offen offset:0 nt lds
  s_waitcnt vmcnt(4)
  s_add_u32 m0, s60, 37920
  s_nop 0
  buffer_load_dwordx4 v24, s[20:23], s69 offen offset:1024 nt lds
  s_waitcnt vmcnt(4)
  s_add_u32 m0, s60, 37952
  s_nop 0
  buffer_load_dwordx4 v24, s[20:23], s69 offen offset:2048 nt lds
  s_waitcnt vmcnt(4)
  s_add_u32 m0, s60, 37984
  s_nop 0
  buffer_load_dwordx4 v24, s[20:23], s69 offen offset:3072 nt lds
  s_barrier
  s_waitcnt vmcnt(4)
  s_add_u32 m0, s60, 71680
  s_mov_b32 s69, 245760
  buffer_load_dwordx4 v24, s[20:23], s69 offen offset:0 nt lds
  s_waitcnt vmcnt(4)
  s_add_u32 m0, s60, 71712
  s_nop 0
  buffer_load_dwordx4 v24, s[20:23], s69 offen offset:1024 nt lds
  s_waitcnt vmcnt(4)
  s_add_u32 m0, s60, 71744
  s_nop 0
  buffer_load_dwordx4 v24, s[20:23], s69 offen offset:2048 nt lds
  s_waitcnt vmcnt(4)
  s_add_u32 m0, s60, 71776
  s_nop 0
  buffer_load_dwordx4 v24, s[20:23], s69 offen offset:3072 nt lds
  s_waitcnt vmcnt(4)
  s_barrier
  s_add_u32 m0, s15, 88576
  s_mov_b32 s69, 0
  buffer_load_dwordx4 v28, s[24:27], s69 offen offset:0 nt lds
  s_waitcnt vmcnt(4)
  buffer_load_dwordx4 v29, s[24:27], s69 offen offset:1024 nt lds
  s_waitcnt vmcnt(4)
  buffer_load_dwordx4 v30, s[24:27], s69 offen offset:2048 nt lds
  s_waitcnt vmcnt(4)
  buffer_load_dwordx4 v31, s[24:27], s69 offen offset:3072 nt lds
  s_waitcnt vmcnt(4)
  s_barrier
  s_add_u32 m0, s15, 20992
  s_mov_b32 s69, 32768
  buffer_load_dwordx4 v28, s[24:27], s69 offen offset:0 nt lds
  s_waitcnt vmcnt(4)
  buffer_load_dwordx4 v29, s[24:27], s69 offen offset:1024 nt lds
  s_waitcnt vmcnt(4)
  buffer_load_dwordx4 v30, s[24:27], s69 offen offset:2048 nt lds
  s_waitcnt vmcnt(4)
  buffer_load_dwordx4 v31, s[24:27], s69 offen offset:3072 nt lds
  s_waitcnt vmcnt(4)
  s_barrier
  s_add_u32 m0, s15, 122368
  s_mov_b32 s69, 65536
  buffer_load_dwordx4 v28, s[24:27], s69 offen offset:0 nt lds
  s_waitcnt vmcnt(4)
  buffer_load_dwordx4 v29, s[24:27], s69 offen offset:1024 nt lds
  s_waitcnt vmcnt(4)
  buffer_load_dwordx4 v30, s[24:27], s69 offen offset:2048 nt lds
  s_waitcnt vmcnt(4)
  buffer_load_dwordx4 v31, s[24:27], s69 offen offset:3072 nt lds
  s_waitcnt vmcnt(4)
  s_barrier
  s_add_u32 m0, s15, 105472
  s_mov_b32 s69, 98304
  buffer_load_dwordx4 v28, s[24:27], s69 offen offset:0 nt lds
  s_waitcnt vmcnt(4)
  buffer_load_dwordx4 v29, s[24:27], s69 offen offset:1024 nt lds
  s_waitcnt vmcnt(4)
  buffer_load_dwordx4 v30, s[24:27], s69 offen offset:2048 nt lds
  s_waitcnt vmcnt(4)
  buffer_load_dwordx4 v31, s[24:27], s69 offen offset:3072 nt lds
  s_waitcnt vmcnt(4)
  s_barrier
  s_add_u32 m0, s15, 54784
  s_mov_b32 s69, 131072
  buffer_load_dwordx4 v28, s[24:27], s69 offen offset:0 nt lds
  s_waitcnt vmcnt(4)
  buffer_load_dwordx4 v29, s[24:27], s69 offen offset:1024 nt lds
  s_waitcnt vmcnt(4)
  buffer_load_dwordx4 v30, s[24:27], s69 offen offset:2048 nt lds
  s_waitcnt vmcnt(4)
  buffer_load_dwordx4 v31, s[24:27], s69 offen offset:3072 nt lds
  s_waitcnt vmcnt(4)
  s_barrier
  s_add_u32 m0, s15, 139264
  s_mov_b32 s69, 163840
  buffer_load_dwordx4 v28, s[24:27], s69 offen offset:0 nt lds
  s_waitcnt vmcnt(4)
  buffer_load_dwordx4 v29, s[24:27], s69 offen offset:1024 nt lds
  s_waitcnt vmcnt(4)
  buffer_load_dwordx4 v30, s[24:27], s69 offen offset:2048 nt lds
  s_waitcnt vmcnt(4)
  buffer_load_dwordx4 v31, s[24:27], s69 offen offset:3072 nt lds
  s_waitcnt vmcnt(4)
  s_barrier
  s_add_u32 m0, s15, 4096
  s_mov_b32 s69, 196608
  buffer_load_dwordx4 v28, s[24:27], s69 offen offset:0 nt lds
  s_waitcnt vmcnt(4)
  buffer_load_dwordx4 v29, s[24:27], s69 offen offset:1024 nt lds
  s_waitcnt vmcnt(4)
  buffer_load_dwordx4 v30, s[24:27], s69 offen offset:2048 nt lds
  s_waitcnt vmcnt(4)
  buffer_load_dwordx4 v31, s[24:27], s69 offen offset:3072 nt lds
  s_waitcnt vmcnt(4)
  s_barrier
  s_add_u32 m0, s15, 37888
  s_mov_b32 s69, 229376
  buffer_load_dwordx4 v28, s[24:27], s69 offen offset:0 nt lds
  s_waitcnt vmcnt(4)
  buffer_load_dwordx4 v29, s[24:27], s69 offen offset:1024 nt lds
  s_waitcnt vmcnt(4)
  buffer_load_dwordx4 v30, s[24:27], s69 offen offset:2048 nt lds
  s_waitcnt vmcnt(4)
  buffer_load_dwordx4 v31, s[24:27], s69 offen offset:3072 nt lds
  s_waitcnt vmcnt(4)
  s_barrier
  s_add_u32 m0, s15, 71680
  s_mov_b32 s69, 256
  buffer_load_dwordx4 v28, s[24:27], s69 offen offset:0 nt lds
  s_waitcnt vmcnt(4)
  buffer_load_dwordx4 v29, s[24:27], s69 offen offset:1024 nt lds
  s_waitcnt vmcnt(4)
  buffer_load_dwordx4 v30, s[24:27], s69 offen offset:2048 nt lds
  s_waitcnt vmcnt(4)
  buffer_load_dwordx4 v31, s[24:27], s69 offen offset:3072 nt lds
  s_waitcnt vmcnt(4)
  s_barrier
  s_add_u32 m0, s15, 88576
  s_mov_b32 s69, 33024
  buffer_load_dwordx4 v28, s[24:27], s69 offen offset:0 nt lds
  s_waitcnt vmcnt(4)
  buffer_load_dwordx4 v29, s[24:27], s69 offen offset:1024 nt lds
  s_waitcnt vmcnt(4)
  buffer_load_dwordx4 v30, s[24:27], s69 offen offset:2048 nt lds
  s_waitcnt vmcnt(4)
  buffer_load_dwordx4 v31, s[24:27], s69 offen offset:3072 nt lds
  s_waitcnt vmcnt(4)
  s_barrier
  s_add_u32 m0, s15, 20992
  s_mov_b32 s69, 65792
  buffer_load_dwordx4 v28, s[24:27], s69 offen offset:0 nt lds
  s_waitcnt vmcnt(4)
  buffer_load_dwordx4 v29, s[24:27], s69 offen offset:1024 nt lds
  s_waitcnt vmcnt(4)
  buffer_load_dwordx4 v30, s[24:27], s69 offen offset:2048 nt lds
  s_waitcnt vmcnt(4)
  buffer_load_dwordx4 v31, s[24:27], s69 offen offset:3072 nt lds
  s_waitcnt vmcnt(4)
  s_barrier
  s_add_u32 m0, s15, 122368
  s_mov_b32 s69, 98560
  buffer_load_dwordx4 v28, s[24:27], s69 offen offset:0 nt lds
  s_waitcnt vmcnt(4)
  buffer_load_dwordx4 v29, s[24:27], s69 offen offset:1024 nt lds
  s_waitcnt vmcnt(4)
  buffer_load_dwordx4 v30, s[24:27], s69 offen offset:2048 nt lds
  s_waitcnt vmcnt(4)
  buffer_load_dwordx4 v31, s[24:27], s69 offen offset:3072 nt lds
  s_waitcnt vmcnt(4)
  s_barrier
  s_add_u32 m0, s15, 105472
  s_mov_b32 s69, 131328
  buffer_load_dwordx4 v28, s[24:27], s69 offen offset:0 nt lds
  s_waitcnt vmcnt(4)
  buffer_load_dwordx4 v29, s[24:27], s69 offen offset:1024 nt lds
  s_waitcnt vmcnt(4)
  buffer_load_dwordx4 v30, s[24:27], s69 offen offset:2048 nt lds
  s_waitcnt vmcnt(4)
  buffer_load_dwordx4 v31, s[24:27], s69 offen offset:3072 nt lds
  s_waitcnt vmcnt(4)
  s_barrier
  s_add_u32 m0, s15, 54784
  s_mov_b32 s69, 164096
  buffer_load_dwordx4 v28, s[24:27], s69 offen offset:0 nt lds
  s_waitcnt vmcnt(4)
  buffer_load_dwordx4 v29, s[24:27], s69 offen offset:1024 nt lds
  s_waitcnt vmcnt(4)
  buffer_load_dwordx4 v30, s[24:27], s69 offen offset:2048 nt lds
  s_waitcnt vmcnt(4)
  buffer_load_dwordx4 v31, s[24:27], s69 offen offset:3072 nt lds
  s_waitcnt vmcnt(4)
  s_barrier
  s_add_u32 m0, s15, 139264
  s_mov_b32 s69, 196864
  buffer_load_dwordx4 v28, s[24:27], s69 offen offset:0 nt lds
  s_waitcnt vmcnt(4)
  buffer_load_dwordx4 v29, s[24:27], s69 offen offset:1024 nt lds
  s_waitcnt vmcnt(4)
  buffer_load_dwordx4 v30, s[24:27], s69 offen offset:2048 nt lds
  s_waitcnt vmcnt(4)
  buffer_load_dwordx4 v31, s[24:27], s69 offen offset:3072 nt lds
  s_waitcnt vmcnt(4)
  s_barrier
  s_add_u32 m0, s15, 4096
  s_mov_b32 s69, 229632
  buffer_load_dwordx4 v28, s[24:27], s69 offen offset:0 nt lds
  s_waitcnt vmcnt(4)
  buffer_load_dwordx4 v29, s[24:27], s69 offen offset:1024 nt lds
  s_waitcnt vmcnt(4)
  buffer_load_dwordx4 v30, s[24:27], s69 offen offset:2048 nt lds
  s_waitcnt vmcnt(4)
  buffer_load_dwordx4 v31, s[24:27], s69 offen offset:3072 nt lds
  s_add_u32 m0, s15, 37888
  s_mov_b32 s69, s67
  buffer_load_dwordx4 v32, s[32:35], s69 offen offset:0 lds
  buffer_load_dwordx4 v33, s[32:35], s69 offen offset:1024 lds
  buffer_load_dwordx4 v34, s[32:35], s69 offen offset:2048 lds
  buffer_load_dwordx4 v35, s[32:35], s69 offen offset:3072 lds
  s_waitcnt vmcnt(8)
  s_barrier
  s_add_u32 m0, s15, 71680
  s_add_u32 s69, s67, 114688
  buffer_load_dwordx4 v32, s[32:35], s69 offen offset:0 lds
  buffer_load_dwordx4 v33, s[32:35], s69 offen offset:1024 lds
  buffer_load_dwordx4 v34, s[32:35], s69 offen offset:2048 lds
  buffer_load_dwordx4 v35, s[32:35], s69 offen offset:3072 lds
  s_waitcnt vmcnt(8)
  s_barrier
  s_add_u32 m0, s15, 88576
  s_add_u32 s67, s67, 128
  s_cmp_eq_u32 s67, 896
  s_cselect_b32 s67, 0, s67
  s_mov_b32 s69, s67
  buffer_load_dwordx4 v32, s[32:35], s69 offen offset:0 lds
  buffer_load_dwordx4 v33, s[32:35], s69 offen offset:1024 lds
  buffer_load_dwordx4 v34, s[32:35], s69 offen offset:2048 lds
  buffer_load_dwordx4 v35, s[32:35], s69 offen offset:3072 lds
  s_add_u32 m0, s15, 20992
  s_add_u32 s69, s67, 114688
  buffer_load_dwordx4 v32, s[32:35], s69 offen offset:0 lds
  buffer_load_dwordx4 v33, s[32:35], s69 offen offset:1024 lds
  buffer_load_dwordx4 v34, s[32:35], s69 offen offset:2048 lds
  buffer_load_dwordx4 v35, s[32:35], s69 offen offset:3072 lds
  s_waitcnt vmcnt(12)
  s_barrier
  s_add_u32 m0, s15, 122368
  s_add_u32 s67, s67, 128
  s_cmp_eq_u32 s67, 896
  s_cselect_b32 s67, 0, s67
  s_mov_b32 s69, s67
  buffer_load_dwordx4 v32, s[32:35], s69 offen offset:0 lds
  buffer_load_dwordx4 v33, s[32:35], s69 offen offset:1024 lds
  buffer_load_dwordx4 v34, s[32:35], s69 offen offset:2048 lds
  buffer_load_dwordx4 v35, s[32:35], s69 offen offset:3072 lds
  s_waitcnt vmcnt(12)
  s_barrier
  s_add_u32 m0, s15, 105472
  s_add_u32 s69, s67, 114688
  buffer_load_dwordx4 v32, s[32:35], s69 offen offset:0 lds
  buffer_load_dwordx4 v33, s[32:35], s69 offen offset:1024 lds
  buffer_load_dwordx4 v34, s[32:35], s69 offen offset:2048 lds
  buffer_load_dwordx4 v35, s[32:35], s69 offen offset:3072 lds
  s_add_u32 m0, s15, 54784
  s_add_u32 s67, s67, 128
  s_cmp_eq_u32 s67, 896
  s_cselect_b32 s67, 0, s67
  s_mov_b32 s69, s67
  buffer_load_dwordx4 v32, s[32:35], s69 offen offset:0 lds
  buffer_load_dwordx4 v33, s[32:35], s69 offen offset:1024 lds
  buffer_load_dwordx4 v34, s[32:35], s69 offen offset:2048 lds
  buffer_load_dwordx4 v35, s[32:35], s69 offen offset:3072 lds
  s_add_u32 m0, s15, 139264
  s_add_u32 s69, s67, 114688
  buffer_load_dwordx4 v32, s[32:35], s69 offen offset:0 lds
  buffer_load_dwordx4 v33, s[32:35], s69 offen offset:1024 lds
  buffer_load_dwordx4 v34, s[32:35], s69 offen offset:2048 lds
  buffer_load_dwordx4 v35, s[32:35], s69 offen offset:3072 lds
  s_waitcnt vmcnt(16)
  s_barrier
  s_add_u32 m0, s15, 4096
  s_add_u32 s67, s67, 128
  s_cmp_eq_u32 s67, 896
  s_cselect_b32 s67, 0, s67
  s_mov_b32 s69, s67
  buffer_load_dwordx4 v32, s[32:35], s69 offen offset:0 lds
  buffer_load_dwordx4 v33, s[32:35], s69 offen offset:1024 lds
  buffer_load_dwordx4 v34, s[32:35], s69 offen offset:2048 lds
  buffer_load_dwordx4 v35, s[32:35], s69 offen offset:3072 lds
  s_add_u32 m0, s15, 37888
  s_add_u32 s69, s67, 114688
  buffer_load_dwordx4 v32, s[32:35], s69 offen offset:0 lds
  buffer_load_dwordx4 v33, s[32:35], s69 offen offset:1024 lds
  buffer_load_dwordx4 v34, s[32:35], s69 offen offset:2048 lds
  buffer_load_dwordx4 v35, s[32:35], s69 offen offset:3072 lds
  s_waitcnt vmcnt(16)
  s_barrier
  s_add_u32 m0, s15, 71680
  s_add_u32 s67, s67, 128
  s_cmp_eq_u32 s67, 896
  s_cselect_b32 s67, 0, s67
  s_mov_b32 s69, s67
  buffer_load_dwordx4 v32, s[32:35], s69 offen offset:0 lds
  buffer_load_dwordx4 v33, s[32:35], s69 offen offset:1024 lds
  buffer_load_dwordx4 v34, s[32:35], s69 offen offset:2048 lds
  buffer_load_dwordx4 v35, s[32:35], s69 offen offset:3072 lds
  s_add_u32 m0, s15, 88576
  s_add_u32 s69, s67, 114688
  buffer_load_dwordx4 v32, s[32:35], s69 offen offset:0 lds
  buffer_load_dwordx4 v33, s[32:35], s69 offen offset:1024 lds
  buffer_load_dwordx4 v34, s[32:35], s69 offen offset:2048 lds
  buffer_load_dwordx4 v35, s[32:35], s69 offen offset:3072 lds
  s_waitcnt vmcnt(16)
  s_barrier
  s_add_u32 m0, s15, 20992
  s_add_u32 s67, s67, 128
  s_cmp_eq_u32 s67, 896
  s_cselect_b32 s67, 0, s67
  s_mov_b32 s69, s67
  buffer_load_dwordx4 v32, s[32:35], s69 offen offset:0 lds
  buffer_load_dwordx4 v33, s[32:35], s69 offen offset:1024 lds
  buffer_load_dwordx4 v34, s[32:35], s69 offen offset:2048 lds
  buffer_load_dwordx4 v35, s[32:35], s69 offen offset:3072 lds
  s_add_u32 m0, s15, 122368
  s_add_u32 s69, s67, 114688
  buffer_load_dwordx4 v32, s[32:35], s69 offen offset:0 lds
  buffer_load_dwordx4 v33, s[32:35], s69 offen offset:1024 lds
  buffer_load_dwordx4 v34, s[32:35], s69 offen offset:2048 lds
  buffer_load_dwordx4 v35, s[32:35], s69 offen offset:3072 lds
  s_mov_b32 s76, s6
  s_and_b32 s77, s14, 3
  s_mov_b32 s78, 0
  s_mov_b32 s80, 0
  s_mov_b32 s79, 2000
  v_mov_b32 v70, 0
  ds_read_b32 v70, v70
  s_mov_b32 s91, 1
  s_lshl_b32 s73, 0x10001, s6
  s_mov_b32 s74, 0
  s_lshl_b32 s88, s5, 3
  s_add_u32 s88, s88, s7
  s_mul_i32 s8, s88, 17408
  s_add_u32 s8, s8, 33554432
  s_add_u32 s28, s12, s8
  s_addc_u32 s29, s13, 0
  s_mov_b32 s30, 17408
  s_mov_b32 s31, 0x20000
  s_mul_i32 s8, s88, 1835008
  s_add_u32 s16, s12, s8
  s_addc_u32 s17, s13, 0
  s_mov_b32 s18, 1835008
  s_mov_b32 s19, 0x20000
  s_mov_b32 s20, s56
  s_mov_b32 s21, s57
  s_mov_b32 s22, 1835008
  s_mov_b32 s23, 0x20000
  v_mbcnt_lo_u32_b32 v71, -1, 0
  v_mbcnt_hi_u32_b32 v71, -1, v71
  s_and_b32 s4, s76, 3
  s_lshr_b32 s3, s76, 2
  s_add_u32 s60, s10, s77
  s_sub_u32 s61, s60, 7
  s_min_u32 s60, s60, s61
  s_min_u32 s61, s77, 2
  s_add_u32 s61, s61, s10
  s_add_u32 s61, s61, 4
  s_sub_u32 s8, s61, 7
  s_min_u32 s61, s61, s8
  s_mul_i32 s8, s3, 28672
  v_lshl_add_u32 v75, v71, 4, s8
  v_lshl_add_u32 v64, s60, 12, v75
  v_lshl_add_u32 v65, s61, 12, v75
  s_lshl_b32 s32, s4, 10
  s_xor_b32 s33, s32, 1024
  s_xor_b32 s34, s32, 2048
  s_xor_b32 s35, s32, 3072
  s_add_u32 s47, s35, 1720320
  s_add_u32 s46, s34, 1605632
  s_add_u32 s45, s33, 1490944
  s_add_u32 s44, s32, 1376256
  s_add_u32 s43, s35, 1261568
  s_add_u32 s42, s34, 1146880
  s_add_u32 s41, s33, 1032192
  s_add_u32 s40, s32, 917504
  s_add_u32 s39, s35, 802816
  s_add_u32 s38, s34, 688128
  s_add_u32 s37, s33, 573440
  s_add_u32 s36, s32, 458752
  s_add_u32 s35, s35, 344064
  s_add_u32 s34, s34, 229376
  s_add_u32 s33, s33, 114688
  s_lshl_b32 s60, s60, 2
  s_add_u32 s60, s60, s4
  s_lshl_b32 s61, s61, 2
  s_add_u32 s61, s61, s4
  s_lshl_b32 s8, s7, 2
  s_add_u32 s8, s8, s3
  s_mul_i32 s8, s8, 57344
  s_mul_i32 s4, s5, 896
  s_add_u32 s8, s8, s4
  v_and_b32 v72, 31, v71
  v_lshrrev_b32 v73, 5, v71
  v_mul_u32_u24 v75, 1792, v72
  v_lshl_add_u32 v75, v73, 4, v75
  v_add_u32 v75, s8, v75
  v_lshl_add_u32 v66, s60, 5, v75
  v_lshl_add_u32 v67, s61, 5, v75
  v_and_b32 v75, 15, v71
  v_lshlrev_b32 v75, 2, v75
  s_mul_i32 s3, s3, 4352
  v_add_u32 v69, s3, v75
  s_mov_b32 s90, 0
  s_mov_b32 s89, 0xffff0000
  s_mov_b64 s[94:95], -1
  s_cmp_eq_u32 s77, 3
  s_cselect_b32 s81, s89, 0
  s_cselect_b32 s84, 0x11110000, 0
  s_cselect_b64 s[92:93], 0, -1
  s_lshl_b32 s72, s76, 2
  s_lshl_b32 s3, s77, 10
  s_add_u32 s3, s3, 156160
  v_lshl_add_u32 v68, v71, 4, s3
  v_and_b32 v72, 1, v71
  v_lshlrev_b32 v72, 4, v72
  v_mov_b32 v73, 0x3f80
  v_lshlrev_b32 v72, v72, v73
  v_lshrrev_b32 v73, 3, v71
  v_xor_b32 v73, v73, v71
  v_and_b32 v73, 4, v73
  v_and_b32 v74, 0x1a, v71
  v_or_b32 v73, v73, v74
  v_cmp_eq_u32 vcc, 0, v73
  v_cndmask_b32 v120, 0, v72, vcc
  v_cmp_eq_u32 vcc, 2, v73
  v_cndmask_b32 v121, 0, v72, vcc
  v_cmp_eq_u32 vcc, 8, v73
  v_cndmask_b32 v122, 0, v72, vcc
  v_cmp_eq_u32 vcc, 10, v73
  v_cndmask_b32 v123, 0, v72, vcc
  v_mov_b32 v80, 0
  v_mov_b32 v81, 0
  v_mov_b32 v82, 0
  v_mov_b32 v83, 0
  v_mov_b32 v84, 0
  v_mov_b32 v85, 0
  v_mov_b32 v86, 0
  v_mov_b32 v87, 0
  v_mov_b32 v88, 0
  v_mov_b32 v89, 0
  v_mov_b32 v90, 0
  v_mov_b32 v91, 0
  v_mov_b32 v92, 0
  v_mov_b32 v93, 0
  v_mov_b32 v94, 0
  v_mov_b32 v95, 0
  v_mov_b32 v96, 0
  v_mov_b32 v97, 0
  v_mov_b32 v98, 0
  v_mov_b32 v99, 0
  v_mov_b32 v100, 0
  v_mov_b32 v101, 0
  v_mov_b32 v102, 0
  v_mov_b32 v103, 0
  v_mov_b32 v104, 0
  v_mov_b32 v105, 0
  v_mov_b32 v106, 0
  v_mov_b32 v107, 0
  v_mov_b32 v108, 0
  v_mov_b32 v109, 0
  v_mov_b32 v110, 0
  v_mov_b32 v111, 0
  s_waitcnt lgkmcnt(0)
  v_readfirstlane_b32 s83, v70
  s_waitcnt vmcnt(16)
  s_barrier
  s_waitcnt vmcnt(8)
  v_mov_b32 v70, 0
  s_mov_b64 exec, 0xffff
  buffer_atomic_or v70, v69, s[28:31], 0 offen sc0 sc1
  s_mov_b64 exec, -1
  s_barrier
  s_cmp_ge_u32 s83, 16
  s_cbranch_scc1 L_rloop
  s_mov_b32 s91, 0
  s_waitcnt vmcnt(0)
  s_barrier
L_rcnt:
  s_cmp_ge_u32 s83, 16
  s_cbranch_scc1 L_rgo
  s_sub_u32 s79, s79, 1
  s_cmp_lg_u32 s79, 0
  s_cbranch_scc1 L_rcnt1
  s_cmp_lg_u32 s80, 0
  s_cbranch_scc1 L_done
  s_mov_b32 s75, 0
  s_branch L_aband
L_rcnt1:
  v_mov_b32 v73, s88
  v_lshlrev_b32 v73, 4, v73
  global_load_dword v70, v73, s[58:59] sc1
  s_waitcnt vmcnt(0)
  v_readfirstlane_b32 s83, v70
  s_branch L_rcnt
L_rgo:
  v_mov_b32 v70, 0
  s_mov_b64 exec, 0xffff
  buffer_atomic_or v70, v69, s[28:31], 0 offen sc0 sc1
  s_mov_b64 exec, -1
L_rloop:
  s_waitcnt vmcnt(0)
  v_cmp_le_u32 vcc, 1, v70
  v_cmp_le_u32 s[62:63], 2, v70
  s_mov_b32 s82, s81
  s_pack_ll_b32_b16 s83, vcc_lo, s62
  s_andn2_b32 s85, s83, s82
  s_cbranch_scc0 L_rnone
  s_ff1_i32_b32 s3, s85
  s_lshl_b32 s3, 0xffff, s3
  s_and_b32 s85, s85, s3
  s_or_b32 s81, s81, s85
  s_and_b32 s74, s85, s73
  s_andn2_b32 s85, s85, s73
  s_and_b32 s3, s85, 0xf0000
  s_cbranch_scc0 L_rs4
  s_bitcmp1_b32 s85, 16
  s_cselect_b64 exec, s[92:93], 0
  buffer_load_dwordx4 v[192:195], v65, s[16:19], s32 offen sc1
  s_bitcmp1_b32 s85, 17
  s_cselect_b64 exec, s[92:93], 0
  buffer_load_dwordx4 v[196:199], v65, s[16:19], s33 offen sc1
  s_bitcmp1_b32 s85, 18
  s_cselect_b64 exec, s[92:93], 0
  buffer_load_dwordx4 v[200:203], v65, s[16:19], s34 offen sc1
  s_bitcmp1_b32 s85, 19
  s_cselect_b64 exec, s[92:93], 0
  buffer_load_dwordx4 v[204:207], v65, s[16:19], s35 offen sc1
L_rs4:
  s_and_b32 s3, s85, 0xf00000
  s_cbranch_scc0 L_rs5
  s_bitcmp1_b32 s85, 20
  s_cselect_b64 exec, s[92:93], 0
  buffer_load_dwordx4 v[208:211], v65, s[16:19], s36 offen sc1
  s_bitcmp1_b32 s85, 21
  s_cselect_b64 exec, s[92:93], 0
  buffer_load_dwordx4 v[212:215], v65, s[16:19], s37 offen sc1
  s_bitcmp1_b32 s85, 22
  s_cselect_b64 exec, s[92:93], 0
  buffer_load_dwordx4 v[216:219], v65, s[16:19], s38 offen sc1
  s_bitcmp1_b32 s85, 23
  s_cselect_b64 exec, s[92:93], 0
  buffer_load_dwordx4 v[220:223], v65, s[16:19], s39 offen sc1
L_rs5:
  s_and_b32 s3, s85, 0xf000000
  s_cbranch_scc0 L_rs6
  s_bitcmp1_b32 s85, 24
  s_cselect_b64 exec, s[92:93], 0
  buffer_load_dwordx4 v[224:227], v65, s[16:19], s40 offen sc1
  s_bitcmp1_b32 s85, 25
  s_cselect_b64 exec, s[92:93], 0
  buffer_load_dwordx4 v[228:231], v65, s[16:19], s41 offen sc1
  s_bitcmp1_b32 s85, 26
  s_cselect_b64 exec, s[92:93], 0
  buffer_load_dwordx4 v[232:235], v65, s[16:19], s42 offen sc1
  s_bitcmp1_b32 s85, 27
  s_cselect_b64 exec, s[92:93], 0
  buffer_load_dwordx4 v[236:239], v65, s[16:19], s43 offen sc1
L_rs6:
  s_and_b32 s3, s85, 0xf0000000
  s_cbranch_scc0 L_rs7
  s_bitcmp1_b32 s85, 28
  s_cselect_b64 exec, s[92:93], 0
  buffer_load_dwordx4 v[240:243], v65, s[16:19], s44 offen sc1
  s_bitcmp1_b32 s85, 29
  s_cselect_b64 exec, s[92:93], 0
  buffer_load_dwordx4 v[244:247], v65, s[16:19], s45 offen sc1
  s_bitcmp1_b32 s85, 30
  s_cselect_b64 exec, s[92:93], 0
  buffer_load_dwordx4 v[248:251], v65, s[16:19], s46 offen sc1
  s_bitcmp1_b32 s85, 31
  s_cselect_b64 exec, s[92:93], 0
  buffer_load_dwordx4 v[252:255], v65, s[16:19], s47 offen sc1
L_rs7:
  s_and_b32 s3, s85, 0xf
  s_cbranch_scc0 L_rs0
  s_bitcmp1_b32 s85, 0
  s_cselect_b64 exec, -1, 0
  buffer_load_dwordx4 v[128:131], v64, s[16:19], s32 offen sc1
  s_bitcmp1_b32 s85, 1
  s_cselect_b64 exec, -1, 0
  buffer_load_dwordx4 v[132:135], v64, s[16:19], s33 offen sc1
  s_bitcmp1_b32 s85, 2
  s_cselect_b64 exec, -1, 0
  buffer_load_dwordx4 v[136:139], v64, s[16:19], s34 offen sc1
  s_bitcmp1_b32 s85, 3
  s_cselect_b64 exec, -1, 0
  buffer_load_dwordx4 v[140:143], v64, s[16:19], s35 offen sc1
L_rs0:
  s_and_b32 s3, s85, 0xf0
  s_cbranch_scc0 L_rs1
  s_bitcmp1_b32 s85, 4
  s_cselect_b64 exec, -1, 0
  buffer_load_dwordx4 v[144:147], v64, s[16:19], s36 offen sc1
  s_bitcmp1_b32 s85, 5
  s_cselect_b64 exec, -1, 0
  buffer_load_dwordx4 v[148:151], v64, s[16:19], s37 offen sc1
  s_bitcmp1_b32 s85, 6
  s_cselect_b64 exec, -1, 0
  buffer_load_dwordx4 v[152:155], v64, s[16:19], s38 offen sc1
  s_bitcmp1_b32 s85, 7
  s_cselect_b64 exec, -1, 0
  buffer_load_dwordx4 v[156:159], v64, s[16:19], s39 offen sc1
L_rs1:
  s_and_b32 s3, s85, 0xf00
  s_cbranch_scc0 L_rs2
  s_bitcmp1_b32 s85, 8
  s_cselect_b64 exec, -1, 0
  buffer_load_dwordx4 v[160:163], v64, s[16:19], s40 offen sc1
  s_bitcmp1_b32 s85, 9
  s_cselect_b64 exec, -1, 0
  buffer_load_dwordx4 v[164:167], v64, s[16:19], s41 offen sc1
  s_bitcmp1_b32 s85, 10
  s_cselect_b64 exec, -1, 0
  buffer_load_dwordx4 v[168:171], v64, s[16:19], s42 offen sc1
  s_bitcmp1_b32 s85, 11
  s_cselect_b64 exec, -1, 0
  buffer_load_dwordx4 v[172:175], v64, s[16:19], s43 offen sc1
L_rs2:
  s_and_b32 s3, s85, 0xf000
  s_cbranch_scc0 L_rs3
  s_bitcmp1_b32 s85, 12
  s_cselect_b64 exec, -1, 0
  buffer_load_dwordx4 v[176:179], v64, s[16:19], s44 offen sc1
  s_bitcmp1_b32 s85, 13
  s_cselect_b64 exec, -1, 0
  buffer_load_dwordx4 v[180:183], v64, s[16:19], s45 offen sc1
  s_bitcmp1_b32 s85, 14
  s_cselect_b64 exec, -1, 0
  buffer_load_dwordx4 v[184:187], v64, s[16:19], s46 offen sc1
  s_bitcmp1_b32 s85, 15
  s_cselect_b64 exec, -1, 0
  buffer_load_dwordx4 v[188:191], v64, s[16:19], s47 offen sc1
L_rs3:
  s_mov_b64 exec, -1
L_rnone:
  s_cmp_eq_u32 s81, -1
  s_cbranch_scc1 L_rnp
  v_mov_b32 v70, 0
  s_mov_b64 exec, 0xffff
  buffer_atomic_or v70, v69, s[28:31], 0 offen sc0 sc1
  s_mov_b64 exec, -1
L_rnp:
  s_cmp_eq_u32 s74, 0
  s_cbranch_scc1 L_rno
  s_and_b32 s3, s74, 0xffff
  s_cbranch_scc0 L_rno0
  ds_read_b128 v[76:79], v68 offset:0
  s_waitcnt lgkmcnt(0)
  s_set_gpr_idx_on s72, gpr_idx(DST)
  v_mov_b32 v128, v76
  v_mov_b32 v129, v77
  v_mov_b32 v130, v78
  v_mov_b32 v131, v79
  s_set_gpr_idx_off
L_rno0:
  s_and_b32 s3, s74, 0xffff0000
  s_cbranch_scc0 L_rno1
  ds_read_b128 v[76:79], v68 offset:4096
  s_waitcnt lgkmcnt(0)
  s_set_gpr_idx_on s72, gpr_idx(DST)
  v_mov_b32 v192, v76
  v_mov_b32 v193, v77
  v_mov_b32 v194, v78
  v_mov_b32 v195, v79
  s_set_gpr_idx_off
L_rno1:
  s_mov_b32 s74, 0
L_rno:
  s_cmp_eq_u32 s91, 0
  s_cbranch_scc1 L_rnb
  s_barrier
  s_mov_b32 s91, 0
  s_setprio 0
L_rnb:
  s_lshr_b32 s3, s82, 1
  s_and_b32 s82, s82, s3
  s_lshr_b32 s3, s82, 2
  s_and_b32 s82, s82, s3
  s_and_b32 s82, s82, 0x11111111
  s_andn2_b32 s85, s82, s84
  s_cbranch_scc0 L_rnext
  s_or_b32 s84, s84, s85
  s_bitcmp1_b32 s85, 0
  s_cbranch_scc0 L_rm0
  v_mfma_f32_32x32x16_bf16 v[80:95], v[120:123], v[128:131], v[80:95]
  v_mfma_f32_32x32x16_bf16 v[80:95], v[120:123], v[132:135], v[80:95]
  v_mfma_f32_32x32x16_bf16 v[80:95], v[120:123], v[136:139], v[80:95]
  v_mfma_f32_32x32x16_bf16 v[80:95], v[120:123], v[140:143], v[80:95]
L_rm0:
  s_bitcmp1_b32 s85, 4
  s_cbranch_scc0 L_rm1
  v_mfma_f32_32x32x16_bf16 v[80:95], v[120:123], v[144:147], v[80:95]
  v_mfma_f32_32x32x16_bf16 v[80:95], v[120:123], v[148:151], v[80:95]
  v_mfma_f32_32x32x16_bf16 v[80:95], v[120:123], v[152:155], v[80:95]
  v_mfma_f32_32x32x16_bf16 v[80:95], v[120:123], v[156:159], v[80:95]
L_rm1:
  s_bitcmp1_b32 s85, 8
  s_cbranch_scc0 L_rm2
  v_mfma_f32_32x32x16_bf16 v[80:95], v[120:123], v[160:163], v[80:95]
  v_mfma_f32_32x32x16_bf16 v[80:95], v[120:123], v[164:167], v[80:95]
  v_mfma_f32_32x32x16_bf16 v[80:95], v[120:123], v[168:171], v[80:95]
  v_mfma_f32_32x32x16_bf16 v[80:95], v[120:123], v[172:175], v[80:95]
L_rm2:
  s_bitcmp1_b32 s85, 12
  s_cbranch_scc0 L_rm3
  v_mfma_f32_32x32x16_bf16 v[80:95], v[120:123], v[176:179], v[80:95]
  v_mfma_f32_32x32x16_bf16 v[80:95], v[120:123], v[180:183], v[80:95]
  v_mfma_f32_32x32x16_bf16 v[80:95], v[120:123], v[184:187], v[80:95]
  v_mfma_f32_32x32x16_bf16 v[80:95], v[120:123], v[188:191], v[80:95]
L_rm3:
  s_bitcmp1_b32 s85, 16
  s_cbranch_scc0 L_rm4
  v_mfma_f32_32x32x16_bf16 v[96:111], v[120:123], v[192:195], v[96:111]
  v_mfma_f32_32x32x16_bf16 v[96:111], v[120:123], v[196:199], v[96:111]
  v_mfma_f32_32x32x16_bf16 v[96:111], v[120:123], v[200:203], v[96:111]
  v_mfma_f32_32x32x16_bf16 v[96:111], v[120:123], v[204:207], v[96:111]
L_rm4:
  s_bitcmp1_b32 s85, 20
  s_cbranch_scc0 L_rm5
  v_mfma_f32_32x32x16_bf16 v[96:111], v[120:123], v[208:211], v[96:111]
  v_mfma_f32_32x32x16_bf16 v[96:111], v[120:123], v[212:215], v[96:111]
  v_mfma_f32_32x32x16_bf16 v[96:111], v[120:123], v[216:219], v[96:111]
  v_mfma_f32_32x32x16_bf16 v[96:111], v[120:123], v[220:223], v[96:111]
L_rm5:
  s_bitcmp1_b32 s85, 24
  s_cbranch_scc0 L_rm6
  v_mfma_f32_32x32x16_bf16 v[96:111], v[120:123], v[224:227], v[96:111]
  v_mfma_f32_32x32x16_bf16 v[96:111], v[120:123], v[228:231], v[96:111]
  v_mfma_f32_32x32x16_bf16 v[96:111], v[120:123], v[232:235], v[96:111]
  v_mfma_f32_32x32x16_bf16 v[96:111], v[120:123], v[236:239], v[96:111]
L_rm6:
  s_bitcmp1_b32 s85, 28
  s_cbranch_scc0 L_rm7
  v_mfma_f32_32x32x16_bf16 v[96:111], v[120:123], v[240:243], v[96:111]
  v_mfma_f32_32x32x16_bf16 v[96:111], v[120:123], v[244:247], v[96:111]
  v_mfma_f32_32x32x16_bf16 v[96:111], v[120:123], v[248:251], v[96:111]
  v_mfma_f32_32x32x16_bf16 v[96:111], v[120:123], v[252:255], v[96:111]
L_rm7:
L_rfq:
  s_lshr_b32 s3, s84, s90
  s_and_b32 s3, s3, 0x1111
  s_cmp_eq_u32 s3, 0x1111
  s_cbranch_scc0 L_rnext
  s_nop 7
  s_set_gpr_idx_on s90, gpr_idx(SRC0,SRC1)
  v_cvt_pk_bf16_f32 v112, v80, v81
  v_cvt_pk_bf16_f32 v113, v82, v83
  v_cvt_pk_bf16_f32 v114, v84, v85
  v_cvt_pk_bf16_f32 v115, v86, v87
  s_set_gpr_idx_off
  s_mov_b64 exec, s[94:95]
  buffer_store_dwordx4 v[112:115], v66, s[20:23], 0 offen
  s_mov_b64 exec, -1
  s_cmp_lg_u32 s90, 0
  s_cbranch_scc1 L_rfin
  s_mov_b32 s90, 16
  s_mov_b64 s[94:95], s[92:93]
  v_mov_b32 v66, v67
  s_branch L_rfq
L_rnext:
  s_sub_u32 s79, s79, 1
  s_cmp_lg_u32 s79, 0
  s_cbranch_scc1 L_rloop
  s_mov_b32 s79, 4
  s_cmp_eq_u32 s81, -1
  s_cbranch_scc1 L_rloop
  s_cmp_lg_u32 s80, 0
  s_cbranch_scc1 L_done
  s_mov_b32 s75, 1
  s_branch L_aband
L_rfin:
  s_cmp_lg_u32 s78, 0
  s_cbranch_scc1 L_rescue
  s_endpgm
  s_endpgm
.p2align 6
L_main:
  v_and_b32 v3, 31, v2
  v_lshrrev_b32 v4, 5, v2
  v_bfe_u32 v5, v2, 4, 1
  v_bfe_u32 v6, v2, 2, 2
  v_and_b32 v7, 3, v2
  v_bfe_u32 v8, v2, 1, 3
  v_lshrrev_b32 v15, 4, v2
  v_xor_b32 v8, v8, v15
  v_lshlrev_b32 v8, 4, v8
  v_and_b32 v9, 15, v2
  v_lshl_add_u32 v9, v1, 5, v9
  v_lshl_add_u32 v13, v9, 7, v8
  v_and_b32 v8, 1, v3
  v_lshlrev_b32 v9, 9, v8
  v_xor_b32 v8, v8, v4
  v_lshlrev_b32 v8, 4, v8
  v_add_u32 v8, v8, v9
  v_lshrrev_b32 v9, 1, v3
  v_mul_u32_u24 v9, 1056, v9
  v_add_u32 v240, v8, v9
  v_add_u32 v242, 49152, v240
  v_add_u32 v243, 98304, v240
  v_lshlrev_b32 v8, 2, v4
  v_add_u32 v8, v8, v6
  v_lshlrev_b32 v9, 8, v8
  v_lshlrev_b32 v10, 6, v6
  v_add_u32 v9, v9, v10
  v_lshlrev_b32 v11, 5, v5
  v_add_u32 v9, v9, v11
  v_lshlrev_b32 v12, 3, v7
  v_add_u32 v241, v9, v12
  v_and_b32 v12, 1, v7
  v_lshlrev_b32 v12, 4, v12
  v_add_u32 v11, v11, v12
  v_lshrrev_b32 v12, 1, v7
  v_lshlrev_b32 v12, 3, v12
  v_add_u32 v11, v11, v12
  v_lshlrev_b32 v9, 7, v8
  v_lshrrev_b32 v12, 1, v6
  v_lshlrev_b32 v12, 6, v12
  v_add_u32 v9, v9, v12
  v_add_u32 v254, v9, v11
  v_mul_u32_u24 v9, 4224, v15
  v_mul_u32_u24 v8, 544, v6
  v_add_u32 v9, v9, v8
  v_lshl_add_u32 v14, v7, 3, v9
  v_mul_u32_u24 v8, 28672, v1
  v_lshlrev_b32 v9, 4, v2
  v_add_u32 v255, v8, v9
  v_xor_b32 v215, 0x0, v14
  v_xor_b32 v214, 0x20, v14
  v_xor_b32 v213, 0xc000, v14
  v_xor_b32 v212, 0xc020, v14
  v_xor_b32 v211, 0x18000, v14
  v_xor_b32 v210, 0x18020, v14
  v_xor_b32 v160, 0x0, v13
  v_xor_b32 v161, 0x40, v13
  v_xor_b32 v162, 0xc000, v13
  v_xor_b32 v163, 0xc040, v13
  v_xor_b32 v164, 0x18000, v13
  v_xor_b32 v165, 0x18040, v13
  s_lshl_b32 s3, s5, 3
  s_add_u32 s3, s3, s7
  s_lshl_b32 s3, s3, 4
  s_add_u32 s3, s3, s6
  s_mul_i32 s3, s3, 114688
  s_waitcnt lgkmcnt(0)
  s_add_u32 s24, s12, s3
  s_addc_u32 s25, s13, 0
  s_mov_b32 s26, 114688
  s_mov_b32 s27, 0x20000
  s_mov_b32 s40, 0x3db8aa3b
  s_mov_b32 s41, 0xbdb8aa3b
  s_lshl_b32 s48, s10, 12
  s_add_u32 s49, s48, 4096
  s_cmp_eq_u32 s49, 28672
  s_cselect_b32 s49, 0, s49
  s_add_u32 s50, s49, 4096
  s_cmp_eq_u32 s50, 28672
  s_cselect_b32 s50, 0, s50
  s_add_u32 s51, s50, 4096
  s_cmp_eq_u32 s51, 28672
  s_cselect_b32 s51, 0, s51
  s_add_u32 s52, s51, 4096
  s_cmp_eq_u32 s52, 28672
  s_cselect_b32 s52, 0, s52
  s_add_u32 s53, s52, 4096
  s_cmp_eq_u32 s53, 28672
  s_cselect_b32 s53, 0, s53
  s_add_u32 s54, s53, 4096
  s_cmp_eq_u32 s54, 28672
  s_cselect_b32 s54, 0, s54
  s_lshl_b32 s3, s11, 5
  v_xor_b32 v254, s3, v254
  s_lshr_b32 s3, s6, 2
  s_cmp_eq_u32 s3, s14
  s_cselect_b64 vcc, -1, 0
  s_mul_i32 s17, s14, 28672
  s_sub_u32 s17, 156160, s17
  s_lshl_b32 s88, s5, 3
  s_add_u32 s88, s88, s7
  s_mul_i32 s8, s88, 17408
  s_add_u32 s8, s8, 33554432
  s_add_u32 s28, s12, s8
  s_addc_u32 s29, s13, 0
  s_mov_b32 s30, 17408
  s_mov_b32 s31, 0x20000
  v_and_b32 v249, 3, v2
  v_mul_u32_u24 v249, 4352, v249
  s_lshl_b32 s3, s6, 2
  v_add_u32 v249, s3, v249
  s_lshr_b32 s4, s6, 2
  s_mul_i32 s4, s4, 4352
  s_lshl_b32 s8, s11, 2
  s_add_u32 s4, s4, s8
  s_add_u32 s4, s4, 128
  v_writelane_b32 v249, s4, 4
  v_mov_b32 v250, 0
  s_cmp_eq_u32 s14, 0
  s_cselect_b64 s[42:43], 31, 0
  s_cselect_b64 s[44:45], 1, 0
  s_mul_i32 s47, s14, 4352
  s_add_u32 s46, s47, s3
  s_mov_b64 exec, s[42:43]
  buffer_store_dword v250, v249, s[28:31], 0 offen sc1
  s_mov_b64 exec, -1
  s_barrier
  ds_read_b128 v[144:147], v160 offset:4096
  ds_read_b128 v[148:151], v160 offset:6144
  ds_read_b128 v[152:155], v161 offset:4096
  ds_read_b128 v[156:159], v161 offset:6144
  s_barrier
  ds_read_b64_tr_b16 v[224:225], v215 offset:20992
  ds_read_b64_tr_b16 v[226:227], v215 offset:23104
  ds_read_b64_tr_b16 v[228:229], v215 offset:21248
  ds_read_b64_tr_b16 v[230:231], v215 offset:23360
  ds_read_b64_tr_b16 v[232:233], v214 offset:20992
  ds_read_b64_tr_b16 v[234:235], v214 offset:23104
  ds_read_b64_tr_b16 v[236:237], v214 offset:21248
  ds_read_b64_tr_b16 v[238:239], v214 offset:23360
  ds_read_b64_tr_b16 v[216:217], v215 offset:21056
  ds_read_b64_tr_b16 v[218:219], v215 offset:23168
  s_waitcnt lgkmcnt(8)
  v_mfma_f32_16x16x32_bf16 v[0:3], v[224:227], v[144:147], 0
  v_mfma_f32_16x16x32_bf16 v[4:7], v[224:227], v[148:151], 0
  ds_read_b64_tr_b16 v[220:221], v215 offset:21312
  ds_read_b64_tr_b16 v[222:223], v215 offset:23424
  s_waitcnt lgkmcnt(8)
  v_mfma_f32_16x16x32_bf16 v[64:67], v[228:231], v[144:147], 0
  v_mfma_f32_16x16x32_bf16 v[68:71], v[228:231], v[148:151], 0
  ds_read_b64_tr_b16 v[224:225], v214 offset:21056
  ds_read_b64_tr_b16 v[226:227], v214 offset:23168
  s_waitcnt lgkmcnt(6)
  v_mfma_f32_16x16x32_bf16 v[8:11], v[232:235], v[144:147], 0
  v_mfma_f32_16x16x32_bf16 v[12:15], v[232:235], v[148:151], 0
  ds_read_b64_tr_b16 v[228:229], v214 offset:21312
  ds_read_b64_tr_b16 v[230:231], v214 offset:23424
  v_mfma_f32_16x16x32_bf16 v[72:75], v[236:239], v[144:147], 0
  v_mfma_f32_16x16x32_bf16 v[76:79], v[236:239], v[148:151], 0
  ds_read_b64_tr_b16 v[232:233], v215 offset:21120
  ds_read_b64_tr_b16 v[234:235], v215 offset:23232
  s_waitcnt lgkmcnt(6)
  v_mfma_f32_16x16x32_bf16 v[16:19], v[216:219], v[144:147], 0
  v_mfma_f32_16x16x32_bf16 v[20:23], v[216:219], v[148:151], 0
  ds_read_b64_tr_b16 v[236:237], v215 offset:21376
  ds_read_b64_tr_b16 v[238:239], v215 offset:23488
  v_mfma_f32_16x16x32_bf16 v[80:83], v[220:223], v[144:147], 0
  v_mfma_f32_16x16x32_bf16 v[84:87], v[220:223], v[148:151], 0
  ds_read_b64_tr_b16 v[216:217], v214 offset:21120
  ds_read_b64_tr_b16 v[218:219], v214 offset:23232
  s_waitcnt lgkmcnt(6)
  v_mfma_f32_16x16x32_bf16 v[24:27], v[224:227], v[144:147], 0
  v_mfma_f32_16x16x32_bf16 v[28:31], v[224:227], v[148:151], 0
  ds_read_b64_tr_b16 v[220:221], v214 offset:21376
  ds_read_b64_tr_b16 v[222:223], v214 offset:23488
  v_mfma_f32_16x16x32_bf16 v[88:91], v[228:231], v[144:147], 0
  v_mfma_f32_16x16x32_bf16 v[92:95], v[228:231], v[148:151], 0
  ds_read_b64_tr_b16 v[224:225], v215 offset:21184
  ds_read_b64_tr_b16 v[226:227], v215 offset:23296
  s_waitcnt lgkmcnt(6)
  v_mfma_f32_16x16x32_bf16 v[32:35], v[232:235], v[144:147], 0
  v_mfma_f32_16x16x32_bf16 v[36:39], v[232:235], v[148:151], 0
  ds_read_b64_tr_b16 v[228:229], v215 offset:21440
  ds_read_b64_tr_b16 v[230:231], v215 offset:23552
  v_mfma_f32_16x16x32_bf16 v[96:99], v[236:239], v[144:147], 0
  v_mfma_f32_16x16x32_bf16 v[100:103], v[236:239], v[148:151], 0
  ds_read_b64_tr_b16 v[232:233], v214 offset:21184
  ds_read_b64_tr_b16 v[234:235], v214 offset:23296
  s_waitcnt lgkmcnt(6)
  v_mfma_f32_16x16x32_bf16 v[40:43], v[216:219], v[144:147], 0
  v_mfma_f32_16x16x32_bf16 v[44:47], v[216:219], v[148:151], 0
  ds_read_b64_tr_b16 v[236:237], v214 offset:21440
  ds_read_b64_tr_b16 v[238:239], v214 offset:23552
  v_mfma_f32_16x16x32_bf16 v[104:107], v[220:223], v[144:147], 0
  v_mfma_f32_16x16x32_bf16 v[108:111], v[220:223], v[148:151], 0
  s_barrier
  ds_read_b64_tr_b16 v[216:217], v215 offset:37888
  ds_read_b64_tr_b16 v[218:219], v215 offset:40000
  s_waitcnt lgkmcnt(6)
  v_mfma_f32_16x16x32_bf16 v[48:51], v[224:227], v[144:147], 0
  v_mfma_f32_16x16x32_bf16 v[52:55], v[224:227], v[148:151], 0
  ds_read_b64_tr_b16 v[220:221], v215 offset:38144
  ds_read_b64_tr_b16 v[222:223], v215 offset:40256
  v_mfma_f32_16x16x32_bf16 v[112:115], v[228:231], v[144:147], 0
  v_mfma_f32_16x16x32_bf16 v[116:119], v[228:231], v[148:151], 0
  ds_read_b64_tr_b16 v[224:225], v214 offset:37888
  ds_read_b64_tr_b16 v[226:227], v214 offset:40000
  s_waitcnt lgkmcnt(6)
  v_mfma_f32_16x16x32_bf16 v[56:59], v[232:235], v[144:147], 0
  v_mfma_f32_16x16x32_bf16 v[60:63], v[232:235], v[148:151], 0
  ds_read_b64_tr_b16 v[228:229], v214 offset:38144
  ds_read_b64_tr_b16 v[230:231], v214 offset:40256
  v_mfma_f32_16x16x32_bf16 v[120:123], v[236:239], v[144:147], 0
  v_mfma_f32_16x16x32_bf16 v[124:127], v[236:239], v[148:151], 0
  ds_read_b64_tr_b16 v[232:233], v215 offset:37952
  ds_read_b64_tr_b16 v[234:235], v215 offset:40064
  s_waitcnt lgkmcnt(6)
  v_mfma_f32_16x16x32_bf16 v[0:3], v[216:219], v[152:155], v[0:3]
  v_mfma_f32_16x16x32_bf16 v[4:7], v[216:219], v[156:159], v[4:7]
  ds_read_b64_tr_b16 v[236:237], v215 offset:38208
  ds_read_b64_tr_b16 v[238:239], v215 offset:40320
  v_mfma_f32_16x16x32_bf16 v[64:67], v[220:223], v[152:155], v[64:67]
  v_mfma_f32_16x16x32_bf16 v[68:71], v[220:223], v[156:159], v[68:71]
  ds_read_b64_tr_b16 v[216:217], v214 offset:37952
  ds_read_b64_tr_b16 v[218:219], v214 offset:40064
  s_waitcnt lgkmcnt(6)
  v_mfma_f32_16x16x32_bf16 v[8:11], v[224:227], v[152:155], v[8:11]
  v_mfma_f32_16x16x32_bf16 v[12:15], v[224:227], v[156:159], v[12:15]
  ds_read_b64_tr_b16 v[220:221], v214 offset:38208
  ds_read_b64_tr_b16 v[222:223], v214 offset:40320
  v_mfma_f32_16x16x32_bf16 v[72:75], v[228:231], v[152:155], v[72:75]
  v_mfma_f32_16x16x32_bf16 v[76:79], v[228:231], v[156:159], v[76:79]
  s_barrier
  ds_read_b128 v[128:131], v162 offset:5632
  ds_read_b64_tr_b16 v[224:225], v215 offset:38016
  ds_read_b64_tr_b16 v[226:227], v215 offset:40128
  s_waitcnt lgkmcnt(7)
  v_mfma_f32_16x16x32_bf16 v[16:19], v[232:235], v[152:155], v[16:19]
  v_mfma_f32_16x16x32_bf16 v[20:23], v[232:235], v[156:159], v[20:23]
  ds_read_b64_tr_b16 v[228:229], v215 offset:38272
  ds_read_b64_tr_b16 v[230:231], v215 offset:40384
  v_mfma_f32_16x16x32_bf16 v[80:83], v[236:239], v[152:155], v[80:83]
  v_mfma_f32_16x16x32_bf16 v[84:87], v[236:239], v[156:159], v[84:87]
  ds_read_b128 v[132:135], v162 offset:7680
  ds_read_b64_tr_b16 v[232:233], v214 offset:38016
  ds_read_b64_tr_b16 v[234:235], v214 offset:40128
  s_waitcnt lgkmcnt(8)
  v_mfma_f32_16x16x32_bf16 v[24:27], v[216:219], v[152:155], v[24:27]
  v_mfma_f32_16x16x32_bf16 v[28:31], v[216:219], v[156:159], v[28:31]
  ds_read_b64_tr_b16 v[236:237], v214 offset:38272
  ds_read_b64_tr_b16 v[238:239], v214 offset:40384
  v_mfma_f32_16x16x32_bf16 v[88:91], v[220:223], v[152:155], v[88:91]
  v_mfma_f32_16x16x32_bf16 v[92:95], v[220:223], v[156:159], v[92:95]
  ds_read_b128 v[136:139], v163 offset:5632
  ds_read_b64_tr_b16 v[216:217], v215 offset:38080
  ds_read_b64_tr_b16 v[218:219], v215 offset:40192
  s_waitcnt lgkmcnt(8)
  v_mfma_f32_16x16x32_bf16 v[32:35], v[224:227], v[152:155], v[32:35]
  v_mfma_f32_16x16x32_bf16 v[36:39], v[224:227], v[156:159], v[36:39]
  ds_read_b64_tr_b16 v[220:221], v215 offset:38336
  ds_read_b64_tr_b16 v[222:223], v215 offset:40448
  v_mfma_f32_16x16x32_bf16 v[96:99], v[228:231], v[152:155], v[96:99]
  v_mfma_f32_16x16x32_bf16 v[100:103], v[228:231], v[156:159], v[100:103]
  ds_read_b128 v[140:143], v163 offset:7680
  ds_read_b64_tr_b16 v[224:225], v214 offset:38080
  ds_read_b64_tr_b16 v[226:227], v214 offset:40192
  s_waitcnt lgkmcnt(8)
  v_mfma_f32_16x16x32_bf16 v[40:43], v[232:235], v[152:155], v[40:43]
  v_mfma_f32_16x16x32_bf16 v[44:47], v[232:235], v[156:159], v[44:47]
  ds_read_b64_tr_b16 v[228:229], v214 offset:38336
  ds_read_b64_tr_b16 v[230:231], v214 offset:40448
  v_mfma_f32_16x16x32_bf16 v[104:107], v[236:239], v[152:155], v[104:107]
  v_mfma_f32_16x16x32_bf16 v[108:111], v[236:239], v[156:159], v[108:111]
  s_barrier
  ds_read_b64_tr_b16 v[232:233], v213 offset:22528
  ds_read_b64_tr_b16 v[234:235], v213 offset:24640
  s_waitcnt lgkmcnt(7)
  v_mfma_f32_16x16x32_bf16 v[48:51], v[216:219], v[152:155], v[48:51]
  v_mfma_f32_16x16x32_bf16 v[52:55], v[216:219], v[156:159], v[52:55]
  ds_read_b64_tr_b16 v[236:237], v213 offset:22784
  ds_read_b64_tr_b16 v[238:239], v213 offset:24896
  v_mfma_f32_16x16x32_bf16 v[112:115], v[220:223], v[152:155], v[112:115]
  v_mfma_f32_16x16x32_bf16 v[116:119], v[220:223], v[156:159], v[116:119]
  ds_read_b64_tr_b16 v[216:217], v212 offset:22528
  ds_read_b64_tr_b16 v[218:219], v212 offset:24640
  s_waitcnt lgkmcnt(6)
  v_mfma_f32_16x16x32_bf16 v[56:59], v[224:227], v[152:155], v[56:59]
  v_mfma_f32_16x16x32_bf16 v[60:63], v[224:227], v[156:159], v[60:63]
  ds_read_b64_tr_b16 v[220:221], v212 offset:22784
  ds_read_b64_tr_b16 v[222:223], v212 offset:24896
  v_mfma_f32_16x16x32_bf16 v[120:123], v[228:231], v[152:155], v[120:123]
  v_mfma_f32_16x16x32_bf16 v[124:127], v[228:231], v[156:159], v[124:127]
  ds_read_b64_tr_b16 v[224:225], v213 offset:22592
  ds_read_b64_tr_b16 v[226:227], v213 offset:24704
  s_waitcnt lgkmcnt(6)
  v_mfma_f32_16x16x32_bf16 v[0:3], v[232:235], v[128:131], v[0:3]
  v_mfma_f32_16x16x32_bf16 v[4:7], v[232:235], v[132:135], v[4:7]
  ds_read_b64_tr_b16 v[228:229], v213 offset:22848
  ds_read_b64_tr_b16 v[230:231], v213 offset:24960
  v_mfma_f32_16x16x32_bf16 v[64:67], v[236:239], v[128:131], v[64:67]
  v_mfma_f32_16x16x32_bf16 v[68:71], v[236:239], v[132:135], v[68:71]
  ds_read_b64_tr_b16 v[232:233], v212 offset:22592
  ds_read_b64_tr_b16 v[234:235], v212 offset:24704
  s_waitcnt lgkmcnt(6)
  v_mfma_f32_16x16x32_bf16 v[8:11], v[216:219], v[128:131], v[8:11]
  v_mfma_f32_16x16x32_bf16 v[12:15], v[216:219], v[132:135], v[12:15]
  ds_read_b64_tr_b16 v[236:237], v212 offset:22848
  ds_read_b64_tr_b16 v[238:239], v212 offset:24960
  v_mfma_f32_16x16x32_bf16 v[72:75], v[220:223], v[128:131], v[72:75]
  v_mfma_f32_16x16x32_bf16 v[76:79], v[220:223], v[132:135], v[76:79]
  ds_read_b64_tr_b16 v[216:217], v213 offset:22656
  ds_read_b64_tr_b16 v[218:219], v213 offset:24768
  s_waitcnt lgkmcnt(6)
  v_mfma_f32_16x16x32_bf16 v[16:19], v[224:227], v[128:131], v[16:19]
  v_mfma_f32_16x16x32_bf16 v[20:23], v[224:227], v[132:135], v[20:23]
  ds_read_b64_tr_b16 v[220:221], v213 offset:22912
  ds_read_b64_tr_b16 v[222:223], v213 offset:25024
  v_mfma_f32_16x16x32_bf16 v[80:83], v[228:231], v[128:131], v[80:83]
  v_mfma_f32_16x16x32_bf16 v[84:87], v[228:231], v[132:135], v[84:87]
  ds_read_b64_tr_b16 v[224:225], v212 offset:22656
  ds_read_b64_tr_b16 v[226:227], v212 offset:24768
  s_waitcnt lgkmcnt(6)
  v_mfma_f32_16x16x32_bf16 v[24:27], v[232:235], v[128:131], v[24:27]
  v_mfma_f32_16x16x32_bf16 v[28:31], v[232:235], v[132:135], v[28:31]
  ds_read_b64_tr_b16 v[228:229], v212 offset:22912
  ds_read_b64_tr_b16 v[230:231], v212 offset:25024
  v_mfma_f32_16x16x32_bf16 v[88:91], v[236:239], v[128:131], v[88:91]
  v_mfma_f32_16x16x32_bf16 v[92:95], v[236:239], v[132:135], v[92:95]
  ds_read_b64_tr_b16 v[232:233], v213 offset:22720
  ds_read_b64_tr_b16 v[234:235], v213 offset:24832
  s_waitcnt lgkmcnt(6)
  v_mfma_f32_16x16x32_bf16 v[32:35], v[216:219], v[128:131], v[32:35]
  v_mfma_f32_16x16x32_bf16 v[36:39], v[216:219], v[132:135], v[36:39]
  ds_read_b64_tr_b16 v[236:237], v213 offset:22976
  ds_read_b64_tr_b16 v[238:239], v213 offset:25088
  v_mfma_f32_16x16x32_bf16 v[96:99], v[220:223], v[128:131], v[96:99]
  v_mfma_f32_16x16x32_bf16 v[100:103], v[220:223], v[132:135], v[100:103]
  ds_read_b64_tr_b16 v[216:217], v212 offset:22720
  ds_read_b64_tr_b16 v[218:219], v212 offset:24832
  s_waitcnt lgkmcnt(6)
  v_mfma_f32_16x16x32_bf16 v[40:43], v[224:227], v[128:131], v[40:43]
  v_mfma_f32_16x16x32_bf16 v[44:47], v[224:227], v[132:135], v[44:47]
  ds_read_b64_tr_b16 v[220:221], v212 offset:22976
  ds_read_b64_tr_b16 v[222:223], v212 offset:25088
  v_mfma_f32_16x16x32_bf16 v[104:107], v[228:231], v[128:131], v[104:107]
  v_mfma_f32_16x16x32_bf16 v[108:111], v[228:231], v[132:135], v[108:111]
  s_barrier
  ds_read_b64_tr_b16 v[224:225], v213 offset:39424
  ds_read_b64_tr_b16 v[226:227], v213 offset:41536
  s_waitcnt lgkmcnt(6)
  v_mfma_f32_16x16x32_bf16 v[48:51], v[232:235], v[128:131], v[48:51]
  v_mfma_f32_16x16x32_bf16 v[52:55], v[232:235], v[132:135], v[52:55]
  ds_read_b64_tr_b16 v[228:229], v213 offset:39680
  ds_read_b64_tr_b16 v[230:231], v213 offset:41792
  v_mfma_f32_16x16x32_bf16 v[112:115], v[236:239], v[128:131], v[112:115]
  v_mfma_f32_16x16x32_bf16 v[116:119], v[236:239], v[132:135], v[116:119]
  ds_read_b64_tr_b16 v[232:233], v212 offset:39424
  ds_read_b64_tr_b16 v[234:235], v212 offset:41536
  s_waitcnt lgkmcnt(6)
  v_mfma_f32_16x16x32_bf16 v[56:59], v[216:219], v[128:131], v[56:59]
  v_mfma_f32_16x16x32_bf16 v[60:63], v[216:219], v[132:135], v[60:63]
  ds_read_b64_tr_b16 v[236:237], v212 offset:39680
  ds_read_b64_tr_b16 v[238:239], v212 offset:41792
  v_mfma_f32_16x16x32_bf16 v[120:123], v[220:223], v[128:131], v[120:123]
  v_mfma_f32_16x16x32_bf16 v[124:127], v[220:223], v[132:135], v[124:127]
  ds_read_b64_tr_b16 v[216:217], v213 offset:39488
  ds_read_b64_tr_b16 v[218:219], v213 offset:41600
  s_waitcnt lgkmcnt(6)
  v_mfma_f32_16x16x32_bf16 v[0:3], v[224:227], v[136:139], v[0:3]
  v_mfma_f32_16x16x32_bf16 v[4:7], v[224:227], v[140:143], v[4:7]
  ds_read_b64_tr_b16 v[220:221], v213 offset:39744
  ds_read_b64_tr_b16 v[222:223], v213 offset:41856
  v_mfma_f32_16x16x32_bf16 v[64:67], v[228:231], v[136:139], v[64:67]
  v_mfma_f32_16x16x32_bf16 v[68:71], v[228:231], v[140:143], v[68:71]
  ds_read_b64_tr_b16 v[224:225], v212 offset:39488
  ds_read_b64_tr_b16 v[226:227], v212 offset:41600
  s_waitcnt lgkmcnt(6)
  v_mfma_f32_16x16x32_bf16 v[8:11], v[232:235], v[136:139], v[8:11]
  v_mfma_f32_16x16x32_bf16 v[12:15], v[232:235], v[140:143], v[12:15]
  ds_read_b64_tr_b16 v[228:229], v212 offset:39744
  ds_read_b64_tr_b16 v[230:231], v212 offset:41856
  v_mfma_f32_16x16x32_bf16 v[72:75], v[236:239], v[136:139], v[72:75]
  v_mfma_f32_16x16x32_bf16 v[76:79], v[236:239], v[140:143], v[76:79]
  s_barrier
  ds_read_b128 v[144:147], v164 offset:7168
  ds_read_b64_tr_b16 v[232:233], v213 offset:39552
  ds_read_b64_tr_b16 v[234:235], v213 offset:41664
  s_waitcnt lgkmcnt(7)
  v_mfma_f32_16x16x32_bf16 v[16:19], v[216:219], v[136:139], v[16:19]
  v_mfma_f32_16x16x32_bf16 v[20:23], v[216:219], v[140:143], v[20:23]
  ds_read_b64_tr_b16 v[236:237], v213 offset:39808
  ds_read_b64_tr_b16 v[238:239], v213 offset:41920
  v_mfma_f32_16x16x32_bf16 v[80:83], v[220:223], v[136:139], v[80:83]
  v_mfma_f32_16x16x32_bf16 v[84:87], v[220:223], v[140:143], v[84:87]
  ds_read_b128 v[148:151], v164 offset:9216
  ds_read_b64_tr_b16 v[216:217], v212 offset:39552
  ds_read_b64_tr_b16 v[218:219], v212 offset:41664
  s_waitcnt lgkmcnt(8)
  v_mfma_f32_16x16x32_bf16 v[24:27], v[224:227], v[136:139], v[24:27]
  v_mfma_f32_16x16x32_bf16 v[28:31], v[224:227], v[140:143], v[28:31]
  ds_read_b64_tr_b16 v[220:221], v212 offset:39808
  ds_read_b64_tr_b16 v[222:223], v212 offset:41920
  v_mfma_f32_16x16x32_bf16 v[88:91], v[228:231], v[136:139], v[88:91]
  v_mfma_f32_16x16x32_bf16 v[92:95], v[228:231], v[140:143], v[92:95]
  ds_read_b128 v[152:155], v165 offset:7168
  ds_read_b64_tr_b16 v[224:225], v213 offset:39616
  ds_read_b64_tr_b16 v[226:227], v213 offset:41728
  s_waitcnt lgkmcnt(8)
  v_mfma_f32_16x16x32_bf16 v[32:35], v[232:235], v[136:139], v[32:35]
  v_mfma_f32_16x16x32_bf16 v[36:39], v[232:235], v[140:143], v[36:39]
  ds_read_b64_tr_b16 v[228:229], v213 offset:39872
  ds_read_b64_tr_b16 v[230:231], v213 offset:41984
  v_mfma_f32_16x16x32_bf16 v[96:99], v[236:239], v[136:139], v[96:99]
  v_mfma_f32_16x16x32_bf16 v[100:103], v[236:239], v[140:143], v[100:103]
  ds_read_b128 v[156:159], v165 offset:9216
  ds_read_b64_tr_b16 v[232:233], v212 offset:39616
  ds_read_b64_tr_b16 v[234:235], v212 offset:41728
  s_waitcnt lgkmcnt(8)
  v_mfma_f32_16x16x32_bf16 v[40:43], v[216:219], v[136:139], v[40:43]
  v_mfma_f32_16x16x32_bf16 v[44:47], v[216:219], v[140:143], v[44:47]
  ds_read_b64_tr_b16 v[236:237], v212 offset:39872
  ds_read_b64_tr_b16 v[238:239], v212 offset:41984
  v_mfma_f32_16x16x32_bf16 v[104:107], v[220:223], v[136:139], v[104:107]
  v_mfma_f32_16x16x32_bf16 v[108:111], v[220:223], v[140:143], v[108:111]
  s_barrier
  ds_read_b64_tr_b16 v[216:217], v211 offset:40960
  ds_read_b64_tr_b16 v[218:219], v211 offset:43072
  s_waitcnt lgkmcnt(7)
  v_mfma_f32_16x16x32_bf16 v[48:51], v[224:227], v[136:139], v[48:51]
  v_mfma_f32_16x16x32_bf16 v[52:55], v[224:227], v[140:143], v[52:55]
  ds_read_b64_tr_b16 v[220:221], v211 offset:41216
  ds_read_b64_tr_b16 v[222:223], v211 offset:43328
  v_mfma_f32_16x16x32_bf16 v[112:115], v[228:231], v[136:139], v[112:115]
  v_mfma_f32_16x16x32_bf16 v[116:119], v[228:231], v[140:143], v[116:119]
  ds_read_b64_tr_b16 v[224:225], v210 offset:40960
  ds_read_b64_tr_b16 v[226:227], v210 offset:43072
  s_waitcnt lgkmcnt(6)
  v_mfma_f32_16x16x32_bf16 v[56:59], v[232:235], v[136:139], v[56:59]
  v_mfma_f32_16x16x32_bf16 v[60:63], v[232:235], v[140:143], v[60:63]
  ds_read_b64_tr_b16 v[228:229], v210 offset:41216
  ds_read_b64_tr_b16 v[230:231], v210 offset:43328
  v_mfma_f32_16x16x32_bf16 v[120:123], v[236:239], v[136:139], v[120:123]
  v_mfma_f32_16x16x32_bf16 v[124:127], v[236:239], v[140:143], v[124:127]
  ds_read_b64_tr_b16 v[232:233], v211 offset:41024
  ds_read_b64_tr_b16 v[234:235], v211 offset:43136
  s_waitcnt lgkmcnt(6)
  v_mfma_f32_16x16x32_bf16 v[0:3], v[216:219], v[144:147], v[0:3]
  v_mfma_f32_16x16x32_bf16 v[4:7], v[216:219], v[148:151], v[4:7]
  ds_read_b64_tr_b16 v[236:237], v211 offset:41280
  ds_read_b64_tr_b16 v[238:239], v211 offset:43392
  v_mfma_f32_16x16x32_bf16 v[64:67], v[220:223], v[144:147], v[64:67]
  v_mfma_f32_16x16x32_bf16 v[68:71], v[220:223], v[148:151], v[68:71]
  ds_read_b64_tr_b16 v[216:217], v210 offset:41024
  ds_read_b64_tr_b16 v[218:219], v210 offset:43136
  s_waitcnt lgkmcnt(6)
  v_mfma_f32_16x16x32_bf16 v[8:11], v[224:227], v[144:147], v[8:11]
  v_mfma_f32_16x16x32_bf16 v[12:15], v[224:227], v[148:151], v[12:15]
  ds_read_b64_tr_b16 v[220:221], v210 offset:41280
  ds_read_b64_tr_b16 v[222:223], v210 offset:43392
  v_mfma_f32_16x16x32_bf16 v[72:75], v[228:231], v[144:147], v[72:75]
  v_mfma_f32_16x16x32_bf16 v[76:79], v[228:231], v[148:151], v[76:79]
  ds_read_b64_tr_b16 v[224:225], v211 offset:41088
  ds_read_b64_tr_b16 v[226:227], v211 offset:43200
  s_waitcnt lgkmcnt(6)
  v_mfma_f32_16x16x32_bf16 v[16:19], v[232:235], v[144:147], v[16:19]
  v_mfma_f32_16x16x32_bf16 v[20:23], v[232:235], v[148:151], v[20:23]
  ds_read_b64_tr_b16 v[228:229], v211 offset:41344
  ds_read_b64_tr_b16 v[230:231], v211 offset:43456
  v_mfma_f32_16x16x32_bf16 v[80:83], v[236:239], v[144:147], v[80:83]
  v_mfma_f32_16x16x32_bf16 v[84:87], v[236:239], v[148:151], v[84:87]
  ds_read_b64_tr_b16 v[232:233], v210 offset:41088
  ds_read_b64_tr_b16 v[234:235], v210 offset:43200
  s_waitcnt lgkmcnt(6)
  v_mfma_f32_16x16x32_bf16 v[24:27], v[216:219], v[144:147], v[24:27]
  v_mfma_f32_16x16x32_bf16 v[28:31], v[216:219], v[148:151], v[28:31]
  ds_read_b64_tr_b16 v[236:237], v210 offset:41344
  ds_read_b64_tr_b16 v[238:239], v210 offset:43456
  v_mfma_f32_16x16x32_bf16 v[88:91], v[220:223], v[144:147], v[88:91]
  v_mfma_f32_16x16x32_bf16 v[92:95], v[220:223], v[148:151], v[92:95]
  ds_read_b64_tr_b16 v[216:217], v211 offset:41152
  ds_read_b64_tr_b16 v[218:219], v211 offset:43264
  s_waitcnt lgkmcnt(6)
  v_mfma_f32_16x16x32_bf16 v[32:35], v[224:227], v[144:147], v[32:35]
  v_mfma_f32_16x16x32_bf16 v[36:39], v[224:227], v[148:151], v[36:39]
  ds_read_b64_tr_b16 v[220:221], v211 offset:41408
  ds_read_b64_tr_b16 v[222:223], v211 offset:43520
  v_mfma_f32_16x16x32_bf16 v[96:99], v[228:231], v[144:147], v[96:99]
  v_mfma_f32_16x16x32_bf16 v[100:103], v[228:231], v[148:151], v[100:103]
  ds_read_b64_tr_b16 v[224:225], v210 offset:41152
  ds_read_b64_tr_b16 v[226:227], v210 offset:43264
  s_waitcnt lgkmcnt(6)
  v_mfma_f32_16x16x32_bf16 v[40:43], v[232:235], v[144:147], v[40:43]
  v_mfma_f32_16x16x32_bf16 v[44:47], v[232:235], v[148:151], v[44:47]
  ds_read_b64_tr_b16 v[228:229], v210 offset:41408
  ds_read_b64_tr_b16 v[230:231], v210 offset:43520
  v_mfma_f32_16x16x32_bf16 v[104:107], v[236:239], v[144:147], v[104:107]
  v_mfma_f32_16x16x32_bf16 v[108:111], v[236:239], v[148:151], v[108:111]
  s_barrier
  ds_read_b64_tr_b16 v[232:233], v215 offset:4096
  ds_read_b64_tr_b16 v[234:235], v215 offset:6208
  s_waitcnt lgkmcnt(6)
  v_mfma_f32_16x16x32_bf16 v[48:51], v[216:219], v[144:147], v[48:51]
  v_mfma_f32_16x16x32_bf16 v[52:55], v[216:219], v[148:151], v[52:55]
  ds_read_b64_tr_b16 v[236:237], v215 offset:4352
  ds_read_b64_tr_b16 v[238:239], v215 offset:6464
  v_mfma_f32_16x16x32_bf16 v[112:115], v[220:223], v[144:147], v[112:115]
  v_mfma_f32_16x16x32_bf16 v[116:119], v[220:223], v[148:151], v[116:119]
  ds_read_b64_tr_b16 v[216:217], v214 offset:4096
  ds_read_b64_tr_b16 v[218:219], v214 offset:6208
  s_waitcnt lgkmcnt(6)
  v_mfma_f32_16x16x32_bf16 v[56:59], v[224:227], v[144:147], v[56:59]
  v_mfma_f32_16x16x32_bf16 v[60:63], v[224:227], v[148:151], v[60:63]
  ds_read_b64_tr_b16 v[220:221], v214 offset:4352
  ds_read_b64_tr_b16 v[222:223], v214 offset:6464
  v_mfma_f32_16x16x32_bf16 v[120:123], v[228:231], v[144:147], v[120:123]
  v_mfma_f32_16x16x32_bf16 v[124:127], v[228:231], v[148:151], v[124:127]
  ds_read_b64_tr_b16 v[224:225], v215 offset:4160
  ds_read_b64_tr_b16 v[226:227], v215 offset:6272
  s_waitcnt lgkmcnt(6)
  v_mfma_f32_16x16x32_bf16 v[0:3], v[232:235], v[152:155], v[0:3]
  v_mfma_f32_16x16x32_bf16 v[4:7], v[232:235], v[156:159], v[4:7]
  ds_read_b64_tr_b16 v[228:229], v215 offset:4416
  ds_read_b64_tr_b16 v[230:231], v215 offset:6528
  v_mfma_f32_16x16x32_bf16 v[64:67], v[236:239], v[152:155], v[64:67]
  v_mfma_f32_16x16x32_bf16 v[68:71], v[236:239], v[156:159], v[68:71]
  ds_read_b64_tr_b16 v[232:233], v214 offset:4160
  ds_read_b64_tr_b16 v[234:235], v214 offset:6272
  s_waitcnt lgkmcnt(6)
  v_mfma_f32_16x16x32_bf16 v[8:11], v[216:219], v[152:155], v[8:11]
  v_mfma_f32_16x16x32_bf16 v[12:15], v[216:219], v[156:159], v[12:15]
  ds_read_b64_tr_b16 v[236:237], v214 offset:4416
  ds_read_b64_tr_b16 v[238:239], v214 offset:6528
  v_mfma_f32_16x16x32_bf16 v[72:75], v[220:223], v[152:155], v[72:75]
  v_mfma_f32_16x16x32_bf16 v[76:79], v[220:223], v[156:159], v[76:79]
  ds_read_b128 v[128:131], v160 offset:20992
  ds_read_b64_tr_b16 v[216:217], v215 offset:4224
  ds_read_b64_tr_b16 v[218:219], v215 offset:6336
  s_waitcnt lgkmcnt(7)
  v_mfma_f32_16x16x32_bf16 v[16:19], v[224:227], v[152:155], v[16:19]
  v_mfma_f32_16x16x32_bf16 v[20:23], v[224:227], v[156:159], v[20:23]
  ds_read_b64_tr_b16 v[220:221], v215 offset:4480
  ds_read_b64_tr_b16 v[222:223], v215 offset:6592
  v_mfma_f32_16x16x32_bf16 v[80:83], v[228:231], v[152:155], v[80:83]
  v_mfma_f32_16x16x32_bf16 v[84:87], v[228:231], v[156:159], v[84:87]
  ds_read_b128 v[132:135], v160 offset:23040
  ds_read_b64_tr_b16 v[224:225], v214 offset:4224
  ds_read_b64_tr_b16 v[226:227], v214 offset:6336
  s_waitcnt lgkmcnt(8)
  v_mfma_f32_16x16x32_bf16 v[24:27], v[232:235], v[152:155], v[24:27]
  v_mfma_f32_16x16x32_bf16 v[28:31], v[232:235], v[156:159], v[28:31]
  ds_read_b64_tr_b16 v[228:229], v214 offset:4480
  ds_read_b64_tr_b16 v[230:231], v214 offset:6592
  v_mfma_f32_16x16x32_bf16 v[88:91], v[236:239], v[152:155], v[88:91]
  v_mfma_f32_16x16x32_bf16 v[92:95], v[236:239], v[156:159], v[92:95]
  ds_read_b128 v[136:139], v161 offset:20992
  ds_read_b64_tr_b16 v[232:233], v215 offset:4288
  ds_read_b64_tr_b16 v[234:235], v215 offset:6400
  s_waitcnt lgkmcnt(8)
  v_mfma_f32_16x16x32_bf16 v[32:35], v[216:219], v[152:155], v[32:35]
  v_mfma_f32_16x16x32_bf16 v[36:39], v[216:219], v[156:159], v[36:39]
  ds_read_b64_tr_b16 v[236:237], v215 offset:4544
  ds_read_b64_tr_b16 v[238:239], v215 offset:6656
  v_mfma_f32_16x16x32_bf16 v[96:99], v[220:223], v[152:155], v[96:99]
  v_mfma_f32_16x16x32_bf16 v[100:103], v[220:223], v[156:159], v[100:103]
  ds_read_b128 v[140:143], v161 offset:23040
  ds_read_b64_tr_b16 v[216:217], v214 offset:4288
  ds_read_b64_tr_b16 v[218:219], v214 offset:6400
  s_waitcnt lgkmcnt(8)
  v_mfma_f32_16x16x32_bf16 v[40:43], v[224:227], v[152:155], v[40:43]
  v_mfma_f32_16x16x32_bf16 v[44:47], v[224:227], v[156:159], v[44:47]
  ds_read_b64_tr_b16 v[220:221], v214 offset:4544
  ds_read_b64_tr_b16 v[222:223], v214 offset:6656
  v_mfma_f32_16x16x32_bf16 v[104:107], v[228:231], v[152:155], v[104:107]
  v_mfma_f32_16x16x32_bf16 v[108:111], v[228:231], v[156:159], v[108:111]
  s_barrier
  ds_read_b64_tr_b16 v[224:225], v213 offset:5632
  ds_read_b64_tr_b16 v[226:227], v213 offset:7744
  s_waitcnt lgkmcnt(7)
  v_mfma_f32_16x16x32_bf16 v[48:51], v[232:235], v[152:155], v[48:51]
  v_mfma_f32_16x16x32_bf16 v[52:55], v[232:235], v[156:159], v[52:55]
  ds_read_b64_tr_b16 v[228:229], v213 offset:5888
  ds_read_b64_tr_b16 v[230:231], v213 offset:8000
  v_mfma_f32_16x16x32_bf16 v[112:115], v[236:239], v[152:155], v[112:115]
  v_mfma_f32_16x16x32_bf16 v[116:119], v[236:239], v[156:159], v[116:119]
  ds_read_b64_tr_b16 v[232:233], v212 offset:5632
  ds_read_b64_tr_b16 v[234:235], v212 offset:7744
  s_waitcnt lgkmcnt(6)
  v_mfma_f32_16x16x32_bf16 v[56:59], v[216:219], v[152:155], v[56:59]
  v_mfma_f32_16x16x32_bf16 v[60:63], v[216:219], v[156:159], v[60:63]
  ds_read_b64_tr_b16 v[236:237], v212 offset:5888
  ds_read_b64_tr_b16 v[238:239], v212 offset:8000
  v_mfma_f32_16x16x32_bf16 v[120:123], v[220:223], v[152:155], v[120:123]
  v_mfma_f32_16x16x32_bf16 v[124:127], v[220:223], v[156:159], v[124:127]
  ds_read_b64_tr_b16 v[216:217], v213 offset:5696
  ds_read_b64_tr_b16 v[218:219], v213 offset:7808
  s_waitcnt lgkmcnt(6)
  v_mfma_f32_16x16x32_bf16 v[0:3], v[224:227], v[128:131], v[0:3]
  v_mfma_f32_16x16x32_bf16 v[4:7], v[224:227], v[132:135], v[4:7]
  ds_read_b64_tr_b16 v[220:221], v213 offset:5952
  ds_read_b64_tr_b16 v[222:223], v213 offset:8064
  v_mfma_f32_16x16x32_bf16 v[64:67], v[228:231], v[128:131], v[64:67]
  v_mfma_f32_16x16x32_bf16 v[68:71], v[228:231], v[132:135], v[68:71]
  ds_read_b64_tr_b16 v[224:225], v212 offset:5696
  ds_read_b64_tr_b16 v[226:227], v212 offset:7808
  s_waitcnt lgkmcnt(6)
  v_mfma_f32_16x16x32_bf16 v[8:11], v[232:235], v[128:131], v[8:11]
  v_mfma_f32_16x16x32_bf16 v[12:15], v[232:235], v[132:135], v[12:15]
  ds_read_b64_tr_b16 v[228:229], v212 offset:5952
  ds_read_b64_tr_b16 v[230:231], v212 offset:8064
  v_mfma_f32_16x16x32_bf16 v[72:75], v[236:239], v[128:131], v[72:75]
  v_mfma_f32_16x16x32_bf16 v[76:79], v[236:239], v[132:135], v[76:79]
  ds_read_b64_tr_b16 v[232:233], v213 offset:5760
  ds_read_b64_tr_b16 v[234:235], v213 offset:7872
  s_waitcnt lgkmcnt(6)
  v_mfma_f32_16x16x32_bf16 v[16:19], v[216:219], v[128:131], v[16:19]
  v_mfma_f32_16x16x32_bf16 v[20:23], v[216:219], v[132:135], v[20:23]
  ds_read_b64_tr_b16 v[236:237], v213 offset:6016
  ds_read_b64_tr_b16 v[238:239], v213 offset:8128
  v_mfma_f32_16x16x32_bf16 v[80:83], v[220:223], v[128:131], v[80:83]
  s_waitcnt vmcnt(0)
  v_mov_b32 v249, s88
  v_mov_b32 v250, 1
  v_lshlrev_b32 v249, 4, v249
  s_mov_b64 exec, s[44:45]
  global_atomic_add v249, v250, s[58:59] sc1
  s_mov_b64 exec, -1
  v_mfma_f32_16x16x32_bf16 v[84:87], v[220:223], v[132:135], v[84:87]
  ds_read_b64_tr_b16 v[216:217], v212 offset:5760
  ds_read_b64_tr_b16 v[218:219], v212 offset:7872
  s_waitcnt lgkmcnt(6)
  v_mfma_f32_16x16x32_bf16 v[24:27], v[224:227], v[128:131], v[24:27]
  v_mfma_f32_16x16x32_bf16 v[28:31], v[224:227], v[132:135], v[28:31]
  ds_read_b64_tr_b16 v[220:221], v212 offset:6016
  ds_read_b64_tr_b16 v[222:223], v212 offset:8128
  v_mfma_f32_16x16x32_bf16 v[88:91], v[228:231], v[128:131], v[88:91]
  v_mfma_f32_16x16x32_bf16 v[92:95], v[228:231], v[132:135], v[92:95]
  ds_read_b64_tr_b16 v[224:225], v213 offset:5824
  ds_read_b64_tr_b16 v[226:227], v213 offset:7936
  s_waitcnt lgkmcnt(6)
  v_mfma_f32_16x16x32_bf16 v[32:35], v[232:235], v[128:131], v[32:35]
  v_mfma_f32_16x16x32_bf16 v[36:39], v[232:235], v[132:135], v[36:39]
  ds_read_b64_tr_b16 v[228:229], v213 offset:6080
  ds_read_b64_tr_b16 v[230:231], v213 offset:8192
  v_mfma_f32_16x16x32_bf16 v[96:99], v[236:239], v[128:131], v[96:99]
  v_mfma_f32_16x16x32_bf16 v[100:103], v[236:239], v[132:135], v[100:103]
  ds_read_b64_tr_b16 v[232:233], v212 offset:5824
  ds_read_b64_tr_b16 v[234:235], v212 offset:7936
  s_waitcnt lgkmcnt(6)
  v_mfma_f32_16x16x32_bf16 v[40:43], v[216:219], v[128:131], v[40:43]
  v_mfma_f32_16x16x32_bf16 v[44:47], v[216:219], v[132:135], v[44:47]
  ds_read_b64_tr_b16 v[236:237], v212 offset:6080
  ds_read_b64_tr_b16 v[238:239], v212 offset:8192
  v_mfma_f32_16x16x32_bf16 v[104:107], v[220:223], v[128:131], v[104:107]
  v_mfma_f32_16x16x32_bf16 v[108:111], v[220:223], v[132:135], v[108:111]
  s_barrier
  ds_read_b64_tr_b16 v[216:217], v215 offset:37888
  ds_read_b64_tr_b16 v[218:219], v215 offset:40000
  s_waitcnt lgkmcnt(6)
  v_mfma_f32_16x16x32_bf16 v[48:51], v[224:227], v[128:131], v[48:51]
  v_mfma_f32_16x16x32_bf16 v[52:55], v[224:227], v[132:135], v[52:55]
  ds_read_b64_tr_b16 v[220:221], v215 offset:38144
  ds_read_b64_tr_b16 v[222:223], v215 offset:40256
  v_mfma_f32_16x16x32_bf16 v[112:115], v[228:231], v[128:131], v[112:115]
  v_mfma_f32_16x16x32_bf16 v[116:119], v[228:231], v[132:135], v[116:119]
  ds_read_b64_tr_b16 v[224:225], v214 offset:37888
  ds_read_b64_tr_b16 v[226:227], v214 offset:40000
  s_waitcnt lgkmcnt(6)
  v_mfma_f32_16x16x32_bf16 v[56:59], v[232:235], v[128:131], v[56:59]
  v_mfma_f32_16x16x32_bf16 v[60:63], v[232:235], v[132:135], v[60:63]
  ds_read_b64_tr_b16 v[228:229], v214 offset:38144
  ds_read_b64_tr_b16 v[230:231], v214 offset:40256
  v_mfma_f32_16x16x32_bf16 v[120:123], v[236:239], v[128:131], v[120:123]
  v_mfma_f32_16x16x32_bf16 v[124:127], v[236:239], v[132:135], v[124:127]
  ds_read_b64_tr_b16 v[232:233], v215 offset:37952
  ds_read_b64_tr_b16 v[234:235], v215 offset:40064
  s_waitcnt lgkmcnt(6)
  v_mfma_f32_16x16x32_bf16 v[0:3], v[216:219], v[136:139], v[0:3]
  v_mfma_f32_16x16x32_bf16 v[4:7], v[216:219], v[140:143], v[4:7]
  ds_read_b64_tr_b16 v[236:237], v215 offset:38208
  ds_read_b64_tr_b16 v[238:239], v215 offset:40320
  v_mfma_f32_16x16x32_bf16 v[64:67], v[220:223], v[136:139], v[64:67]
  v_mfma_f32_16x16x32_bf16 v[68:71], v[220:223], v[140:143], v[68:71]
  ds_read_b64_tr_b16 v[216:217], v214 offset:37952
  ds_read_b64_tr_b16 v[218:219], v214 offset:40064
  s_waitcnt lgkmcnt(6)
  v_mfma_f32_16x16x32_bf16 v[8:11], v[224:227], v[136:139], v[8:11]
  v_mfma_f32_16x16x32_bf16 v[12:15], v[224:227], v[140:143], v[12:15]
  ds_read_b64_tr_b16 v[220:221], v214 offset:38208
  ds_read_b64_tr_b16 v[222:223], v214 offset:40320
  v_mfma_f32_16x16x32_bf16 v[72:75], v[228:231], v[136:139], v[72:75]
  v_mfma_f32_16x16x32_bf16 v[76:79], v[228:231], v[140:143], v[76:79]
  ds_read_b128 v[144:147], v162 offset:22528
  ds_read_b64_tr_b16 v[224:225], v215 offset:38016
  ds_read_b64_tr_b16 v[226:227], v215 offset:40128
  s_waitcnt lgkmcnt(7)
  v_mfma_f32_16x16x32_bf16 v[16:19], v[232:235], v[136:139], v[16:19]
  v_mfma_f32_16x16x32_bf16 v[20:23], v[232:235], v[140:143], v[20:23]
  ds_read_b64_tr_b16 v[228:229], v215 offset:38272
  ds_read_b64_tr_b16 v[230:231], v215 offset:40384
  v_mfma_f32_16x16x32_bf16 v[80:83], v[236:239], v[136:139], v[80:83]
  v_mfma_f32_16x16x32_bf16 v[84:87], v[236:239], v[140:143], v[84:87]
  ds_read_b128 v[148:151], v162 offset:24576
  ds_read_b64_tr_b16 v[232:233], v214 offset:38016
  ds_read_b64_tr_b16 v[234:235], v214 offset:40128
  s_waitcnt lgkmcnt(8)
  v_mfma_f32_16x16x32_bf16 v[24:27], v[216:219], v[136:139], v[24:27]
  v_mfma_f32_16x16x32_bf16 v[28:31], v[216:219], v[140:143], v[28:31]
  ds_read_b64_tr_b16 v[236:237], v214 offset:38272
  ds_read_b64_tr_b16 v[238:239], v214 offset:40384
  v_mfma_f32_16x16x32_bf16 v[88:91], v[220:223], v[136:139], v[88:91]
  v_mfma_f32_16x16x32_bf16 v[92:95], v[220:223], v[140:143], v[92:95]
  ds_read_b128 v[152:155], v163 offset:22528
  ds_read_b64_tr_b16 v[216:217], v215 offset:38080
  ds_read_b64_tr_b16 v[218:219], v215 offset:40192
  s_waitcnt lgkmcnt(8)
  v_mfma_f32_16x16x32_bf16 v[32:35], v[224:227], v[136:139], v[32:35]
  v_mfma_f32_16x16x32_bf16 v[36:39], v[224:227], v[140:143], v[36:39]
  ds_read_b64_tr_b16 v[220:221], v215 offset:38336
  ds_read_b64_tr_b16 v[222:223], v215 offset:40448
  v_mfma_f32_16x16x32_bf16 v[96:99], v[228:231], v[136:139], v[96:99]
  v_mfma_f32_16x16x32_bf16 v[100:103], v[228:231], v[140:143], v[100:103]
  ds_read_b128 v[156:159], v163 offset:24576
  ds_read_b64_tr_b16 v[224:225], v214 offset:38080
  ds_read_b64_tr_b16 v[226:227], v214 offset:40192
  s_waitcnt lgkmcnt(8)
  v_mfma_f32_16x16x32_bf16 v[40:43], v[232:235], v[136:139], v[40:43]
  v_mfma_f32_16x16x32_bf16 v[44:47], v[232:235], v[140:143], v[44:47]
  ds_read_b64_tr_b16 v[228:229], v214 offset:38336
  ds_read_b64_tr_b16 v[230:231], v214 offset:40448
  v_mfma_f32_16x16x32_bf16 v[104:107], v[236:239], v[136:139], v[104:107]
  v_mfma_f32_16x16x32_bf16 v[108:111], v[236:239], v[140:143], v[108:111]
  s_barrier
  ds_read_b64_tr_b16 v[232:233], v213 offset:39424
  ds_read_b64_tr_b16 v[234:235], v213 offset:41536
  s_waitcnt lgkmcnt(7)
  v_mfma_f32_16x16x32_bf16 v[48:51], v[216:219], v[136:139], v[48:51]
  v_mfma_f32_16x16x32_bf16 v[52:55], v[216:219], v[140:143], v[52:55]
  ds_read_b64_tr_b16 v[236:237], v213 offset:39680
  ds_read_b64_tr_b16 v[238:239], v213 offset:41792
  v_mfma_f32_16x16x32_bf16 v[112:115], v[220:223], v[136:139], v[112:115]
  v_mfma_f32_16x16x32_bf16 v[116:119], v[220:223], v[140:143], v[116:119]
  ds_read_b64_tr_b16 v[216:217], v212 offset:39424
  ds_read_b64_tr_b16 v[218:219], v212 offset:41536
  s_waitcnt lgkmcnt(6)
  v_mfma_f32_16x16x32_bf16 v[56:59], v[224:227], v[136:139], v[56:59]
  v_mfma_f32_16x16x32_bf16 v[60:63], v[224:227], v[140:143], v[60:63]
  ds_read_b64_tr_b16 v[220:221], v212 offset:39680
  ds_read_b64_tr_b16 v[222:223], v212 offset:41792
  v_mfma_f32_16x16x32_bf16 v[120:123], v[228:231], v[136:139], v[120:123]
  v_mfma_f32_16x16x32_bf16 v[124:127], v[228:231], v[140:143], v[124:127]
  ds_read_b64_tr_b16 v[224:225], v213 offset:39488
  ds_read_b64_tr_b16 v[226:227], v213 offset:41600
  s_waitcnt lgkmcnt(6)
  v_mfma_f32_16x16x32_bf16 v[0:3], v[232:235], v[144:147], v[0:3]
  v_mfma_f32_16x16x32_bf16 v[4:7], v[232:235], v[148:151], v[4:7]
  ds_read_b64_tr_b16 v[228:229], v213 offset:39744
  ds_read_b64_tr_b16 v[230:231], v213 offset:41856
  v_mfma_f32_16x16x32_bf16 v[64:67], v[236:239], v[144:147], v[64:67]
  v_mfma_f32_16x16x32_bf16 v[68:71], v[236:239], v[148:151], v[68:71]
  ds_read_b64_tr_b16 v[232:233], v212 offset:39488
  ds_read_b64_tr_b16 v[234:235], v212 offset:41600
  s_waitcnt lgkmcnt(6)
  v_mfma_f32_16x16x32_bf16 v[8:11], v[216:219], v[144:147], v[8:11]
  v_mfma_f32_16x16x32_bf16 v[12:15], v[216:219], v[148:151], v[12:15]
  ds_read_b64_tr_b16 v[236:237], v212 offset:39744
  ds_read_b64_tr_b16 v[238:239], v212 offset:41856
  v_mfma_f32_16x16x32_bf16 v[72:75], v[220:223], v[144:147], v[72:75]
  v_mfma_f32_16x16x32_bf16 v[76:79], v[220:223], v[148:151], v[76:79]
  ds_read_b64_tr_b16 v[216:217], v213 offset:39552
  ds_read_b64_tr_b16 v[218:219], v213 offset:41664
  s_waitcnt lgkmcnt(6)
  v_mfma_f32_16x16x32_bf16 v[16:19], v[224:227], v[144:147], v[16:19]
  v_mfma_f32_16x16x32_bf16 v[20:23], v[224:227], v[148:151], v[20:23]
  ds_read_b64_tr_b16 v[220:221], v213 offset:39808
  ds_read_b64_tr_b16 v[222:223], v213 offset:41920
  v_mfma_f32_16x16x32_bf16 v[80:83], v[228:231], v[144:147], v[80:83]
  v_mfma_f32_16x16x32_bf16 v[84:87], v[228:231], v[148:151], v[84:87]
  ds_read_b64_tr_b16 v[224:225], v212 offset:39552
  ds_read_b64_tr_b16 v[226:227], v212 offset:41664
  s_waitcnt lgkmcnt(6)
  v_mfma_f32_16x16x32_bf16 v[24:27], v[232:235], v[144:147], v[24:27]
  v_mfma_f32_16x16x32_bf16 v[28:31], v[232:235], v[148:151], v[28:31]
  ds_read_b64_tr_b16 v[228:229], v212 offset:39808
  ds_read_b64_tr_b16 v[230:231], v212 offset:41920
  v_mfma_f32_16x16x32_bf16 v[88:91], v[236:239], v[144:147], v[88:91]
  v_mfma_f32_16x16x32_bf16 v[92:95], v[236:239], v[148:151], v[92:95]
  ds_read_b64_tr_b16 v[232:233], v213 offset:39616
  ds_read_b64_tr_b16 v[234:235], v213 offset:41728
  s_waitcnt lgkmcnt(6)
  v_mfma_f32_16x16x32_bf16 v[32:35], v[216:219], v[144:147], v[32:35]
  v_mfma_f32_16x16x32_bf16 v[36:39], v[216:219], v[148:151], v[36:39]
  ds_read_b64_tr_b16 v[236:237], v213 offset:39872
  ds_read_b64_tr_b16 v[238:239], v213 offset:41984
  v_mfma_f32_16x16x32_bf16 v[96:99], v[220:223], v[144:147], v[96:99]
  v_mfma_f32_16x16x32_bf16 v[100:103], v[220:223], v[148:151], v[100:103]
  ds_read_b64_tr_b16 v[216:217], v212 offset:39616
  ds_read_b64_tr_b16 v[218:219], v212 offset:41728
  s_waitcnt lgkmcnt(6)
  v_mfma_f32_16x16x32_bf16 v[40:43], v[224:227], v[144:147], v[40:43]
  v_mfma_f32_16x16x32_bf16 v[44:47], v[224:227], v[148:151], v[44:47]
  ds_read_b64_tr_b16 v[220:221], v212 offset:39872
  ds_read_b64_tr_b16 v[222:223], v212 offset:41984
  v_mfma_f32_16x16x32_bf16 v[104:107], v[228:231], v[144:147], v[104:107]
  v_mfma_f32_16x16x32_bf16 v[108:111], v[228:231], v[148:151], v[108:111]
  s_barrier
  ds_read_b64_tr_b16 v[224:225], v211 offset:40960
  ds_read_b64_tr_b16 v[226:227], v211 offset:43072
  s_waitcnt lgkmcnt(6)
  v_mfma_f32_16x16x32_bf16 v[48:51], v[232:235], v[144:147], v[48:51]
  v_mfma_f32_16x16x32_bf16 v[52:55], v[232:235], v[148:151], v[52:55]
  ds_read_b64_tr_b16 v[228:229], v211 offset:41216
  ds_read_b64_tr_b16 v[230:231], v211 offset:43328
  v_mfma_f32_16x16x32_bf16 v[112:115], v[236:239], v[144:147], v[112:115]
  v_mfma_f32_16x16x32_bf16 v[116:119], v[236:239], v[148:151], v[116:119]
  ds_read_b64_tr_b16 v[232:233], v210 offset:40960
  ds_read_b64_tr_b16 v[234:235], v210 offset:43072
  s_waitcnt lgkmcnt(6)
  v_mfma_f32_16x16x32_bf16 v[56:59], v[216:219], v[144:147], v[56:59]
  v_mfma_f32_16x16x32_bf16 v[60:63], v[216:219], v[148:151], v[60:63]
  ds_read_b64_tr_b16 v[236:237], v210 offset:41216
  ds_read_b64_tr_b16 v[238:239], v210 offset:43328
  v_mfma_f32_16x16x32_bf16 v[120:123], v[220:223], v[144:147], v[120:123]
  v_mfma_f32_16x16x32_bf16 v[124:127], v[220:223], v[148:151], v[124:127]
  ds_read_b64_tr_b16 v[216:217], v211 offset:41024
  ds_read_b64_tr_b16 v[218:219], v211 offset:43136
  s_waitcnt lgkmcnt(6)
  v_mfma_f32_16x16x32_bf16 v[0:3], v[224:227], v[152:155], v[0:3]
  v_mfma_f32_16x16x32_bf16 v[4:7], v[224:227], v[156:159], v[4:7]
  ds_read_b64_tr_b16 v[220:221], v211 offset:41280
  ds_read_b64_tr_b16 v[222:223], v211 offset:43392
  v_mfma_f32_16x16x32_bf16 v[64:67], v[228:231], v[152:155], v[64:67]
  v_mfma_f32_16x16x32_bf16 v[68:71], v[228:231], v[156:159], v[68:71]
  ds_read_b64_tr_b16 v[224:225], v210 offset:41024
  ds_read_b64_tr_b16 v[226:227], v210 offset:43136
  s_waitcnt lgkmcnt(6)
  v_mfma_f32_16x16x32_bf16 v[8:11], v[232:235], v[152:155], v[8:11]
  v_mfma_f32_16x16x32_bf16 v[12:15], v[232:235], v[156:159], v[12:15]
  ds_read_b64_tr_b16 v[228:229], v210 offset:41280
  ds_read_b64_tr_b16 v[230:231], v210 offset:43392
  v_mfma_f32_16x16x32_bf16 v[72:75], v[236:239], v[152:155], v[72:75]
  v_mfma_f32_16x16x32_bf16 v[76:79], v[236:239], v[156:159], v[76:79]
  ds_read_b128 v[128:131], v160 offset:20992
  ds_read_b64_tr_b16 v[232:233], v211 offset:41088
  ds_read_b64_tr_b16 v[234:235], v211 offset:43200
  s_waitcnt lgkmcnt(7)
  v_mfma_f32_16x16x32_bf16 v[16:19], v[216:219], v[152:155], v[16:19]
  v_mfma_f32_16x16x32_bf16 v[20:23], v[216:219], v[156:159], v[20:23]
  ds_read_b64_tr_b16 v[236:237], v211 offset:41344
  ds_read_b64_tr_b16 v[238:239], v211 offset:43456
  v_mfma_f32_16x16x32_bf16 v[80:83], v[220:223], v[152:155], v[80:83]
  v_mfma_f32_16x16x32_bf16 v[84:87], v[220:223], v[156:159], v[84:87]
  ds_read_b128 v[132:135], v160 offset:23040
  ds_read_b64_tr_b16 v[216:217], v210 offset:41088
  ds_read_b64_tr_b16 v[218:219], v210 offset:43200
  s_waitcnt lgkmcnt(8)
  v_mfma_f32_16x16x32_bf16 v[24:27], v[224:227], v[152:155], v[24:27]
  v_mfma_f32_16x16x32_bf16 v[28:31], v[224:227], v[156:159], v[28:31]
  ds_read_b64_tr_b16 v[220:221], v210 offset:41344
  ds_read_b64_tr_b16 v[222:223], v210 offset:43456
  v_mfma_f32_16x16x32_bf16 v[88:91], v[228:231], v[152:155], v[88:91]
  v_mfma_f32_16x16x32_bf16 v[92:95], v[228:231], v[156:159], v[92:95]
  ds_read_b128 v[136:139], v161 offset:20992
  ds_read_b64_tr_b16 v[224:225], v211 offset:41152
  ds_read_b64_tr_b16 v[226:227], v211 offset:43264
  s_waitcnt lgkmcnt(8)
  v_mfma_f32_16x16x32_bf16 v[32:35], v[232:235], v[152:155], v[32:35]
  v_mfma_f32_16x16x32_bf16 v[36:39], v[232:235], v[156:159], v[36:39]
  ds_read_b64_tr_b16 v[228:229], v211 offset:41408
  ds_read_b64_tr_b16 v[230:231], v211 offset:43520
  v_mfma_f32_16x16x32_bf16 v[96:99], v[236:239], v[152:155], v[96:99]
  v_mfma_f32_16x16x32_bf16 v[100:103], v[236:239], v[156:159], v[100:103]
  ds_read_b128 v[140:143], v161 offset:23040
  ds_read_b64_tr_b16 v[232:233], v210 offset:41152
  ds_read_b64_tr_b16 v[234:235], v210 offset:43264
  s_waitcnt lgkmcnt(8)
  v_mfma_f32_16x16x32_bf16 v[40:43], v[216:219], v[152:155], v[40:43]
  v_mfma_f32_16x16x32_bf16 v[44:47], v[216:219], v[156:159], v[44:47]
  ds_read_b64_tr_b16 v[236:237], v210 offset:41408
  ds_read_b64_tr_b16 v[238:239], v210 offset:43520
  v_mfma_f32_16x16x32_bf16 v[104:107], v[220:223], v[152:155], v[104:107]
  v_mfma_f32_16x16x32_bf16 v[108:111], v[220:223], v[156:159], v[108:111]
  s_barrier
  ds_read_b64_tr_b16 v[216:217], v215 offset:4096
  ds_read_b64_tr_b16 v[218:219], v215 offset:6208
  s_waitcnt lgkmcnt(7)
  v_mfma_f32_16x16x32_bf16 v[48:51], v[224:227], v[152:155], v[48:51]
  v_mfma_f32_16x16x32_bf16 v[52:55], v[224:227], v[156:159], v[52:55]
  ds_read_b64_tr_b16 v[220:221], v215 offset:4352
  ds_read_b64_tr_b16 v[222:223], v215 offset:6464
  v_mfma_f32_16x16x32_bf16 v[112:115], v[228:231], v[152:155], v[112:115]
  v_mfma_f32_16x16x32_bf16 v[116:119], v[228:231], v[156:159], v[116:119]
  ds_read_b64_tr_b16 v[224:225], v214 offset:4096
  ds_read_b64_tr_b16 v[226:227], v214 offset:6208
  s_waitcnt lgkmcnt(6)
  v_mfma_f32_16x16x32_bf16 v[56:59], v[232:235], v[152:155], v[56:59]
  v_mfma_f32_16x16x32_bf16 v[60:63], v[232:235], v[156:159], v[60:63]
  ds_read_b64_tr_b16 v[228:229], v214 offset:4352
  ds_read_b64_tr_b16 v[230:231], v214 offset:6464
  v_mfma_f32_16x16x32_bf16 v[120:123], v[236:239], v[152:155], v[120:123]
  v_mfma_f32_16x16x32_bf16 v[124:127], v[236:239], v[156:159], v[124:127]
  ds_read_b64_tr_b16 v[232:233], v215 offset:4160
  ds_read_b64_tr_b16 v[234:235], v215 offset:6272
  s_waitcnt lgkmcnt(6)
  v_mfma_f32_16x16x32_bf16 v[0:3], v[216:219], v[128:131], v[0:3]
  v_mfma_f32_16x16x32_bf16 v[4:7], v[216:219], v[132:135], v[4:7]
  ds_read_b64_tr_b16 v[236:237], v215 offset:4416
  ds_read_b64_tr_b16 v[238:239], v215 offset:6528
  v_mfma_f32_16x16x32_bf16 v[64:67], v[220:223], v[128:131], v[64:67]
  v_mfma_f32_16x16x32_bf16 v[68:71], v[220:223], v[132:135], v[68:71]
  ds_read_b64_tr_b16 v[216:217], v214 offset:4160
  ds_read_b64_tr_b16 v[218:219], v214 offset:6272
  s_waitcnt lgkmcnt(6)
  v_mfma_f32_16x16x32_bf16 v[8:11], v[224:227], v[128:131], v[8:11]
  v_mfma_f32_16x16x32_bf16 v[12:15], v[224:227], v[132:135], v[12:15]
  ds_read_b64_tr_b16 v[220:221], v214 offset:4416
  ds_read_b64_tr_b16 v[222:223], v214 offset:6528
  v_mfma_f32_16x16x32_bf16 v[72:75], v[228:231], v[128:131], v[72:75]
  v_mfma_f32_16x16x32_bf16 v[76:79], v[228:231], v[132:135], v[76:79]
  ds_read_b64_tr_b16 v[224:225], v215 offset:4224
  ds_read_b64_tr_b16 v[226:227], v215 offset:6336
  s_waitcnt lgkmcnt(6)
  v_mfma_f32_16x16x32_bf16 v[16:19], v[232:235], v[128:131], v[16:19]
  v_mfma_f32_16x16x32_bf16 v[20:23], v[232:235], v[132:135], v[20:23]
  ds_read_b64_tr_b16 v[228:229], v215 offset:4480
  ds_read_b64_tr_b16 v[230:231], v215 offset:6592
  v_mfma_f32_16x16x32_bf16 v[80:83], v[236:239], v[128:131], v[80:83]
  v_mfma_f32_16x16x32_bf16 v[84:87], v[236:239], v[132:135], v[84:87]
  ds_read_b64_tr_b16 v[232:233], v214 offset:4224
  ds_read_b64_tr_b16 v[234:235], v214 offset:6336
  s_waitcnt lgkmcnt(6)
  v_mfma_f32_16x16x32_bf16 v[24:27], v[216:219], v[128:131], v[24:27]
  v_mfma_f32_16x16x32_bf16 v[28:31], v[216:219], v[132:135], v[28:31]
  ds_read_b64_tr_b16 v[236:237], v214 offset:4480
  ds_read_b64_tr_b16 v[238:239], v214 offset:6592
  v_mfma_f32_16x16x32_bf16 v[88:91], v[220:223], v[128:131], v[88:91]
  v_mfma_f32_16x16x32_bf16 v[92:95], v[220:223], v[132:135], v[92:95]
  ds_read_b64_tr_b16 v[216:217], v215 offset:4288
  ds_read_b64_tr_b16 v[218:219], v215 offset:6400
  s_waitcnt lgkmcnt(6)
  v_mfma_f32_16x16x32_bf16 v[32:35], v[224:227], v[128:131], v[32:35]
  v_mfma_f32_16x16x32_bf16 v[36:39], v[224:227], v[132:135], v[36:39]
  ds_read_b64_tr_b16 v[220:221], v215 offset:4544
  ds_read_b64_tr_b16 v[222:223], v215 offset:6656
  v_mfma_f32_16x16x32_bf16 v[96:99], v[228:231], v[128:131], v[96:99]
  v_mfma_f32_16x16x32_bf16 v[100:103], v[228:231], v[132:135], v[100:103]
  ds_read_b64_tr_b16 v[224:225], v214 offset:4288
  ds_read_b64_tr_b16 v[226:227], v214 offset:6400
  s_waitcnt lgkmcnt(6)
  v_mfma_f32_16x16x32_bf16 v[40:43], v[232:235], v[128:131], v[40:43]
  v_mfma_f32_16x16x32_bf16 v[44:47], v[232:235], v[132:135], v[44:47]
  ds_read_b64_tr_b16 v[228:229], v214 offset:4544
  ds_read_b64_tr_b16 v[230:231], v214 offset:6656
  v_mfma_f32_16x16x32_bf16 v[104:107], v[236:239], v[128:131], v[104:107]
  v_mfma_f32_16x16x32_bf16 v[108:111], v[236:239], v[132:135], v[108:111]
  s_barrier
  ds_read_b64_tr_b16 v[232:233], v213 offset:22528
  ds_read_b64_tr_b16 v[234:235], v213 offset:24640
  s_waitcnt lgkmcnt(6)
  v_mfma_f32_16x16x32_bf16 v[48:51], v[216:219], v[128:131], v[48:51]
  v_mfma_f32_16x16x32_bf16 v[52:55], v[216:219], v[132:135], v[52:55]
  ds_read_b64_tr_b16 v[236:237], v213 offset:22784
  ds_read_b64_tr_b16 v[238:239], v213 offset:24896
  v_mfma_f32_16x16x32_bf16 v[112:115], v[220:223], v[128:131], v[112:115]
  v_mfma_f32_16x16x32_bf16 v[116:119], v[220:223], v[132:135], v[116:119]
  ds_read_b64_tr_b16 v[216:217], v212 offset:22528
  ds_read_b64_tr_b16 v[218:219], v212 offset:24640
  s_waitcnt lgkmcnt(6)
  v_mfma_f32_16x16x32_bf16 v[56:59], v[224:227], v[128:131], v[56:59]
  v_mfma_f32_16x16x32_bf16 v[60:63], v[224:227], v[132:135], v[60:63]
  ds_read_b64_tr_b16 v[220:221], v212 offset:22784
  ds_read_b64_tr_b16 v[222:223], v212 offset:24896
  v_mfma_f32_16x16x32_bf16 v[120:123], v[228:231], v[128:131], v[120:123]
  v_mfma_f32_16x16x32_bf16 v[124:127], v[228:231], v[132:135], v[124:127]
  ds_read_b64_tr_b16 v[224:225], v213 offset:22592
  ds_read_b64_tr_b16 v[226:227], v213 offset:24704
  s_waitcnt lgkmcnt(6)
  v_mfma_f32_16x16x32_bf16 v[0:3], v[232:235], v[136:139], v[0:3]
  v_mfma_f32_16x16x32_bf16 v[4:7], v[232:235], v[140:143], v[4:7]
  ds_read_b64_tr_b16 v[228:229], v213 offset:22848
  ds_read_b64_tr_b16 v[230:231], v213 offset:24960
  v_mfma_f32_16x16x32_bf16 v[64:67], v[236:239], v[136:139], v[64:67]
  v_mfma_f32_16x16x32_bf16 v[68:71], v[236:239], v[140:143], v[68:71]
  ds_read_b64_tr_b16 v[232:233], v212 offset:22592
  ds_read_b64_tr_b16 v[234:235], v212 offset:24704
  s_waitcnt lgkmcnt(6)
  v_mfma_f32_16x16x32_bf16 v[8:11], v[216:219], v[136:139], v[8:11]
  v_mfma_f32_16x16x32_bf16 v[12:15], v[216:219], v[140:143], v[12:15]
  ds_read_b64_tr_b16 v[236:237], v212 offset:22848
  ds_read_b64_tr_b16 v[238:239], v212 offset:24960
  v_mfma_f32_16x16x32_bf16 v[72:75], v[220:223], v[136:139], v[72:75]
  v_mfma_f32_16x16x32_bf16 v[76:79], v[220:223], v[140:143], v[76:79]
  ds_read_b128 v[144:147], v160 offset:37888
  ds_read_b64_tr_b16 v[216:217], v213 offset:22656
  ds_read_b64_tr_b16 v[218:219], v213 offset:24768
  s_waitcnt lgkmcnt(7)
  v_mfma_f32_16x16x32_bf16 v[16:19], v[224:227], v[136:139], v[16:19]
  v_mfma_f32_16x16x32_bf16 v[20:23], v[224:227], v[140:143], v[20:23]
  ds_read_b64_tr_b16 v[220:221], v213 offset:22912
  ds_read_b64_tr_b16 v[222:223], v213 offset:25024
  v_mfma_f32_16x16x32_bf16 v[80:83], v[228:231], v[136:139], v[80:83]
  v_mfma_f32_16x16x32_bf16 v[84:87], v[228:231], v[140:143], v[84:87]
  ds_read_b128 v[148:151], v160 offset:39936
  ds_read_b64_tr_b16 v[224:225], v212 offset:22656
  ds_read_b64_tr_b16 v[226:227], v212 offset:24768
  s_waitcnt lgkmcnt(8)
  v_mfma_f32_16x16x32_bf16 v[24:27], v[232:235], v[136:139], v[24:27]
  v_mfma_f32_16x16x32_bf16 v[28:31], v[232:235], v[140:143], v[28:31]
  ds_read_b64_tr_b16 v[228:229], v212 offset:22912
  ds_read_b64_tr_b16 v[230:231], v212 offset:25024
  v_mfma_f32_16x16x32_bf16 v[88:91], v[236:239], v[136:139], v[88:91]
  v_mfma_f32_16x16x32_bf16 v[92:95], v[236:239], v[140:143], v[92:95]
  ds_read_b128 v[152:155], v161 offset:37888
  ds_read_b64_tr_b16 v[232:233], v213 offset:22720
  ds_read_b64_tr_b16 v[234:235], v213 offset:24832
  s_waitcnt lgkmcnt(8)
  v_mfma_f32_16x16x32_bf16 v[32:35], v[216:219], v[136:139], v[32:35]
  v_mfma_f32_16x16x32_bf16 v[36:39], v[216:219], v[140:143], v[36:39]
  ds_read_b64_tr_b16 v[236:237], v213 offset:22976
  ds_read_b64_tr_b16 v[238:239], v213 offset:25088
  v_mfma_f32_16x16x32_bf16 v[96:99], v[220:223], v[136:139], v[96:99]
  v_mfma_f32_16x16x32_bf16 v[100:103], v[220:223], v[140:143], v[100:103]
  ds_read_b128 v[156:159], v161 offset:39936
  ds_read_b64_tr_b16 v[216:217], v212 offset:22720
  ds_read_b64_tr_b16 v[218:219], v212 offset:24832
  s_waitcnt lgkmcnt(8)
  v_mfma_f32_16x16x32_bf16 v[40:43], v[224:227], v[136:139], v[40:43]
  v_mfma_f32_16x16x32_bf16 v[44:47], v[224:227], v[140:143], v[44:47]
  ds_read_b64_tr_b16 v[220:221], v212 offset:22976
  ds_read_b64_tr_b16 v[222:223], v212 offset:25088
  v_mfma_f32_16x16x32_bf16 v[104:107], v[228:231], v[136:139], v[104:107]
  v_mfma_f32_16x16x32_bf16 v[108:111], v[228:231], v[140:143], v[108:111]
  s_barrier
  ds_read_b64_tr_b16 v[224:225], v213 offset:39424
  ds_read_b64_tr_b16 v[226:227], v213 offset:41536
  s_waitcnt lgkmcnt(7)
  v_mfma_f32_16x16x32_bf16 v[48:51], v[232:235], v[136:139], v[48:51]
  v_mfma_f32_16x16x32_bf16 v[52:55], v[232:235], v[140:143], v[52:55]
  ds_read_b64_tr_b16 v[228:229], v213 offset:39680
  ds_read_b64_tr_b16 v[230:231], v213 offset:41792
  v_mfma_f32_16x16x32_bf16 v[112:115], v[236:239], v[136:139], v[112:115]
  v_mfma_f32_16x16x32_bf16 v[116:119], v[236:239], v[140:143], v[116:119]
  ds_read_b64_tr_b16 v[232:233], v212 offset:39424
  ds_read_b64_tr_b16 v[234:235], v212 offset:41536
  s_waitcnt lgkmcnt(6)
  v_mfma_f32_16x16x32_bf16 v[56:59], v[216:219], v[136:139], v[56:59]
  v_mfma_f32_16x16x32_bf16 v[60:63], v[216:219], v[140:143], v[60:63]
  ds_read_b64_tr_b16 v[236:237], v212 offset:39680
  ds_read_b64_tr_b16 v[238:239], v212 offset:41792
  v_mfma_f32_16x16x32_bf16 v[120:123], v[220:223], v[136:139], v[120:123]
  v_mfma_f32_16x16x32_bf16 v[124:127], v[220:223], v[140:143], v[124:127]
  ds_read_b64_tr_b16 v[216:217], v213 offset:39488
  ds_read_b64_tr_b16 v[218:219], v213 offset:41600
  s_waitcnt lgkmcnt(6)
  v_mfma_f32_16x16x32_bf16 v[0:3], v[224:227], v[144:147], v[0:3]
  v_mfma_f32_16x16x32_bf16 v[4:7], v[224:227], v[148:151], v[4:7]
  ds_read_b64_tr_b16 v[220:221], v213 offset:39744
  ds_read_b64_tr_b16 v[222:223], v213 offset:41856
  v_mfma_f32_16x16x32_bf16 v[64:67], v[228:231], v[144:147], v[64:67]
  v_mfma_f32_16x16x32_bf16 v[68:71], v[228:231], v[148:151], v[68:71]
  ds_read_b64_tr_b16 v[224:225], v212 offset:39488
  ds_read_b64_tr_b16 v[226:227], v212 offset:41600
  s_waitcnt lgkmcnt(6)
  v_mfma_f32_16x16x32_bf16 v[8:11], v[232:235], v[144:147], v[8:11]
  v_mfma_f32_16x16x32_bf16 v[12:15], v[232:235], v[148:151], v[12:15]
  ds_read_b64_tr_b16 v[228:229], v212 offset:39744
  ds_read_b64_tr_b16 v[230:231], v212 offset:41856
  v_mfma_f32_16x16x32_bf16 v[72:75], v[236:239], v[144:147], v[72:75]
  v_mfma_f32_16x16x32_bf16 v[76:79], v[236:239], v[148:151], v[76:79]
  ds_read_b64_tr_b16 v[232:233], v213 offset:39552
  ds_read_b64_tr_b16 v[234:235], v213 offset:41664
  s_waitcnt lgkmcnt(6)
  v_mfma_f32_16x16x32_bf16 v[16:19], v[216:219], v[144:147], v[16:19]
  v_mfma_f32_16x16x32_bf16 v[20:23], v[216:219], v[148:151], v[20:23]
  ds_read_b64_tr_b16 v[236:237], v213 offset:39808
  ds_read_b64_tr_b16 v[238:239], v213 offset:41920
  v_mfma_f32_16x16x32_bf16 v[80:83], v[220:223], v[144:147], v[80:83]
  v_mfma_f32_16x16x32_bf16 v[84:87], v[220:223], v[148:151], v[84:87]
  ds_read_b64_tr_b16 v[216:217], v212 offset:39552
  ds_read_b64_tr_b16 v[218:219], v212 offset:41664
  s_waitcnt lgkmcnt(6)
  v_mfma_f32_16x16x32_bf16 v[24:27], v[224:227], v[144:147], v[24:27]
  v_mfma_f32_16x16x32_bf16 v[28:31], v[224:227], v[148:151], v[28:31]
  ds_read_b64_tr_b16 v[220:221], v212 offset:39808
  ds_read_b64_tr_b16 v[222:223], v212 offset:41920
  v_mfma_f32_16x16x32_bf16 v[88:91], v[228:231], v[144:147], v[88:91]
  v_mfma_f32_16x16x32_bf16 v[92:95], v[228:231], v[148:151], v[92:95]
  ds_read_b64_tr_b16 v[224:225], v213 offset:39616
  ds_read_b64_tr_b16 v[226:227], v213 offset:41728
  s_waitcnt lgkmcnt(6)
  v_mfma_f32_16x16x32_bf16 v[32:35], v[232:235], v[144:147], v[32:35]
  v_mfma_f32_16x16x32_bf16 v[36:39], v[232:235], v[148:151], v[36:39]
  ds_read_b64_tr_b16 v[228:229], v213 offset:39872
  ds_read_b64_tr_b16 v[230:231], v213 offset:41984
  v_mfma_f32_16x16x32_bf16 v[96:99], v[236:239], v[144:147], v[96:99]
  v_mfma_f32_16x16x32_bf16 v[100:103], v[236:239], v[148:151], v[100:103]
  ds_read_b64_tr_b16 v[232:233], v212 offset:39616
  ds_read_b64_tr_b16 v[234:235], v212 offset:41728
  s_waitcnt lgkmcnt(6)
  v_mfma_f32_16x16x32_bf16 v[40:43], v[216:219], v[144:147], v[40:43]
  v_mfma_f32_16x16x32_bf16 v[44:47], v[216:219], v[148:151], v[44:47]
  ds_read_b64_tr_b16 v[236:237], v212 offset:39872
  ds_read_b64_tr_b16 v[238:239], v212 offset:41984
  v_mfma_f32_16x16x32_bf16 v[104:107], v[220:223], v[144:147], v[104:107]
  v_mfma_f32_16x16x32_bf16 v[108:111], v[220:223], v[148:151], v[108:111]
  s_barrier
  ds_read_b64_tr_b16 v[216:217], v215 offset:20992
  ds_read_b64_tr_b16 v[218:219], v215 offset:23104
  s_waitcnt lgkmcnt(6)
  v_mfma_f32_16x16x32_bf16 v[48:51], v[224:227], v[144:147], v[48:51]
  v_mfma_f32_16x16x32_bf16 v[52:55], v[224:227], v[148:151], v[52:55]
  ds_read_b64_tr_b16 v[220:221], v215 offset:21248
  ds_read_b64_tr_b16 v[222:223], v215 offset:23360
  v_mfma_f32_16x16x32_bf16 v[112:115], v[228:231], v[144:147], v[112:115]
  v_mfma_f32_16x16x32_bf16 v[116:119], v[228:231], v[148:151], v[116:119]
  ds_read_b64_tr_b16 v[224:225], v214 offset:20992
  ds_read_b64_tr_b16 v[226:227], v214 offset:23104
  s_waitcnt lgkmcnt(6)
  v_mfma_f32_16x16x32_bf16 v[56:59], v[232:235], v[144:147], v[56:59]
  v_mfma_f32_16x16x32_bf16 v[60:63], v[232:235], v[148:151], v[60:63]
  ds_read_b64_tr_b16 v[228:229], v214 offset:21248
  ds_read_b64_tr_b16 v[230:231], v214 offset:23360
  v_mfma_f32_16x16x32_bf16 v[120:123], v[236:239], v[144:147], v[120:123]
  v_mfma_f32_16x16x32_bf16 v[124:127], v[236:239], v[148:151], v[124:127]
  ds_read_b64_tr_b16 v[232:233], v215 offset:21056
  ds_read_b64_tr_b16 v[234:235], v215 offset:23168
  s_waitcnt lgkmcnt(6)
  v_mfma_f32_16x16x32_bf16 v[0:3], v[216:219], v[152:155], v[0:3]
  v_mfma_f32_16x16x32_bf16 v[4:7], v[216:219], v[156:159], v[4:7]
  ds_read_b64_tr_b16 v[236:237], v215 offset:21312
  ds_read_b64_tr_b16 v[238:239], v215 offset:23424
  v_mfma_f32_16x16x32_bf16 v[64:67], v[220:223], v[152:155], v[64:67]
  v_mfma_f32_16x16x32_bf16 v[68:71], v[220:223], v[156:159], v[68:71]
  ds_read_b64_tr_b16 v[216:217], v214 offset:21056
  ds_read_b64_tr_b16 v[218:219], v214 offset:23168
  s_waitcnt lgkmcnt(6)
  v_mfma_f32_16x16x32_bf16 v[8:11], v[224:227], v[152:155], v[8:11]
  v_mfma_f32_16x16x32_bf16 v[12:15], v[224:227], v[156:159], v[12:15]
  ds_read_b64_tr_b16 v[220:221], v214 offset:21312
  ds_read_b64_tr_b16 v[222:223], v214 offset:23424
  v_mfma_f32_16x16x32_bf16 v[72:75], v[228:231], v[152:155], v[72:75]
  v_cvt_pk_bf16_f32 v160, v0, v1
  v_cvt_pk_bf16_f32 v162, v4, v5
  v_mfma_f32_16x16x32_bf16 v[76:79], v[228:231], v[156:159], v[76:79]
  ds_read_b64_tr_b16 v[224:225], v215 offset:21120
  ds_read_b64_tr_b16 v[226:227], v215 offset:23232
  s_waitcnt lgkmcnt(6)
  v_mfma_f32_16x16x32_bf16 v[16:19], v[232:235], v[152:155], v[16:19]
  v_cvt_pk_bf16_f32 v161, v2, v3
  v_mfma_f32_16x16x32_bf16 v[20:23], v[232:235], v[156:159], v[20:23]
  ds_read_b64_tr_b16 v[228:229], v215 offset:21376
  ds_read_b64_tr_b16 v[230:231], v215 offset:23488
  v_mfma_f32_16x16x32_bf16 v[80:83], v[236:239], v[152:155], v[80:83]
  v_cvt_pk_bf16_f32 v163, v6, v7
  v_permlane16_swap_b32 v160, v162
  v_mfma_f32_16x16x32_bf16 v[84:87], v[236:239], v[156:159], v[84:87]
  ds_read_b64_tr_b16 v[232:233], v214 offset:21120
  ds_read_b64_tr_b16 v[234:235], v214 offset:23232
  s_waitcnt lgkmcnt(6)
  v_mfma_f32_16x16x32_bf16 v[24:27], v[216:219], v[152:155], v[24:27]
  v_permlane16_swap_b32 v161, v163
  v_cvt_pk_bf16_f32 v192, v64, v65
  v_mfma_f32_16x16x32_bf16 v[28:31], v[216:219], v[156:159], v[28:31]
  ds_read_b64_tr_b16 v[236:237], v214 offset:21376
  ds_read_b64_tr_b16 v[238:239], v214 offset:23488
  v_mfma_f32_16x16x32_bf16 v[88:91], v[220:223], v[152:155], v[88:91]
  v_cvt_pk_bf16_f32 v194, v68, v69
  v_cvt_pk_bf16_f32 v193, v66, v67
  v_mfma_f32_16x16x32_bf16 v[92:95], v[220:223], v[156:159], v[92:95]
  ds_read_b64_tr_b16 v[216:217], v215 offset:21184
  ds_read_b64_tr_b16 v[218:219], v215 offset:23296
  s_waitcnt lgkmcnt(6)
  v_mfma_f32_16x16x32_bf16 v[32:35], v[224:227], v[152:155], v[32:35]
  v_cvt_pk_bf16_f32 v195, v70, v71
  v_mfma_f32_16x16x32_bf16 v[36:39], v[224:227], v[156:159], v[36:39]
  ds_read_b64_tr_b16 v[220:221], v215 offset:21440
  ds_read_b64_tr_b16 v[222:223], v215 offset:23552
  v_mfma_f32_16x16x32_bf16 v[96:99], v[228:231], v[152:155], v[96:99]
  v_permlane16_swap_b32 v192, v194
  v_permlane16_swap_b32 v193, v195
  v_mfma_f32_16x16x32_bf16 v[100:103], v[228:231], v[156:159], v[100:103]
  ds_read_b64_tr_b16 v[224:225], v214 offset:21184
  ds_read_b64_tr_b16 v[226:227], v214 offset:23296
  s_waitcnt lgkmcnt(6)
  v_mfma_f32_16x16x32_bf16 v[40:43], v[232:235], v[152:155], v[40:43]
  v_cvt_pk_bf16_f32 v164, v8, v9
  v_mfma_f32_16x16x32_bf16 v[44:47], v[232:235], v[156:159], v[44:47]
  ds_read_b64_tr_b16 v[228:229], v214 offset:21440
  ds_read_b64_tr_b16 v[230:231], v214 offset:23552
  v_mfma_f32_16x16x32_bf16 v[104:107], v[236:239], v[152:155], v[104:107]
  v_cvt_pk_bf16_f32 v166, v12, v13
  v_cvt_pk_bf16_f32 v165, v10, v11
  v_mfma_f32_16x16x32_bf16 v[108:111], v[236:239], v[156:159], v[108:111]
  s_waitcnt lgkmcnt(4)
  v_mfma_f32_16x16x32_bf16 v[48:51], v[216:219], v[152:155], v[48:51]
  v_cvt_pk_bf16_f32 v167, v14, v15
  v_permlane16_swap_b32 v164, v166
  s_nop 0
  v_permlane16_swap_b32 v165, v167
  v_cvt_pk_bf16_f32 v196, v72, v73
  v_mfma_f32_16x16x32_bf16 v[52:55], v[216:219], v[156:159], v[52:55]
  s_barrier
  ds_read_b128 v[232:235], v243 offset:24064
  v_mfma_f32_16x16x32_bf16 v[112:115], v[220:223], v[152:155], v[112:115]
  v_cvt_pk_bf16_f32 v198, v76, v77
  v_mfma_f32_16x16x32_bf16 v[116:119], v[220:223], v[156:159], v[116:119]
  ds_read_b128 v[236:239], v243 offset:24320
  s_waitcnt lgkmcnt(2)
  v_mfma_f32_16x16x32_bf16 v[56:59], v[224:227], v[152:155], v[56:59]
  v_cvt_pk_bf16_f32 v197, v74, v75
  v_cvt_pk_bf16_f32 v199, v78, v79
  v_mfma_f32_16x16x32_bf16 v[60:63], v[224:227], v[156:159], v[60:63]
  ds_read_b128 v[224:227], v243 offset:24096
  v_mfma_f32_16x16x32_bf16 v[120:123], v[228:231], v[152:155], v[120:123]
  v_permlane16_swap_b32 v196, v198
  v_permlane16_swap_b32 v197, v199
  v_cvt_pk_bf16_f32 v168, v16, v17
  v_mfma_f32_16x16x32_bf16 v[124:127], v[228:231], v[156:159], v[124:127]
  ds_read_b128 v[228:231], v243 offset:24352
  s_waitcnt lgkmcnt(2)
  v_cvt_pk_bf16_f32 v170, v20, v21
  v_cvt_pk_bf16_f32 v169, v18, v19
  v_cvt_pk_bf16_f32 v171, v22, v23
  v_permlane16_swap_b32 v168, v170
  v_mfma_f32_32x32x16_bf16 v[128:143], v[232:235], v[160:163], 0
  ds_read_b128 v[232:235], v243 offset:24128
L_k:
  v_permlane16_swap_b32 v169, v171
  v_cvt_pk_bf16_f32 v200, v80, v81
  v_cvt_pk_bf16_f32 v202, v84, v85
  v_cvt_pk_bf16_f32 v201, v82, v83
  v_cvt_pk_bf16_f32 v203, v86, v87
  v_mfma_f32_32x32x16_bf16 v[128:143], v[236:239], v[192:195], v[128:143]
  ds_read_b128 v[236:239], v243 offset:24384
  s_waitcnt lgkmcnt(2)
  v_permlane16_swap_b32 v200, v202
  v_permlane16_swap_b32 v201, v203
  v_cvt_pk_bf16_f32 v172, v24, v25
  v_cvt_pk_bf16_f32 v174, v28, v29
  v_cvt_pk_bf16_f32 v173, v26, v27
  v_mfma_f32_32x32x16_bf16 v[128:143], v[224:227], v[164:167], v[128:143]
  ds_read_b128 v[224:227], v243 offset:24160
  v_cvt_pk_bf16_f32 v175, v30, v31
  v_permlane16_swap_b32 v172, v174
  s_nop 0
  v_permlane16_swap_b32 v173, v175
  v_cvt_pk_bf16_f32 v204, v88, v89
  v_cvt_pk_bf16_f32 v206, v92, v93
  v_mfma_f32_32x32x16_bf16 v[128:143], v[228:231], v[196:199], v[128:143]
  ds_read_b128 v[228:231], v243 offset:24416
  s_waitcnt lgkmcnt(2)
  v_cvt_pk_bf16_f32 v205, v90, v91
  v_cvt_pk_bf16_f32 v207, v94, v95
  v_permlane16_swap_b32 v204, v206
  s_nop 0
  v_permlane16_swap_b32 v205, v207
  v_mfma_f32_32x32x16_bf16 v[128:143], v[232:235], v[168:171], v[128:143]
  ds_read_b128 v[232:235], v243 offset:24192
  v_cvt_pk_bf16_f32 v176, v32, v33
  v_cvt_pk_bf16_f32 v178, v36, v37
  v_cvt_pk_bf16_f32 v177, v34, v35
  v_cvt_pk_bf16_f32 v179, v38, v39
  v_permlane16_swap_b32 v176, v178
  v_mfma_f32_32x32x16_bf16 v[128:143], v[236:239], v[200:203], v[128:143]
  ds_read_b128 v[236:239], v243 offset:24448
  s_waitcnt lgkmcnt(2)
  v_permlane16_swap_b32 v177, v179
  v_cvt_pk_bf16_f32 v208, v96, v97
  v_cvt_pk_bf16_f32 v210, v100, v101
  v_cvt_pk_bf16_f32 v209, v98, v99
  v_mfma_f32_32x32x16_bf16 v[128:143], v[224:227], v[172:175], v[128:143]
  ds_read_b128 v[224:227], v243 offset:24224
  v_cvt_pk_bf16_f32 v211, v102, v103
  v_permlane16_swap_b32 v208, v210
  s_nop 0
  v_permlane16_swap_b32 v209, v211
  v_cvt_pk_bf16_f32 v180, v40, v41
  v_cvt_pk_bf16_f32 v182, v44, v45
  v_mfma_f32_32x32x16_bf16 v[128:143], v[228:231], v[204:207], v[128:143]
  ds_read_b128 v[228:231], v243 offset:24480
  s_waitcnt lgkmcnt(2)
  v_cvt_pk_bf16_f32 v181, v42, v43
  v_cvt_pk_bf16_f32 v183, v46, v47
  v_permlane16_swap_b32 v180, v182
  s_nop 0
  v_permlane16_swap_b32 v181, v183
  v_mfma_f32_32x32x16_bf16 v[128:143], v[232:235], v[176:179], v[128:143]
  ds_read_b128 v[232:235], v243 offset:24256
  v_cvt_pk_bf16_f32 v212, v104, v105
  v_cvt_pk_bf16_f32 v214, v108, v109
  v_cvt_pk_bf16_f32 v213, v106, v107
  v_cvt_pk_bf16_f32 v215, v110, v111
  v_permlane16_swap_b32 v212, v214
  v_mfma_f32_32x32x16_bf16 v[128:143], v[236:239], v[208:211], v[128:143]
  ds_read_b128 v[236:239], v243 offset:24512
  s_waitcnt lgkmcnt(2)
  v_permlane16_swap_b32 v213, v215
  v_cvt_pk_bf16_f32 v184, v48, v49
  v_cvt_pk_bf16_f32 v186, v52, v53
  v_cvt_pk_bf16_f32 v185, v50, v51
  v_mfma_f32_32x32x16_bf16 v[128:143], v[224:227], v[180:183], v[128:143]
  ds_read_b128 v[224:227], v243 offset:24288
  v_cvt_pk_bf16_f32 v187, v54, v55
  v_permlane16_swap_b32 v184, v186
  s_nop 0
  v_permlane16_swap_b32 v185, v187
  v_cvt_pk_bf16_f32 v216, v112, v113
  v_cvt_pk_bf16_f32 v218, v116, v117
  v_mfma_f32_32x32x16_bf16 v[128:143], v[228:231], v[212:215], v[128:143]
  ds_read_b128 v[228:231], v243 offset:24544
  s_waitcnt lgkmcnt(2)
  v_cvt_pk_bf16_f32 v217, v114, v115
  v_cvt_pk_bf16_f32 v219, v118, v119
  v_permlane16_swap_b32 v216, v218
  s_nop 0
  v_permlane16_swap_b32 v217, v219
  v_mfma_f32_32x32x16_bf16 v[128:143], v[232:235], v[184:187], v[128:143]
  s_barrier
  ds_read_b128 v[232:235], v243 offset:7168
  v_cvt_pk_bf16_f32 v188, v56, v57
  v_cvt_pk_bf16_f32 v190, v60, v61
  v_cvt_pk_bf16_f32 v189, v58, v59
  v_mfma_f32_32x32x16_bf16 v[128:143], v[236:239], v[216:219], v[128:143]
  ds_read_b128 v[236:239], v243 offset:7424
  s_waitcnt lgkmcnt(2)
  v_cvt_pk_bf16_f32 v191, v62, v63
  v_permlane16_swap_b32 v188, v190
  s_nop 0
  v_permlane16_swap_b32 v189, v191
  v_cvt_pk_bf16_f32 v220, v120, v121
  s_nop 0
  v_mfma_f32_32x32x16_bf16 v[128:143], v[224:227], v[188:191], v[128:143]
  ds_read_b128 v[224:227], v243 offset:7200
  v_cvt_pk_bf16_f32 v222, v124, v125
  v_cvt_pk_bf16_f32 v221, v122, v123
  v_cvt_pk_bf16_f32 v223, v126, v127
  v_permlane16_swap_b32 v220, v222
  s_nop 0
  v_permlane16_swap_b32 v221, v223
  s_nop 1
  v_mfma_f32_32x32x16_bf16 v[128:143], v[228:231], v[220:223], v[128:143]
  ds_read_b128 v[228:231], v243 offset:7456
  s_waitcnt lgkmcnt(2)
  v_mfma_f32_32x32x16_bf16 v[0:15], v[232:235], v[160:163], 0
  ds_read_b128 v[232:235], v243 offset:7232
  v_mfma_f32_32x32x16_bf16 v[0:15], v[236:239], v[192:195], v[0:15]
  ds_read_b128 v[236:239], v243 offset:7488
  s_waitcnt lgkmcnt(2)
  s_nop 4
  v_max_f32 v248, v128, v129
  v_max3_f32 v248, v248, v130, v131
  v_max3_f32 v248, v248, v132, v133
  v_max3_f32 v248, v248, v134, v135
  v_mfma_f32_32x32x16_bf16 v[0:15], v[224:227], v[164:167], v[0:15]
  ds_read_b128 v[224:227], v243 offset:7264
  v_max3_f32 v248, v248, v136, v137
  v_max3_f32 v248, v248, v138, v139
  v_max3_f32 v248, v248, v140, v141
  v_max3_f32 v248, v248, v142, v143
  v_mfma_f32_32x32x16_bf16 v[0:15], v[228:231], v[196:199], v[0:15]
  ds_read_b128 v[228:231], v243 offset:7520
  s_waitcnt lgkmcnt(2)
  v_mfma_f32_32x32x16_bf16 v[0:15], v[232:235], v[168:171], v[0:15]
  ds_read_b128 v[232:235], v243 offset:7296
  v_mfma_f32_32x32x16_bf16 v[0:15], v[236:239], v[200:203], v[0:15]
  ds_read_b128 v[236:239], v243 offset:7552
  s_waitcnt lgkmcnt(2)
  v_mfma_f32_32x32x16_bf16 v[0:15], v[224:227], v[172:175], v[0:15]
  ds_read_b128 v[224:227], v243 offset:7328
  v_mfma_f32_32x32x16_bf16 v[0:15], v[228:231], v[204:207], v[0:15]
  ds_read_b128 v[228:231], v243 offset:7584
  s_waitcnt lgkmcnt(2)
  v_mfma_f32_32x32x16_bf16 v[0:15], v[232:235], v[176:179], v[0:15]
  ds_read_b128 v[232:235], v243 offset:7360
  v_mfma_f32_32x32x16_bf16 v[0:15], v[236:239], v[208:211], v[0:15]
  ds_read_b128 v[236:239], v243 offset:7616
  s_waitcnt lgkmcnt(2)
  v_mfma_f32_32x32x16_bf16 v[0:15], v[224:227], v[180:183], v[0:15]
  ds_read_b128 v[224:227], v243 offset:7392
  v_mfma_f32_32x32x16_bf16 v[0:15], v[228:231], v[212:215], v[0:15]
  ds_read_b128 v[228:231], v243 offset:7648
  s_waitcnt lgkmcnt(2)
  v_mfma_f32_32x32x16_bf16 v[0:15], v[232:235], v[184:187], v[0:15]
  s_barrier
  ds_read_b128 v[232:235], v242 offset:5632
  v_mfma_f32_32x32x16_bf16 v[0:15], v[236:239], v[216:219], v[0:15]
  ds_read_b128 v[236:239], v242 offset:5888
  s_waitcnt lgkmcnt(2)
  v_mfma_f32_32x32x16_bf16 v[0:15], v[224:227], v[188:191], v[0:15]
  ds_read_b128 v[224:227], v242 offset:5664
  v_mfma_f32_32x32x16_bf16 v[0:15], v[228:231], v[220:223], v[0:15]
  ds_read_b128 v[228:231], v242 offset:5920
  s_waitcnt lgkmcnt(2)
  v_mfma_f32_32x32x16_bf16 v[16:31], v[232:235], v[160:163], 0
  ds_read_b128 v[232:235], v242 offset:5696
  v_mfma_f32_32x32x16_bf16 v[16:31], v[236:239], v[192:195], v[16:31]
  ds_read_b128 v[236:239], v242 offset:5952
  s_waitcnt lgkmcnt(2)
  s_nop 4
  v_max3_f32 v248, v248, v0, v1
  v_max3_f32 v248, v248, v2, v3
  v_max3_f32 v248, v248, v4, v5
  v_max3_f32 v248, v248, v6, v7
  v_mfma_f32_32x32x16_bf16 v[16:31], v[224:227], v[164:167], v[16:31]
  ds_read_b128 v[224:227], v242 offset:5728
  v_max3_f32 v248, v248, v8, v9
  v_max3_f32 v248, v248, v10, v11
  v_max3_f32 v248, v248, v12, v13
  v_max3_f32 v248, v248, v14, v15
  v_mfma_f32_32x32x16_bf16 v[16:31], v[228:231], v[196:199], v[16:31]
  ds_read_b128 v[228:231], v242 offset:5984
  s_waitcnt lgkmcnt(2)
  v_mfma_f32_32x32x16_bf16 v[16:31], v[232:235], v[168:171], v[16:31]
  ds_read_b128 v[232:235], v242 offset:5760
  v_mfma_f32_32x32x16_bf16 v[16:31], v[236:239], v[200:203], v[16:31]
  ds_read_b128 v[236:239], v242 offset:6016
  s_waitcnt lgkmcnt(2)
  v_mfma_f32_32x32x16_bf16 v[16:31], v[224:227], v[172:175], v[16:31]
  ds_read_b128 v[224:227], v242 offset:5792
  v_mfma_f32_32x32x16_bf16 v[16:31], v[228:231], v[204:207], v[16:31]
  ds_read_b128 v[228:231], v242 offset:6048
  s_waitcnt lgkmcnt(2)
  v_mfma_f32_32x32x16_bf16 v[16:31], v[232:235], v[176:179], v[16:31]
  ds_read_b128 v[232:235], v242 offset:5824
  v_mfma_f32_32x32x16_bf16 v[16:31], v[236:239], v[208:211], v[16:31]
  ds_read_b128 v[236:239], v242 offset:6080
  s_waitcnt lgkmcnt(2)
  v_mfma_f32_32x32x16_bf16 v[16:31], v[224:227], v[180:183], v[16:31]
  ds_read_b128 v[224:227], v242 offset:5856
  v_mfma_f32_32x32x16_bf16 v[16:31], v[228:231], v[212:215], v[16:31]
  ds_read_b128 v[228:231], v242 offset:6112
  s_waitcnt lgkmcnt(2)
  v_mfma_f32_32x32x16_bf16 v[16:31], v[232:235], v[184:187], v[16:31]
  s_barrier
  ds_read_b128 v[232:235], v243 offset:40960
  v_mfma_f32_32x32x16_bf16 v[16:31], v[236:239], v[216:219], v[16:31]
  ds_read_b128 v[236:239], v243 offset:41216
  s_waitcnt lgkmcnt(2)
  v_mfma_f32_32x32x16_bf16 v[16:31], v[224:227], v[188:191], v[16:31]
  ds_read_b128 v[224:227], v243 offset:40992
  v_mfma_f32_32x32x16_bf16 v[16:31], v[228:231], v[220:223], v[16:31]
  ds_read_b128 v[228:231], v243 offset:41248
  s_waitcnt lgkmcnt(2)
  v_mfma_f32_32x32x16_bf16 v[32:47], v[232:235], v[160:163], 0
  ds_read_b128 v[232:235], v243 offset:41024
  v_mfma_f32_32x32x16_bf16 v[32:47], v[236:239], v[192:195], v[32:47]
  ds_read_b128 v[236:239], v243 offset:41280
  s_waitcnt lgkmcnt(2)
  s_nop 4
  v_max3_f32 v248, v248, v16, v17
  v_max3_f32 v248, v248, v18, v19
  v_max3_f32 v248, v248, v20, v21
  v_max3_f32 v248, v248, v22, v23
  v_max3_f32 v248, v248, v24, v25
  v_mfma_f32_32x32x16_bf16 v[32:47], v[224:227], v[164:167], v[32:47]
  ds_read_b128 v[224:227], v243 offset:41056
  v_max3_f32 v248, v248, v26, v27
  v_max3_f32 v248, v248, v28, v29
  v_max3_f32 v248, v248, v30, v31
  v_mfma_f32_32x32x16_bf16 v[32:47], v[228:231], v[196:199], v[32:47]
  ds_read_b128 v[228:231], v243 offset:41312
  s_waitcnt lgkmcnt(2)
  v_mfma_f32_32x32x16_bf16 v[32:47], v[232:235], v[168:171], v[32:47]
  ds_read_b128 v[232:235], v243 offset:41088
  v_mfma_f32_32x32x16_bf16 v[32:47], v[236:239], v[200:203], v[32:47]
  ds_read_b128 v[236:239], v243 offset:41344
  s_waitcnt lgkmcnt(2)
  v_mfma_f32_32x32x16_bf16 v[32:47], v[224:227], v[172:175], v[32:47]
  ds_read_b128 v[224:227], v243 offset:41120
  v_mfma_f32_32x32x16_bf16 v[32:47], v[228:231], v[204:207], v[32:47]
  ds_read_b128 v[228:231], v243 offset:41376
  s_waitcnt lgkmcnt(2)
  v_mfma_f32_32x32x16_bf16 v[32:47], v[232:235], v[176:179], v[32:47]
  ds_read_b128 v[232:235], v243 offset:41152
  v_mfma_f32_32x32x16_bf16 v[32:47], v[236:239], v[208:211], v[32:47]
  ds_read_b128 v[236:239], v243 offset:41408
  s_waitcnt lgkmcnt(2)
  v_mfma_f32_32x32x16_bf16 v[32:47], v[224:227], v[180:183], v[32:47]
  ds_read_b128 v[224:227], v243 offset:41184
  v_mfma_f32_32x32x16_bf16 v[32:47], v[228:231], v[212:215], v[32:47]
  ds_read_b128 v[228:231], v243 offset:41440
  s_waitcnt lgkmcnt(2)
  v_mfma_f32_32x32x16_bf16 v[32:47], v[232:235], v[184:187], v[32:47]
  s_barrier
  ds_read_b128 v[232:235], v240 offset:4096
  v_mfma_f32_32x32x16_bf16 v[32:47], v[236:239], v[216:219], v[32:47]
  ds_read_b128 v[236:239], v240 offset:4352
  s_waitcnt lgkmcnt(2)
  v_mfma_f32_32x32x16_bf16 v[32:47], v[224:227], v[188:191], v[32:47]
  ds_read_b128 v[224:227], v240 offset:4128
  v_mfma_f32_32x32x16_bf16 v[32:47], v[228:231], v[220:223], v[32:47]
  ds_read_b128 v[228:231], v240 offset:4384
  s_waitcnt lgkmcnt(2)
  v_mfma_f32_32x32x16_bf16 v[48:63], v[232:235], v[160:163], 0
  ds_read_b128 v[232:235], v240 offset:4160
  v_mfma_f32_32x32x16_bf16 v[48:63], v[236:239], v[192:195], v[48:63]
  ds_read_b128 v[236:239], v240 offset:4416
  s_waitcnt lgkmcnt(2)
  s_nop 4
  v_max3_f32 v248, v248, v32, v33
  v_max3_f32 v248, v248, v34, v35
  v_max3_f32 v248, v248, v36, v37
  v_max3_f32 v248, v248, v38, v39
  v_max3_f32 v248, v248, v40, v41
  v_mfma_f32_32x32x16_bf16 v[48:63], v[224:227], v[164:167], v[48:63]
  ds_read_b128 v[224:227], v240 offset:4192
  v_max3_f32 v248, v248, v42, v43
  v_max3_f32 v248, v248, v44, v45
  v_max3_f32 v248, v248, v46, v47
  v_mov_b32 v247, v248
  s_nop 1
  v_permlane32_swap_b32 v247, v248
  v_max_f32 v247, v247, v248
  v_mfma_f32_32x32x16_bf16 v[48:63], v[228:231], v[196:199], v[48:63]
  ds_read_b128 v[228:231], v240 offset:4448
  s_waitcnt lgkmcnt(2)
  v_mul_f32 v246, s41, v247
  v_mov_b32 v244, v247
  v_mov_b32 v245, 0
  v_fma_f32 v128, v128, s40, v246
  v_fma_f32 v129, v129, s40, v246
  v_mfma_f32_32x32x16_bf16 v[48:63], v[232:235], v[168:171], v[48:63]
  ds_read_b128 v[232:235], v240 offset:4224
  v_exp_f32 v128, v128
  v_fma_f32 v130, v130, s40, v246
  v_exp_f32 v129, v129
  v_fma_f32 v131, v131, s40, v246
  v_mfma_f32_32x32x16_bf16 v[48:63], v[236:239], v[200:203], v[48:63]
  ds_read_b128 v[236:239], v240 offset:4480
  s_waitcnt lgkmcnt(2)
  v_exp_f32 v130, v130
  v_fma_f32 v132, v132, s40, v246
  v_exp_f32 v131, v131
  v_mfma_f32_32x32x16_bf16 v[48:63], v[224:227], v[172:175], v[48:63]
  ds_read_b128 v[224:227], v240 offset:4256
  v_fma_f32 v133, v133, s40, v246
  v_add_f32 v245, v245, v128
  v_add_f32 v245, v245, v129
  v_cvt_pk_bf16_f32 v128, v128, v129
  v_exp_f32 v132, v132
  v_mfma_f32_32x32x16_bf16 v[48:63], v[228:231], v[204:207], v[48:63]
  ds_read_b128 v[228:231], v240 offset:4512
  s_waitcnt lgkmcnt(2)
  v_fma_f32 v134, v134, s40, v246
  v_exp_f32 v133, v133
  v_fma_f32 v135, v135, s40, v246
  v_add_f32 v245, v245, v130
  v_add_f32 v245, v245, v131
  v_mfma_f32_32x32x16_bf16 v[48:63], v[232:235], v[176:179], v[48:63]
  ds_read_b128 v[232:235], v240 offset:4288
  v_cvt_pk_bf16_f32 v129, v130, v131
  v_exp_f32 v134, v134
  v_fma_f32 v136, v136, s40, v246
  v_exp_f32 v135, v135
  v_mfma_f32_32x32x16_bf16 v[48:63], v[236:239], v[208:211], v[48:63]
  ds_read_b128 v[236:239], v240 offset:4544
  s_waitcnt lgkmcnt(2)
  v_fma_f32 v137, v137, s40, v246
  v_add_f32 v245, v245, v132
  v_add_f32 v245, v245, v133
  v_cvt_pk_bf16_f32 v130, v132, v133
  v_mfma_f32_32x32x16_bf16 v[48:63], v[224:227], v[180:183], v[48:63]
  ds_read_b128 v[224:227], v240 offset:4320
  v_exp_f32 v136, v136
  v_fma_f32 v138, v138, s40, v246
  v_exp_f32 v137, v137
  v_fma_f32 v139, v139, s40, v246
  v_mfma_f32_32x32x16_bf16 v[48:63], v[228:231], v[212:215], v[48:63]
  ds_read_b128 v[228:231], v240 offset:4576
  s_waitcnt lgkmcnt(2)
  v_add_f32 v245, v245, v134
  v_add_f32 v245, v245, v135
  v_cvt_pk_bf16_f32 v131, v134, v135
  v_exp_f32 v138, v138
  v_mfma_f32_32x32x16_bf16 v[48:63], v[232:235], v[184:187], v[48:63]
  s_barrier
  ds_read_b128 v[232:235], v240 offset:37888
  v_fma_f32 v140, v140, s40, v246
  v_exp_f32 v139, v139
  v_fma_f32 v141, v141, s40, v246
  v_add_f32 v245, v245, v136
  v_mfma_f32_32x32x16_bf16 v[48:63], v[236:239], v[216:219], v[48:63]
  ds_read_b128 v[236:239], v240 offset:38144
  s_waitcnt lgkmcnt(2)
  v_add_f32 v245, v245, v137
  v_cvt_pk_bf16_f32 v132, v136, v137
  v_exp_f32 v140, v140
  v_fma_f32 v142, v142, s40, v246
  v_mfma_f32_32x32x16_bf16 v[48:63], v[224:227], v[188:191], v[48:63]
  ds_read_b128 v[224:227], v240 offset:37920
  v_exp_f32 v141, v141
  v_fma_f32 v143, v143, s40, v246
  v_add_f32 v245, v245, v138
  v_add_f32 v245, v245, v139
  v_cvt_pk_bf16_f32 v133, v138, v139
  v_mfma_f32_32x32x16_bf16 v[48:63], v[228:231], v[220:223], v[48:63]
  ds_read_b128 v[228:231], v240 offset:38176
  s_waitcnt lgkmcnt(2)
  v_exp_f32 v142, v142
  v_exp_f32 v143, v143
  v_add_f32 v245, v245, v140
  v_mfma_f32_32x32x16_bf16 v[64:79], v[232:235], v[160:163], 0
  ds_read_b128 v[232:235], v240 offset:37952
  v_add_f32 v245, v245, v141
  v_cvt_pk_bf16_f32 v134, v140, v141
  v_add_f32 v245, v245, v142
  v_add_f32 v245, v245, v143
  v_cvt_pk_bf16_f32 v135, v142, v143
  v_fma_f32 v0, v0, s40, v246
  v_mfma_f32_32x32x16_bf16 v[64:79], v[236:239], v[192:195], v[64:79]
  ds_read_b128 v[236:239], v240 offset:38208
  s_waitcnt lgkmcnt(2)
  v_max3_f32 v248, v244, v48, v49
  v_max3_f32 v248, v248, v50, v51
  v_max3_f32 v248, v248, v52, v53
  v_max3_f32 v248, v248, v54, v55
  v_max3_f32 v248, v248, v56, v57
  v_max3_f32 v248, v248, v58, v59
  v_mfma_f32_32x32x16_bf16 v[64:79], v[224:227], v[164:167], v[64:79]
  ds_read_b128 v[224:227], v240 offset:37984
  v_max3_f32 v248, v248, v60, v61
  v_max3_f32 v248, v248, v62, v63
  v_fma_f32 v1, v1, s40, v246
  v_exp_f32 v0, v0
  v_fma_f32 v2, v2, s40, v246
  v_mfma_f32_32x32x16_bf16 v[64:79], v[228:231], v[196:199], v[64:79]
  ds_read_b128 v[228:231], v240 offset:38240
  s_waitcnt lgkmcnt(2)
  v_exp_f32 v1, v1
  v_fma_f32 v3, v3, s40, v246
  v_exp_f32 v2, v2
  v_mfma_f32_32x32x16_bf16 v[64:79], v[232:235], v[168:171], v[64:79]
  ds_read_b128 v[232:235], v240 offset:38016
  v_fma_f32 v4, v4, s40, v246
  v_exp_f32 v3, v3
  v_fma_f32 v5, v5, s40, v246
  v_add_f32 v245, v245, v0
  v_cvt_pk_bf16_f32 v136, v0, v1
  v_mfma_f32_32x32x16_bf16 v[64:79], v[236:239], v[200:203], v[64:79]
  ds_read_b128 v[236:239], v240 offset:38272
  s_waitcnt lgkmcnt(2)
  v_add_f32 v245, v245, v1
  v_exp_f32 v4, v4
  v_fma_f32 v6, v6, s40, v246
  v_exp_f32 v5, v5
  v_mfma_f32_32x32x16_bf16 v[64:79], v[224:227], v[172:175], v[64:79]
  ds_read_b128 v[224:227], v240 offset:38048
  v_fma_f32 v7, v7, s40, v246
  v_add_f32 v245, v245, v2
  v_cvt_pk_bf16_f32 v137, v2, v3
  v_add_f32 v245, v245, v3
  v_exp_f32 v6, v6
  v_mfma_f32_32x32x16_bf16 v[64:79], v[228:231], v[204:207], v[64:79]
  ds_read_b128 v[228:231], v240 offset:38304
  s_waitcnt lgkmcnt(2)
  v_fma_f32 v8, v8, s40, v246
  v_exp_f32 v7, v7
  v_fma_f32 v9, v9, s40, v246
  v_add_f32 v245, v245, v4
  v_mfma_f32_32x32x16_bf16 v[64:79], v[232:235], v[176:179], v[64:79]
  ds_read_b128 v[232:235], v240 offset:38080
  v_cvt_pk_bf16_f32 v138, v4, v5
  v_add_f32 v245, v245, v5
  v_exp_f32 v8, v8
  v_fma_f32 v10, v10, s40, v246
  v_mfma_f32_32x32x16_bf16 v[64:79], v[236:239], v[208:211], v[64:79]
  ds_read_b128 v[236:239], v240 offset:38336
  s_waitcnt lgkmcnt(2)
  v_exp_f32 v9, v9
  v_fma_f32 v11, v11, s40, v246
  v_add_f32 v245, v245, v6
  v_cvt_pk_bf16_f32 v139, v6, v7
  v_mfma_f32_32x32x16_bf16 v[64:79], v[224:227], v[180:183], v[64:79]
  ds_read_b128 v[224:227], v240 offset:38112
  v_add_f32 v245, v245, v7
  v_exp_f32 v10, v10
  v_fma_f32 v12, v12, s40, v246
  v_exp_f32 v11, v11
  v_fma_f32 v13, v13, s40, v246
  v_mfma_f32_32x32x16_bf16 v[64:79], v[228:231], v[212:215], v[64:79]
  ds_read_b128 v[228:231], v240 offset:38368
  s_waitcnt lgkmcnt(2)
  v_add_f32 v245, v245, v8
  v_cvt_pk_bf16_f32 v140, v8, v9
  v_add_f32 v245, v245, v9
  v_exp_f32 v12, v12
  v_mfma_f32_32x32x16_bf16 v[64:79], v[232:235], v[184:187], v[64:79]
  s_barrier
  ds_read_b128 v[232:235], v242 offset:22528
  v_fma_f32 v14, v14, s40, v246
  v_exp_f32 v13, v13
  v_fma_f32 v15, v15, s40, v246
  v_mfma_f32_32x32x16_bf16 v[64:79], v[236:239], v[216:219], v[64:79]
  ds_read_b128 v[236:239], v242 offset:22784
  s_waitcnt lgkmcnt(2)
  v_add_f32 v245, v245, v10
  v_cvt_pk_bf16_f32 v141, v10, v11
  v_add_f32 v245, v245, v11
  v_exp_f32 v14, v14
  v_mfma_f32_32x32x16_bf16 v[64:79], v[224:227], v[188:191], v[64:79]
  ds_read_b128 v[224:227], v242 offset:22560
  v_exp_f32 v15, v15
  v_add_f32 v245, v245, v12
  v_cvt_pk_bf16_f32 v142, v12, v13
  v_add_f32 v245, v245, v13
  v_add_f32 v245, v245, v14
  v_cvt_pk_bf16_f32 v143, v14, v15
  v_mfma_f32_32x32x16_bf16 v[64:79], v[228:231], v[220:223], v[64:79]
  ds_read_b128 v[228:231], v242 offset:22816
  s_waitcnt lgkmcnt(2)
  v_add_f32 v245, v245, v15
  v_fma_f32 v16, v16, s40, v246
  v_fma_f32 v17, v17, s40, v246
  v_exp_f32 v16, v16
  v_mfma_f32_32x32x16_bf16 v[80:95], v[232:235], v[160:163], 0
  ds_read_b128 v[232:235], v242 offset:22592
  v_fma_f32 v18, v18, s40, v246
  v_exp_f32 v17, v17
  v_fma_f32 v19, v19, s40, v246
  v_exp_f32 v18, v18
  v_mfma_f32_32x32x16_bf16 v[80:95], v[236:239], v[192:195], v[80:95]
  ds_read_b128 v[236:239], v242 offset:22848
  s_waitcnt lgkmcnt(2)
  v_max3_f32 v248, v248, v64, v65
  v_max3_f32 v248, v248, v66, v67
  v_max3_f32 v248, v248, v68, v69
  v_max3_f32 v248, v248, v70, v71
  v_max3_f32 v248, v248, v72, v73
  v_mfma_f32_32x32x16_bf16 v[80:95], v[224:227], v[164:167], v[80:95]
  ds_read_b128 v[224:227], v242 offset:22624
  v_max3_f32 v248, v248, v74, v75
  v_max3_f32 v248, v248, v76, v77
  v_max3_f32 v248, v248, v78, v79
  v_fma_f32 v20, v20, s40, v246
  v_exp_f32 v19, v19
  v_mfma_f32_32x32x16_bf16 v[80:95], v[228:231], v[196:199], v[80:95]
  ds_read_b128 v[228:231], v242 offset:22880
  s_waitcnt lgkmcnt(2)
  v_fma_f32 v21, v21, s40, v246
  v_add_f32 v245, v245, v16
  v_add_f32 v245, v245, v17
  v_cvt_pk_bf16_f32 v16, v16, v17
  v_exp_f32 v20, v20
  v_mfma_f32_32x32x16_bf16 v[80:95], v[232:235], v[168:171], v[80:95]
  ds_read_b128 v[232:235], v242 offset:22656
  v_fma_f32 v22, v22, s40, v246
  v_exp_f32 v21, v21
  v_fma_f32 v23, v23, s40, v246
  v_add_f32 v245, v245, v18
  v_add_f32 v245, v245, v19
  v_mfma_f32_32x32x16_bf16 v[80:95], v[236:239], v[200:203], v[80:95]
  ds_read_b128 v[236:239], v242 offset:22912
  s_waitcnt lgkmcnt(2)
  v_cvt_pk_bf16_f32 v17, v18, v19
  v_exp_f32 v22, v22
  v_fma_f32 v24, v24, s40, v246
  v_mfma_f32_32x32x16_bf16 v[80:95], v[224:227], v[172:175], v[80:95]
  ds_read_b128 v[224:227], v242 offset:22688
  v_exp_f32 v23, v23
  v_fma_f32 v25, v25, s40, v246
  v_add_f32 v245, v245, v20
  v_add_f32 v245, v245, v21
  v_cvt_pk_bf16_f32 v18, v20, v21
  v_mfma_f32_32x32x16_bf16 v[80:95], v[228:231], v[204:207], v[80:95]
  ds_read_b128 v[228:231], v242 offset:22944
  s_waitcnt lgkmcnt(2)
  v_exp_f32 v24, v24
  v_fma_f32 v26, v26, s40, v246
  v_exp_f32 v25, v25
  v_fma_f32 v27, v27, s40, v246
  v_mfma_f32_32x32x16_bf16 v[80:95], v[232:235], v[176:179], v[80:95]
  ds_read_b128 v[232:235], v242 offset:22720
  v_add_f32 v245, v245, v22
  v_add_f32 v245, v245, v23
  v_cvt_pk_bf16_f32 v19, v22, v23
  v_exp_f32 v26, v26
  v_fma_f32 v28, v28, s40, v246
  v_mfma_f32_32x32x16_bf16 v[80:95], v[236:239], v[208:211], v[80:95]
  ds_read_b128 v[236:239], v242 offset:22976
  s_waitcnt lgkmcnt(2)
  v_exp_f32 v27, v27
  v_fma_f32 v29, v29, s40, v246
  v_add_f32 v245, v245, v24
  v_add_f32 v245, v245, v25
  v_mfma_f32_32x32x16_bf16 v[80:95], v[224:227], v[180:183], v[80:95]
  ds_read_b128 v[224:227], v242 offset:22752
  v_cvt_pk_bf16_f32 v20, v24, v25
  v_exp_f32 v28, v28
  v_fma_f32 v30, v30, s40, v246
  v_exp_f32 v29, v29
  v_mfma_f32_32x32x16_bf16 v[80:95], v[228:231], v[212:215], v[80:95]
  ds_read_b128 v[228:231], v242 offset:23008
  s_waitcnt lgkmcnt(2)
  v_fma_f32 v31, v31, s40, v246
  v_add_f32 v245, v245, v26
  v_add_f32 v245, v245, v27
  v_cvt_pk_bf16_f32 v21, v26, v27
  v_mfma_f32_32x32x16_bf16 v[80:95], v[232:235], v[184:187], v[80:95]
  s_barrier
  ds_read_b128 v[232:235], v242 offset:39424
  v_exp_f32 v30, v30
  v_exp_f32 v31, v31
  v_add_f32 v245, v245, v28
  v_mfma_f32_32x32x16_bf16 v[80:95], v[236:239], v[216:219], v[80:95]
  ds_read_b128 v[236:239], v242 offset:39680
  s_waitcnt lgkmcnt(2)
  v_add_f32 v245, v245, v29
  v_cvt_pk_bf16_f32 v22, v28, v29
  v_add_f32 v245, v245, v30
  v_add_f32 v245, v245, v31
  v_cvt_pk_bf16_f32 v23, v30, v31
  v_mfma_f32_32x32x16_bf16 v[80:95], v[224:227], v[188:191], v[80:95]
  ds_read_b128 v[224:227], v242 offset:39456
  v_fma_f32 v32, v32, s40, v246
  v_fma_f32 v33, v33, s40, v246
  v_exp_f32 v32, v32
  v_fma_f32 v34, v34, s40, v246
  v_mfma_f32_32x32x16_bf16 v[80:95], v[228:231], v[220:223], v[80:95]
  ds_read_b128 v[228:231], v242 offset:39712
  s_waitcnt lgkmcnt(2)
  v_exp_f32 v33, v33
  v_fma_f32 v35, v35, s40, v246
  v_exp_f32 v34, v34
  v_mfma_f32_32x32x16_bf16 v[96:111], v[232:235], v[160:163], 0
  ds_read_b128 v[232:235], v242 offset:39488
  v_fma_f32 v36, v36, s40, v246
  v_exp_f32 v35, v35
  v_fma_f32 v37, v37, s40, v246
  v_add_f32 v245, v245, v32
  v_cvt_pk_bf16_f32 v24, v32, v33
  v_add_f32 v245, v245, v33
  v_mfma_f32_32x32x16_bf16 v[96:111], v[236:239], v[192:195], v[96:111]
  ds_read_b128 v[236:239], v242 offset:39744
  s_waitcnt lgkmcnt(2)
  v_max3_f32 v248, v248, v80, v81
  v_max3_f32 v248, v248, v82, v83
  v_max3_f32 v248, v248, v84, v85
  v_max3_f32 v248, v248, v86, v87
  v_max3_f32 v248, v248, v88, v89
  v_mfma_f32_32x32x16_bf16 v[96:111], v[224:227], v[164:167], v[96:111]
  ds_read_b128 v[224:227], v242 offset:39520
  v_max3_f32 v248, v248, v90, v91
  v_max3_f32 v248, v248, v92, v93
  v_max3_f32 v248, v248, v94, v95
  v_exp_f32 v36, v36
  v_fma_f32 v38, v38, s40, v246
  v_mfma_f32_32x32x16_bf16 v[96:111], v[228:231], v[196:199], v[96:111]
  ds_read_b128 v[228:231], v242 offset:39776
  s_waitcnt lgkmcnt(2)
  v_exp_f32 v37, v37
  v_fma_f32 v39, v39, s40, v246
  v_add_f32 v245, v245, v34
  v_cvt_pk_bf16_f32 v25, v34, v35
  v_mfma_f32_32x32x16_bf16 v[96:111], v[232:235], v[168:171], v[96:111]
  ds_read_b128 v[232:235], v242 offset:39552
  v_add_f32 v245, v245, v35
  v_exp_f32 v38, v38
  v_fma_f32 v40, v40, s40, v246
  v_exp_f32 v39, v39
  v_fma_f32 v41, v41, s40, v246
  v_mfma_f32_32x32x16_bf16 v[96:111], v[236:239], v[200:203], v[96:111]
  ds_read_b128 v[236:239], v242 offset:39808
  s_waitcnt lgkmcnt(2)
  v_add_f32 v245, v245, v36
  v_cvt_pk_bf16_f32 v26, v36, v37
  v_add_f32 v245, v245, v37
  v_exp_f32 v40, v40
  v_mfma_f32_32x32x16_bf16 v[96:111], v[224:227], v[172:175], v[96:111]
  ds_read_b128 v[224:227], v242 offset:39584
  v_fma_f32 v42, v42, s40, v246
  v_exp_f32 v41, v41
  v_fma_f32 v43, v43, s40, v246
  v_add_f32 v245, v245, v38
  v_cvt_pk_bf16_f32 v27, v38, v39
  v_mfma_f32_32x32x16_bf16 v[96:111], v[228:231], v[204:207], v[96:111]
  ds_read_b128 v[228:231], v242 offset:39840
  s_waitcnt lgkmcnt(2)
  v_add_f32 v245, v245, v39
  v_exp_f32 v42, v42
  v_fma_f32 v44, v44, s40, v246
  v_mfma_f32_32x32x16_bf16 v[96:111], v[232:235], v[176:179], v[96:111]
  ds_read_b128 v[232:235], v242 offset:39616
  v_exp_f32 v43, v43
  v_fma_f32 v45, v45, s40, v246
  v_add_f32 v245, v245, v40
  v_cvt_pk_bf16_f32 v28, v40, v41
  v_add_f32 v245, v245, v41
  v_mfma_f32_32x32x16_bf16 v[96:111], v[236:239], v[208:211], v[96:111]
  ds_read_b128 v[236:239], v242 offset:39872
  s_waitcnt lgkmcnt(2)
  v_exp_f32 v44, v44
  v_fma_f32 v46, v46, s40, v246
  v_exp_f32 v45, v45
  v_mfma_f32_32x32x16_bf16 v[96:111], v[224:227], v[180:183], v[96:111]
  ds_read_b128 v[224:227], v242 offset:39648
  v_fma_f32 v47, v47, s40, v246
  v_add_f32 v245, v245, v42
  v_cvt_pk_bf16_f32 v29, v42, v43
  v_add_f32 v245, v245, v43
  v_exp_f32 v46, v46
  v_mfma_f32_32x32x16_bf16 v[96:111], v[228:231], v[212:215], v[96:111]
  ds_read_b128 v[228:231], v242 offset:39904
  s_waitcnt lgkmcnt(2)
  v_exp_f32 v47, v47
  v_add_f32 v245, v245, v44
  v_cvt_pk_bf16_f32 v30, v44, v45
  v_add_f32 v245, v245, v45
  v_mfma_f32_32x32x16_bf16 v[96:111], v[232:235], v[184:187], v[96:111]
  s_barrier
  ds_read_b128 v[232:235], v240 offset:20992
  v_add_f32 v245, v245, v46
  v_cvt_pk_bf16_f32 v31, v46, v47
  v_add_f32 v245, v245, v47
  v_mfma_f32_32x32x16_bf16 v[96:111], v[236:239], v[216:219], v[96:111]
  ds_read_b128 v[236:239], v240 offset:21248
  s_waitcnt lgkmcnt(2)
  v_mfma_f32_32x32x16_bf16 v[96:111], v[224:227], v[188:191], v[96:111]
  ds_read_b128 v[224:227], v240 offset:21024
  v_mfma_f32_32x32x16_bf16 v[96:111], v[228:231], v[220:223], v[96:111]
  ds_read_b128 v[228:231], v240 offset:21280
  s_waitcnt lgkmcnt(2)
  v_mfma_f32_32x32x16_bf16 v[112:127], v[232:235], v[160:163], 0
  ds_read_b128 v[232:235], v240 offset:21056
  v_mfma_f32_32x32x16_bf16 v[112:127], v[236:239], v[192:195], v[112:127]
  ds_read_b128 v[236:239], v240 offset:21312
  s_waitcnt lgkmcnt(2)
  s_nop 4
  v_max3_f32 v248, v248, v96, v97
  v_max3_f32 v248, v248, v98, v99
  v_max3_f32 v248, v248, v100, v101
  v_max3_f32 v248, v248, v102, v103
  v_max3_f32 v248, v248, v104, v105
  v_max3_f32 v248, v248, v106, v107
  v_mfma_f32_32x32x16_bf16 v[112:127], v[224:227], v[164:167], v[112:127]
  ds_read_b128 v[224:227], v240 offset:21088
  v_max3_f32 v248, v248, v108, v109
  v_max3_f32 v248, v248, v110, v111
  v_mov_b32 v247, v248
  s_nop 1
  v_permlane32_swap_b32 v247, v248
  v_max_f32 v247, v247, v248
  v_mul_f32 v246, s41, v247
  v_mfma_f32_32x32x16_bf16 v[112:127], v[228:231], v[196:199], v[112:127]
  ds_read_b128 v[228:231], v240 offset:21344
  s_waitcnt lgkmcnt(2)
  v_fma_f32 v251, v244, s40, v246
  v_exp_f32 v251, v251
  v_mov_b32 v244, v247
  v_mul_f32 v245, v245, v251
  v_fma_f32 v48, v48, s40, v246
  v_mfma_f32_32x32x16_bf16 v[112:127], v[232:235], v[168:171], v[112:127]
  ds_read_b128 v[232:235], v240 offset:21120
  v_fma_f32 v49, v49, s40, v246
  v_exp_f32 v48, v48
  v_fma_f32 v50, v50, s40, v246
  v_exp_f32 v49, v49
  v_mfma_f32_32x32x16_bf16 v[112:127], v[236:239], v[200:203], v[112:127]
  ds_read_b128 v[236:239], v240 offset:21376
  s_waitcnt lgkmcnt(2)
  v_fma_f32 v51, v51, s40, v246
  v_exp_f32 v50, v50
  v_fma_f32 v52, v52, s40, v246
  v_mfma_f32_32x32x16_bf16 v[112:127], v[224:227], v[172:175], v[112:127]
  ds_read_b128 v[224:227], v240 offset:21152
  v_exp_f32 v51, v51
  v_fma_f32 v53, v53, s40, v246
  v_add_f32 v245, v245, v48
  v_add_f32 v245, v245, v49
  v_cvt_pk_bf16_f32 v48, v48, v49
  v_mfma_f32_32x32x16_bf16 v[112:127], v[228:231], v[204:207], v[112:127]
  ds_read_b128 v[228:231], v240 offset:21408
  s_waitcnt lgkmcnt(2)
  v_exp_f32 v52, v52
  v_fma_f32 v54, v54, s40, v246
  v_exp_f32 v53, v53
  v_mfma_f32_32x32x16_bf16 v[112:127], v[232:235], v[176:179], v[112:127]
  ds_read_b128 v[232:235], v240 offset:21184
  v_fma_f32 v55, v55, s40, v246
  v_add_f32 v245, v245, v50
  v_add_f32 v245, v245, v51
  v_cvt_pk_bf16_f32 v49, v50, v51
  v_exp_f32 v54, v54
  v_fma_f32 v56, v56, s40, v246
  v_mfma_f32_32x32x16_bf16 v[112:127], v[236:239], v[208:211], v[112:127]
  ds_read_b128 v[236:239], v240 offset:21440
  s_waitcnt lgkmcnt(2)
  v_exp_f32 v55, v55
  v_fma_f32 v57, v57, s40, v246
  v_add_f32 v245, v245, v52
  v_add_f32 v245, v245, v53
  v_mfma_f32_32x32x16_bf16 v[112:127], v[224:227], v[180:183], v[112:127]
  ds_read_b128 v[224:227], v240 offset:21216
  v_cvt_pk_bf16_f32 v50, v52, v53
  v_exp_f32 v56, v56
  v_fma_f32 v58, v58, s40, v246
  v_exp_f32 v57, v57
  v_fma_f32 v59, v59, s40, v246
  v_mfma_f32_32x32x16_bf16 v[112:127], v[228:231], v[212:215], v[112:127]
  ds_read_b128 v[228:231], v240 offset:21472
  s_waitcnt lgkmcnt(2)
  v_add_f32 v245, v245, v54
  v_add_f32 v245, v245, v55
  v_cvt_pk_bf16_f32 v51, v54, v55
  v_exp_f32 v58, v58
  v_fma_f32 v60, v60, s40, v246
  v_mfma_f32_32x32x16_bf16 v[112:127], v[232:235], v[184:187], v[112:127]
  s_barrier
  ds_read_b128 v[232:235], v243 offset:24064
  v_exp_f32 v59, v59
  v_fma_f32 v61, v61, s40, v246
  v_add_f32 v245, v245, v56
  v_mfma_f32_32x32x16_bf16 v[112:127], v[236:239], v[216:219], v[112:127]
  ds_read_b128 v[236:239], v243 offset:24320
  s_waitcnt lgkmcnt(2)
  v_add_f32 v245, v245, v57
  v_cvt_pk_bf16_f32 v52, v56, v57
  v_exp_f32 v60, v60
  v_fma_f32 v62, v62, s40, v246
  v_mfma_f32_32x32x16_bf16 v[112:127], v[224:227], v[188:191], v[112:127]
  ds_read_b128 v[224:227], v243 offset:24096
  v_exp_f32 v61, v61
  v_fma_f32 v63, v63, s40, v246
  v_add_f32 v245, v245, v58
  v_add_f32 v245, v245, v59
  v_cvt_pk_bf16_f32 v53, v58, v59
  v_mfma_f32_32x32x16_bf16 v[112:127], v[228:231], v[220:223], v[112:127]
  ds_read_b128 v[228:231], v243 offset:24352
  s_waitcnt lgkmcnt(2)
  v_exp_f32 v62, v62
  v_exp_f32 v63, v63
  v_add_f32 v245, v245, v60
  v_add_f32 v245, v245, v61
  v_mfma_f32_32x32x16_bf16 v[144:159], v[232:235], v[160:163], 0
  ds_read_b128 v[232:235], v243 offset:24128
  v_cvt_pk_bf16_f32 v54, v60, v61
  v_add_f32 v245, v245, v62
  v_add_f32 v245, v245, v63
  v_cvt_pk_bf16_f32 v55, v62, v63
  v_fma_f32 v64, v64, s40, v246
  v_fma_f32 v65, v65, s40, v246
  v_mfma_f32_32x32x16_bf16 v[144:159], v[236:239], v[192:195], v[144:159]
  ds_read_b128 v[236:239], v243 offset:24384
  s_waitcnt lgkmcnt(2)
  v_max3_f32 v248, v244, v112, v113
  v_max3_f32 v248, v248, v114, v115
  v_max3_f32 v248, v248, v116, v117
  v_max3_f32 v248, v248, v118, v119
  v_max3_f32 v248, v248, v120, v121
  v_max3_f32 v248, v248, v122, v123
  v_mfma_f32_32x32x16_bf16 v[144:159], v[224:227], v[164:167], v[144:159]
  ds_read_b128 v[224:227], v243 offset:24160
  v_max3_f32 v248, v248, v124, v125
  v_max3_f32 v248, v248, v126, v127
  v_exp_f32 v64, v64
  v_fma_f32 v66, v66, s40, v246
  v_mfma_f32_32x32x16_bf16 v[144:159], v[228:231], v[196:199], v[144:159]
  ds_read_b128 v[228:231], v243 offset:24416
  s_waitcnt lgkmcnt(2)
  v_exp_f32 v65, v65
  v_fma_f32 v67, v67, s40, v246
  v_exp_f32 v66, v66
  v_fma_f32 v68, v68, s40, v246
  v_mfma_f32_32x32x16_bf16 v[144:159], v[232:235], v[168:171], v[144:159]
  ds_read_b128 v[232:235], v243 offset:24192
  v_exp_f32 v67, v67
  v_fma_f32 v69, v69, s40, v246
  v_add_f32 v245, v245, v64
  v_cvt_pk_bf16_f32 v56, v64, v65
  v_add_f32 v245, v245, v65
  v_mfma_f32_32x32x16_bf16 v[144:159], v[236:239], v[200:203], v[144:159]
  ds_read_b128 v[236:239], v243 offset:24448
  s_waitcnt lgkmcnt(2)
  v_exp_f32 v68, v68
  v_fma_f32 v70, v70, s40, v246
  v_exp_f32 v69, v69
  v_fma_f32 v71, v71, s40, v246
  v_mfma_f32_32x32x16_bf16 v[144:159], v[224:227], v[172:175], v[144:159]
  ds_read_b128 v[224:227], v243 offset:24224
  v_add_f32 v245, v245, v66
  v_cvt_pk_bf16_f32 v57, v66, v67
  v_add_f32 v245, v245, v67
  v_exp_f32 v70, v70
  v_fma_f32 v72, v72, s40, v246
  v_mfma_f32_32x32x16_bf16 v[144:159], v[228:231], v[204:207], v[144:159]
  ds_read_b128 v[228:231], v243 offset:24480
  s_waitcnt lgkmcnt(2)
  v_exp_f32 v71, v71
  v_fma_f32 v73, v73, s40, v246
  v_add_f32 v245, v245, v68
  v_cvt_pk_bf16_f32 v58, v68, v69
  v_add_f32 v245, v245, v69
  v_mfma_f32_32x32x16_bf16 v[144:159], v[232:235], v[176:179], v[144:159]
  ds_read_b128 v[232:235], v243 offset:24256
  v_exp_f32 v72, v72
  v_fma_f32 v74, v74, s40, v246
  v_exp_f32 v73, v73
  v_fma_f32 v75, v75, s40, v246
  v_mfma_f32_32x32x16_bf16 v[144:159], v[236:239], v[208:211], v[144:159]
  ds_read_b128 v[236:239], v243 offset:24512
  s_waitcnt lgkmcnt(2)
  v_add_f32 v245, v245, v70
  v_cvt_pk_bf16_f32 v59, v70, v71
  v_add_f32 v245, v245, v71
  v_exp_f32 v74, v74
  v_fma_f32 v76, v76, s40, v246
  v_mfma_f32_32x32x16_bf16 v[144:159], v[224:227], v[180:183], v[144:159]
  ds_read_b128 v[224:227], v243 offset:24288
  v_exp_f32 v75, v75
  v_fma_f32 v77, v77, s40, v246
  v_add_f32 v245, v245, v72
  v_cvt_pk_bf16_f32 v60, v72, v73
  v_add_f32 v245, v245, v73
  v_mfma_f32_32x32x16_bf16 v[144:159], v[228:231], v[212:215], v[144:159]
  ds_read_b128 v[228:231], v243 offset:24544
  s_waitcnt lgkmcnt(2)
  v_exp_f32 v76, v76
  v_fma_f32 v78, v78, s40, v246
  v_exp_f32 v77, v77
  v_fma_f32 v79, v79, s40, v246
  v_mfma_f32_32x32x16_bf16 v[144:159], v[232:235], v[184:187], v[144:159]
  s_barrier
  ds_read_b128 v[232:235], v243 offset:7168
  v_add_f32 v245, v245, v74
  v_cvt_pk_bf16_f32 v61, v74, v75
  v_add_f32 v245, v245, v75
  v_mfma_f32_32x32x16_bf16 v[144:159], v[236:239], v[216:219], v[144:159]
  ds_read_b128 v[236:239], v243 offset:7424
  s_waitcnt lgkmcnt(2)
  v_exp_f32 v78, v78
  v_exp_f32 v79, v79
  v_add_f32 v245, v245, v76
  v_cvt_pk_bf16_f32 v62, v76, v77
  v_mfma_f32_32x32x16_bf16 v[144:159], v[224:227], v[188:191], v[144:159]
  ds_read_b128 v[224:227], v243 offset:7200
  v_add_f32 v245, v245, v77
  v_add_f32 v245, v245, v78
  v_cvt_pk_bf16_f32 v63, v78, v79
  v_add_f32 v245, v245, v79
  v_fma_f32 v80, v80, s40, v246
  v_fma_f32 v81, v81, s40, v246
  v_mfma_f32_32x32x16_bf16 v[144:159], v[228:231], v[220:223], v[144:159]
  ds_read_b128 v[228:231], v243 offset:7456
  s_waitcnt lgkmcnt(2)
  v_exp_f32 v80, v80
  v_fma_f32 v82, v82, s40, v246
  v_exp_f32 v81, v81
  v_fma_f32 v83, v83, s40, v246
  v_mfma_f32_32x32x16_bf16 v[0:15], v[232:235], v[160:163], 0
  ds_read_b128 v[232:235], v243 offset:7232
  v_exp_f32 v82, v82
  v_fma_f32 v84, v84, s40, v246
  v_exp_f32 v83, v83
  v_fma_f32 v85, v85, s40, v246
  v_mfma_f32_32x32x16_bf16 v[0:15], v[236:239], v[192:195], v[0:15]
  ds_read_b128 v[236:239], v243 offset:7488
  s_waitcnt lgkmcnt(2)
  v_max3_f32 v248, v248, v144, v145
  v_max3_f32 v248, v248, v146, v147
  v_max3_f32 v248, v248, v148, v149
  v_max3_f32 v248, v248, v150, v151
  v_max3_f32 v248, v248, v152, v153
  v_max3_f32 v248, v248, v154, v155
  v_mfma_f32_32x32x16_bf16 v[0:15], v[224:227], v[164:167], v[0:15]
  ds_read_b128 v[224:227], v243 offset:7264
  v_max3_f32 v248, v248, v156, v157
  v_max3_f32 v248, v248, v158, v159
  v_add_f32 v245, v245, v80
  v_add_f32 v245, v245, v81
  v_cvt_pk_bf16_f32 v80, v80, v81
  v_exp_f32 v84, v84
  v_mfma_f32_32x32x16_bf16 v[0:15], v[228:231], v[196:199], v[0:15]
  ds_read_b128 v[228:231], v243 offset:7520
  s_waitcnt lgkmcnt(2)
  v_fma_f32 v86, v86, s40, v246
  v_exp_f32 v85, v85
  v_fma_f32 v87, v87, s40, v246
  v_add_f32 v245, v245, v82
  v_mfma_f32_32x32x16_bf16 v[0:15], v[232:235], v[168:171], v[0:15]
  ds_read_b128 v[232:235], v243 offset:7296
  v_add_f32 v245, v245, v83
  v_cvt_pk_bf16_f32 v81, v82, v83
  v_exp_f32 v86, v86
  v_fma_f32 v88, v88, s40, v246
  v_exp_f32 v87, v87
  v_mfma_f32_32x32x16_bf16 v[0:15], v[236:239], v[200:203], v[0:15]
  ds_read_b128 v[236:239], v243 offset:7552
  s_waitcnt lgkmcnt(2)
  v_fma_f32 v89, v89, s40, v246
  v_add_f32 v245, v245, v84
  v_add_f32 v245, v245, v85
  v_cvt_pk_bf16_f32 v82, v84, v85
  v_mfma_f32_32x32x16_bf16 v[0:15], v[224:227], v[172:175], v[0:15]
  ds_read_b128 v[224:227], v243 offset:7328
  v_exp_f32 v88, v88
  v_fma_f32 v90, v90, s40, v246
  v_exp_f32 v89, v89
  v_fma_f32 v91, v91, s40, v246
  v_add_f32 v245, v245, v86
  v_mfma_f32_32x32x16_bf16 v[0:15], v[228:231], v[204:207], v[0:15]
  ds_read_b128 v[228:231], v243 offset:7584
  s_waitcnt lgkmcnt(2)
  v_add_f32 v245, v245, v87
  v_cvt_pk_bf16_f32 v83, v86, v87
  v_exp_f32 v90, v90
  v_fma_f32 v92, v92, s40, v246
  v_mfma_f32_32x32x16_bf16 v[0:15], v[232:235], v[176:179], v[0:15]
  ds_read_b128 v[232:235], v243 offset:7360
  v_exp_f32 v91, v91
  v_fma_f32 v93, v93, s40, v246
  v_add_f32 v245, v245, v88
  v_add_f32 v245, v245, v89
  v_cvt_pk_bf16_f32 v84, v88, v89
  v_mfma_f32_32x32x16_bf16 v[0:15], v[236:239], v[208:211], v[0:15]
  ds_read_b128 v[236:239], v243 offset:7616
  s_waitcnt lgkmcnt(2)
  v_exp_f32 v92, v92
  v_fma_f32 v94, v94, s40, v246
  v_exp_f32 v93, v93
  v_mfma_f32_32x32x16_bf16 v[0:15], v[224:227], v[180:183], v[0:15]
  ds_read_b128 v[224:227], v243 offset:7392
  v_fma_f32 v95, v95, s40, v246
  v_add_f32 v245, v245, v90
  v_add_f32 v245, v245, v91
  v_cvt_pk_bf16_f32 v85, v90, v91
  v_exp_f32 v94, v94
  v_mfma_f32_32x32x16_bf16 v[0:15], v[228:231], v[212:215], v[0:15]
  ds_read_b128 v[228:231], v243 offset:7648
  s_waitcnt lgkmcnt(2)
  v_exp_f32 v95, v95
  v_add_f32 v245, v245, v92
  v_add_f32 v245, v245, v93
  v_cvt_pk_bf16_f32 v86, v92, v93
  v_mfma_f32_32x32x16_bf16 v[0:15], v[232:235], v[184:187], v[0:15]
  s_barrier
  ds_read_b128 v[232:235], v242 offset:5632
  v_add_f32 v245, v245, v94
  v_add_f32 v245, v245, v95
  v_cvt_pk_bf16_f32 v87, v94, v95
  v_fma_f32 v96, v96, s40, v246
  v_fma_f32 v97, v97, s40, v246
  v_mfma_f32_32x32x16_bf16 v[0:15], v[236:239], v[216:219], v[0:15]
  ds_read_b128 v[236:239], v242 offset:5888
  s_waitcnt lgkmcnt(2)
  v_exp_f32 v96, v96
  v_fma_f32 v98, v98, s40, v246
  v_exp_f32 v97, v97
  v_fma_f32 v99, v99, s40, v246
  v_mfma_f32_32x32x16_bf16 v[0:15], v[224:227], v[188:191], v[0:15]
  ds_read_b128 v[224:227], v242 offset:5664
  v_exp_f32 v98, v98
  v_fma_f32 v100, v100, s40, v246
  v_exp_f32 v99, v99
  v_fma_f32 v101, v101, s40, v246
  v_mfma_f32_32x32x16_bf16 v[0:15], v[228:231], v[220:223], v[0:15]
  ds_read_b128 v[228:231], v242 offset:5920
  s_waitcnt lgkmcnt(2)
  v_add_f32 v245, v245, v96
  v_cvt_pk_bf16_f32 v88, v96, v97
  v_add_f32 v245, v245, v97
  v_exp_f32 v100, v100
  v_fma_f32 v102, v102, s40, v246
  v_mfma_f32_32x32x16_bf16 v[32:47], v[232:235], v[160:163], 0
  ds_read_b128 v[232:235], v242 offset:5696
  v_exp_f32 v101, v101
  v_fma_f32 v103, v103, s40, v246
  v_add_f32 v245, v245, v98
  v_cvt_pk_bf16_f32 v89, v98, v99
  v_add_f32 v245, v245, v99
  v_mfma_f32_32x32x16_bf16 v[32:47], v[236:239], v[192:195], v[32:47]
  ds_read_b128 v[236:239], v242 offset:5952
  s_waitcnt lgkmcnt(2)
  v_max3_f32 v248, v248, v0, v1
  v_max3_f32 v248, v248, v2, v3
  v_max3_f32 v248, v248, v4, v5
  v_max3_f32 v248, v248, v6, v7
  v_max3_f32 v248, v248, v8, v9
  v_max3_f32 v248, v248, v10, v11
  v_mfma_f32_32x32x16_bf16 v[32:47], v[224:227], v[164:167], v[32:47]
  ds_read_b128 v[224:227], v242 offset:5728
  v_max3_f32 v248, v248, v12, v13
  v_max3_f32 v248, v248, v14, v15
  v_exp_f32 v102, v102
  v_fma_f32 v104, v104, s40, v246
  v_exp_f32 v103, v103
  v_mfma_f32_32x32x16_bf16 v[32:47], v[228:231], v[196:199], v[32:47]
  ds_read_b128 v[228:231], v242 offset:5984
  s_waitcnt lgkmcnt(2)
  v_fma_f32 v105, v105, s40, v246
  v_add_f32 v245, v245, v100
  v_cvt_pk_bf16_f32 v90, v100, v101
  v_add_f32 v245, v245, v101
  v_mfma_f32_32x32x16_bf16 v[32:47], v[232:235], v[168:171], v[32:47]
  ds_read_b128 v[232:235], v242 offset:5760
  v_exp_f32 v104, v104
  v_fma_f32 v106, v106, s40, v246
  v_exp_f32 v105, v105
  v_fma_f32 v107, v107, s40, v246
  v_add_f32 v245, v245, v102
  v_mfma_f32_32x32x16_bf16 v[32:47], v[236:239], v[200:203], v[32:47]
  ds_read_b128 v[236:239], v242 offset:6016
  s_waitcnt lgkmcnt(2)
  v_cvt_pk_bf16_f32 v91, v102, v103
  v_add_f32 v245, v245, v103
  v_exp_f32 v106, v106
  v_fma_f32 v108, v108, s40, v246
  v_mfma_f32_32x32x16_bf16 v[32:47], v[224:227], v[172:175], v[32:47]
  ds_read_b128 v[224:227], v242 offset:5792
  v_exp_f32 v107, v107
  v_fma_f32 v109, v109, s40, v246
  v_add_f32 v245, v245, v104
  v_cvt_pk_bf16_f32 v92, v104, v105
  v_add_f32 v245, v245, v105
  v_mfma_f32_32x32x16_bf16 v[32:47], v[228:231], v[204:207], v[32:47]
  ds_read_b128 v[228:231], v242 offset:6048
  s_waitcnt lgkmcnt(2)
  v_exp_f32 v108, v108
  v_fma_f32 v110, v110, s40, v246
  v_exp_f32 v109, v109
  v_mfma_f32_32x32x16_bf16 v[32:47], v[232:235], v[176:179], v[32:47]
  ds_read_b128 v[232:235], v242 offset:5824
  v_fma_f32 v111, v111, s40, v246
  v_add_f32 v245, v245, v106
  v_cvt_pk_bf16_f32 v93, v106, v107
  v_add_f32 v245, v245, v107
  v_exp_f32 v110, v110
  v_mfma_f32_32x32x16_bf16 v[32:47], v[236:239], v[208:211], v[32:47]
  ds_read_b128 v[236:239], v242 offset:6080
  s_waitcnt lgkmcnt(2)
  v_exp_f32 v111, v111
  v_add_f32 v245, v245, v108
  v_cvt_pk_bf16_f32 v94, v108, v109
  v_add_f32 v245, v245, v109
  v_add_f32 v245, v245, v110
  v_mfma_f32_32x32x16_bf16 v[32:47], v[224:227], v[180:183], v[32:47]
  ds_read_b128 v[224:227], v242 offset:5856
  v_cvt_pk_bf16_f32 v95, v110, v111
  v_add_f32 v245, v245, v111
  v_mfma_f32_32x32x16_bf16 v[32:47], v[228:231], v[212:215], v[32:47]
  ds_read_b128 v[228:231], v242 offset:6112
  s_waitcnt lgkmcnt(2)
  v_mfma_f32_32x32x16_bf16 v[32:47], v[232:235], v[184:187], v[32:47]
  s_barrier
  ds_read_b128 v[232:235], v243 offset:40960
  v_mfma_f32_32x32x16_bf16 v[32:47], v[236:239], v[216:219], v[32:47]
  ds_read_b128 v[236:239], v243 offset:41216
  s_waitcnt lgkmcnt(2)
  v_mfma_f32_32x32x16_bf16 v[32:47], v[224:227], v[188:191], v[32:47]
  ds_read_b128 v[224:227], v243 offset:40992
  v_mfma_f32_32x32x16_bf16 v[32:47], v[228:231], v[220:223], v[32:47]
  ds_read_b128 v[228:231], v243 offset:41248
  s_waitcnt lgkmcnt(2)
  v_mfma_f32_32x32x16_bf16 v[64:79], v[232:235], v[160:163], 0
  ds_read_b128 v[232:235], v243 offset:41024
  v_mfma_f32_32x32x16_bf16 v[64:79], v[236:239], v[192:195], v[64:79]
  ds_read_b128 v[236:239], v243 offset:41280
  s_waitcnt lgkmcnt(2)
  s_nop 4
  v_max3_f32 v248, v248, v32, v33
  v_max3_f32 v248, v248, v34, v35
  v_max3_f32 v248, v248, v36, v37
  v_max3_f32 v248, v248, v38, v39
  v_max3_f32 v248, v248, v40, v41
  v_max3_f32 v248, v248, v42, v43
  v_max3_f32 v248, v248, v44, v45
  v_mfma_f32_32x32x16_bf16 v[64:79], v[224:227], v[164:167], v[64:79]
  ds_read_b128 v[224:227], v243 offset:41056
  v_max3_f32 v248, v248, v46, v47
  v_mov_b32 v247, v248
  s_nop 1
  v_permlane32_swap_b32 v247, v248
  v_max_f32 v247, v247, v248
  v_mul_f32 v246, s41, v247
  v_fma_f32 v252, v244, s40, v246
  v_mfma_f32_32x32x16_bf16 v[64:79], v[228:231], v[196:199], v[64:79]
  ds_read_b128 v[228:231], v243 offset:41312
  s_waitcnt lgkmcnt(2)
  v_exp_f32 v252, v252
  v_mov_b32 v244, v247
  v_mul_f32 v245, v245, v252
  v_fma_f32 v112, v112, s40, v246
  v_fma_f32 v113, v113, s40, v246
  v_mfma_f32_32x32x16_bf16 v[64:79], v[232:235], v[168:171], v[64:79]
  ds_read_b128 v[232:235], v243 offset:41088
  v_exp_f32 v112, v112
  v_fma_f32 v114, v114, s40, v246
  v_exp_f32 v113, v113
  v_fma_f32 v115, v115, s40, v246
  v_mfma_f32_32x32x16_bf16 v[64:79], v[236:239], v[200:203], v[64:79]
  ds_read_b128 v[236:239], v243 offset:41344
  s_waitcnt lgkmcnt(2)
  v_exp_f32 v114, v114
  v_fma_f32 v116, v116, s40, v246
  v_exp_f32 v115, v115
  v_fma_f32 v117, v117, s40, v246
  v_add_f32 v245, v245, v112
  v_mfma_f32_32x32x16_bf16 v[64:79], v[224:227], v[172:175], v[64:79]
  ds_read_b128 v[224:227], v243 offset:41120
  v_add_f32 v245, v245, v113
  v_cvt_pk_bf16_f32 v112, v112, v113
  v_exp_f32 v116, v116
  v_fma_f32 v118, v118, s40, v246
  v_exp_f32 v117, v117
  v_mfma_f32_32x32x16_bf16 v[64:79], v[228:231], v[204:207], v[64:79]
  ds_read_b128 v[228:231], v243 offset:41376
  s_waitcnt lgkmcnt(2)
  v_fma_f32 v119, v119, s40, v246
  v_add_f32 v245, v245, v114
  v_add_f32 v245, v245, v115
  v_cvt_pk_bf16_f32 v113, v114, v115
  v_exp_f32 v118, v118
  v_fma_f32 v120, v120, s40, v246
  v_mfma_f32_32x32x16_bf16 v[64:79], v[232:235], v[176:179], v[64:79]
  ds_read_b128 v[232:235], v243 offset:41152
  v_exp_f32 v119, v119
  v_fma_f32 v121, v121, s40, v246
  v_add_f32 v245, v245, v116
  v_add_f32 v245, v245, v117
  v_cvt_pk_bf16_f32 v114, v116, v117
  v_mfma_f32_32x32x16_bf16 v[64:79], v[236:239], v[208:211], v[64:79]
  ds_read_b128 v[236:239], v243 offset:41408
  s_waitcnt lgkmcnt(2)
  v_exp_f32 v120, v120
  v_fma_f32 v122, v122, s40, v246
  v_exp_f32 v121, v121
  v_fma_f32 v123, v123, s40, v246
  v_add_f32 v245, v245, v118
  v_mfma_f32_32x32x16_bf16 v[64:79], v[224:227], v[180:183], v[64:79]
  ds_read_b128 v[224:227], v243 offset:41184
  v_add_f32 v245, v245, v119
  v_cvt_pk_bf16_f32 v115, v118, v119
  v_exp_f32 v122, v122
  v_fma_f32 v124, v124, s40, v246
  v_exp_f32 v123, v123
  v_mfma_f32_32x32x16_bf16 v[64:79], v[228:231], v[212:215], v[64:79]
  ds_read_b128 v[228:231], v243 offset:41440
  s_waitcnt lgkmcnt(2)
  v_fma_f32 v125, v125, s40, v246
  v_add_f32 v245, v245, v120
  v_add_f32 v245, v245, v121
  v_cvt_pk_bf16_f32 v116, v120, v121
  v_exp_f32 v124, v124
  v_fma_f32 v126, v126, s40, v246
  v_mfma_f32_32x32x16_bf16 v[64:79], v[232:235], v[184:187], v[64:79]
  s_barrier
  ds_read_b128 v[232:235], v240 offset:4096
  v_exp_f32 v125, v125
  v_fma_f32 v127, v127, s40, v246
  v_add_f32 v245, v245, v122
  v_add_f32 v245, v245, v123
  v_cvt_pk_bf16_f32 v117, v122, v123
  v_mfma_f32_32x32x16_bf16 v[64:79], v[236:239], v[216:219], v[64:79]
  ds_read_b128 v[236:239], v240 offset:4352
  s_waitcnt lgkmcnt(2)
  v_exp_f32 v126, v126
  v_exp_f32 v127, v127
  v_add_f32 v245, v245, v124
  v_add_f32 v245, v245, v125
  v_mfma_f32_32x32x16_bf16 v[64:79], v[224:227], v[188:191], v[64:79]
  ds_read_b128 v[224:227], v240 offset:4128
  v_cvt_pk_bf16_f32 v118, v124, v125
  v_add_f32 v245, v245, v126
  v_add_f32 v245, v245, v127
  v_cvt_pk_bf16_f32 v119, v126, v127
  v_fma_f32 v144, v144, s40, v246
  v_fma_f32 v145, v145, s40, v246
  v_exp_f32 v144, v144
  v_mfma_f32_32x32x16_bf16 v[64:79], v[228:231], v[220:223], v[64:79]
  ds_read_b128 v[228:231], v240 offset:4384
  s_waitcnt lgkmcnt(2)
  v_fma_f32 v146, v146, s40, v246
  v_exp_f32 v145, v145
  v_fma_f32 v147, v147, s40, v246
  v_exp_f32 v146, v146
  v_mfma_f32_32x32x16_bf16 v[96:111], v[232:235], v[160:163], 0
  ds_read_b128 v[232:235], v240 offset:4160
  v_fma_f32 v148, v148, s40, v246
  v_exp_f32 v147, v147
  v_fma_f32 v149, v149, s40, v246
  v_add_f32 v245, v245, v144
  v_cvt_pk_bf16_f32 v120, v144, v145
  v_add_f32 v245, v245, v145
  v_mfma_f32_32x32x16_bf16 v[96:111], v[236:239], v[192:195], v[96:111]
  ds_read_b128 v[236:239], v240 offset:4416
  s_waitcnt lgkmcnt(2)
  v_max3_f32 v248, v244, v64, v65
  v_max3_f32 v248, v248, v66, v67
  v_max3_f32 v248, v248, v68, v69
  v_max3_f32 v248, v248, v70, v71
  v_max3_f32 v248, v248, v72, v73
  v_max3_f32 v248, v248, v74, v75
  v_mfma_f32_32x32x16_bf16 v[96:111], v[224:227], v[164:167], v[96:111]
  ds_read_b128 v[224:227], v240 offset:4192
  v_max3_f32 v248, v248, v76, v77
  v_max3_f32 v248, v248, v78, v79
  v_exp_f32 v148, v148
  v_fma_f32 v150, v150, s40, v246
  v_exp_f32 v149, v149
  v_fma_f32 v151, v151, s40, v246
  v_mfma_f32_32x32x16_bf16 v[96:111], v[228:231], v[196:199], v[96:111]
  ds_read_b128 v[228:231], v240 offset:4448
  s_waitcnt lgkmcnt(2)
  v_add_f32 v245, v245, v146
  v_cvt_pk_bf16_f32 v121, v146, v147
  v_add_f32 v245, v245, v147
  v_exp_f32 v150, v150
  v_fma_f32 v152, v152, s40, v246
  v_mfma_f32_32x32x16_bf16 v[96:111], v[232:235], v[168:171], v[96:111]
  ds_read_b128 v[232:235], v240 offset:4224
  v_exp_f32 v151, v151
  v_fma_f32 v153, v153, s40, v246
  v_add_f32 v245, v245, v148
  v_cvt_pk_bf16_f32 v122, v148, v149
  v_add_f32 v245, v245, v149
  v_exp_f32 v152, v152
  v_mfma_f32_32x32x16_bf16 v[96:111], v[236:239], v[200:203], v[96:111]
  ds_read_b128 v[236:239], v240 offset:4480
  s_waitcnt lgkmcnt(2)
  v_fma_f32 v154, v154, s40, v246
  v_exp_f32 v153, v153
  v_fma_f32 v155, v155, s40, v246
  v_add_f32 v245, v245, v150
  v_cvt_pk_bf16_f32 v123, v150, v151
  v_add_f32 v245, v245, v151
  v_mfma_f32_32x32x16_bf16 v[96:111], v[224:227], v[172:175], v[96:111]
  ds_read_b128 v[224:227], v240 offset:4256
  v_exp_f32 v154, v154
  v_fma_f32 v156, v156, s40, v246
  v_exp_f32 v155, v155
  v_fma_f32 v157, v157, s40, v246
  v_add_f32 v245, v245, v152
  v_mfma_f32_32x32x16_bf16 v[96:111], v[228:231], v[204:207], v[96:111]
  ds_read_b128 v[228:231], v240 offset:4512
  s_waitcnt lgkmcnt(2)
  v_cvt_pk_bf16_f32 v124, v152, v153
  v_add_f32 v245, v245, v153
  v_exp_f32 v156, v156
  v_fma_f32 v158, v158, s40, v246
  v_exp_f32 v157, v157
  v_mfma_f32_32x32x16_bf16 v[96:111], v[232:235], v[176:179], v[96:111]
  ds_read_b128 v[232:235], v240 offset:4288
  v_fma_f32 v159, v159, s40, v246
  v_add_f32 v245, v245, v154
  v_cvt_pk_bf16_f32 v125, v154, v155
  v_add_f32 v245, v245, v155
  v_exp_f32 v158, v158
  v_mfma_f32_32x32x16_bf16 v[96:111], v[236:239], v[208:211], v[96:111]
  ds_read_b128 v[236:239], v240 offset:4544
  s_waitcnt lgkmcnt(2)
  v_exp_f32 v159, v159
  v_add_f32 v245, v245, v156
  v_cvt_pk_bf16_f32 v126, v156, v157
  v_add_f32 v245, v245, v157
  v_add_f32 v245, v245, v158
  v_cvt_pk_bf16_f32 v127, v158, v159
  v_mfma_f32_32x32x16_bf16 v[96:111], v[224:227], v[180:183], v[96:111]
  ds_read_b128 v[224:227], v240 offset:4320
  v_add_f32 v245, v245, v159
  v_fma_f32 v0, v0, s40, v246
  v_fma_f32 v1, v1, s40, v246
  v_exp_f32 v0, v0
  v_fma_f32 v2, v2, s40, v246
  v_exp_f32 v1, v1
  v_mfma_f32_32x32x16_bf16 v[96:111], v[228:231], v[212:215], v[96:111]
  ds_read_b128 v[228:231], v240 offset:4576
  s_waitcnt lgkmcnt(2)
  v_fma_f32 v3, v3, s40, v246
  v_exp_f32 v2, v2
  v_fma_f32 v4, v4, s40, v246
  v_exp_f32 v3, v3
  v_mfma_f32_32x32x16_bf16 v[96:111], v[232:235], v[184:187], v[96:111]
  s_barrier
  ds_read_b128 v[232:235], v240 offset:37888
  v_fma_f32 v5, v5, s40, v246
  v_add_f32 v245, v245, v0
  v_add_f32 v245, v245, v1
  v_cvt_pk_bf16_f32 v0, v0, v1
  v_exp_f32 v4, v4
  v_mfma_f32_32x32x16_bf16 v[96:111], v[236:239], v[216:219], v[96:111]
  ds_read_b128 v[236:239], v240 offset:38144
  s_waitcnt lgkmcnt(2)
  v_fma_f32 v6, v6, s40, v246
  v_exp_f32 v5, v5
  v_fma_f32 v7, v7, s40, v246
  v_add_f32 v245, v245, v2
  v_add_f32 v245, v245, v3
  v_mfma_f32_32x32x16_bf16 v[96:111], v[224:227], v[188:191], v[96:111]
  ds_read_b128 v[224:227], v240 offset:37920
  v_cvt_pk_bf16_f32 v1, v2, v3
  v_exp_f32 v6, v6
  v_fma_f32 v8, v8, s40, v246
  v_exp_f32 v7, v7
  v_fma_f32 v9, v9, s40, v246
  v_add_f32 v245, v245, v4
  v_mfma_f32_32x32x16_bf16 v[96:111], v[228:231], v[220:223], v[96:111]
  ds_read_b128 v[228:231], v240 offset:38176
  s_waitcnt lgkmcnt(2)
  v_add_f32 v245, v245, v5
  v_cvt_pk_bf16_f32 v2, v4, v5
  v_exp_f32 v8, v8
  v_fma_f32 v10, v10, s40, v246
  v_exp_f32 v9, v9
  v_mfma_f32_32x32x16_bf16 v[144:159], v[232:235], v[160:163], 0
  ds_read_b128 v[232:235], v240 offset:37952
  v_fma_f32 v11, v11, s40, v246
  v_add_f32 v245, v245, v6
  v_add_f32 v245, v245, v7
  v_cvt_pk_bf16_f32 v3, v6, v7
  v_exp_f32 v10, v10
  v_fma_f32 v12, v12, s40, v246
  v_mfma_f32_32x32x16_bf16 v[144:159], v[236:239], v[192:195], v[144:159]
  ds_read_b128 v[236:239], v240 offset:38208
  s_waitcnt lgkmcnt(2)
  v_max3_f32 v248, v248, v96, v97
  v_max3_f32 v248, v248, v98, v99
  v_max3_f32 v248, v248, v100, v101
  v_max3_f32 v248, v248, v102, v103
  v_max3_f32 v248, v248, v104, v105
  v_max3_f32 v248, v248, v106, v107
  v_max3_f32 v248, v248, v108, v109
  v_mfma_f32_32x32x16_bf16 v[144:159], v[224:227], v[164:167], v[144:159]
  ds_read_b128 v[224:227], v240 offset:37984
  v_max3_f32 v248, v248, v110, v111
  v_exp_f32 v11, v11
  v_fma_f32 v13, v13, s40, v246
  v_add_f32 v245, v245, v8
  v_add_f32 v245, v245, v9
  v_cvt_pk_bf16_f32 v4, v8, v9
  v_mfma_f32_32x32x16_bf16 v[144:159], v[228:231], v[196:199], v[144:159]
  ds_read_b128 v[228:231], v240 offset:38240
  s_waitcnt lgkmcnt(2)
  v_exp_f32 v12, v12
  v_fma_f32 v14, v14, s40, v246
  v_exp_f32 v13, v13
  v_fma_f32 v15, v15, s40, v246
  v_mfma_f32_32x32x16_bf16 v[144:159], v[232:235], v[168:171], v[144:159]
  ds_read_b128 v[232:235], v240 offset:38016
  v_add_f32 v245, v245, v10
  v_add_f32 v245, v245, v11
  v_cvt_pk_bf16_f32 v5, v10, v11
  v_exp_f32 v14, v14
  v_exp_f32 v15, v15
  v_add_f32 v245, v245, v12
  v_mfma_f32_32x32x16_bf16 v[144:159], v[236:239], v[200:203], v[144:159]
  ds_read_b128 v[236:239], v240 offset:38272
  s_waitcnt lgkmcnt(2)
  v_add_f32 v245, v245, v13
  v_cvt_pk_bf16_f32 v6, v12, v13
  v_add_f32 v245, v245, v14
  v_add_f32 v245, v245, v15
  v_cvt_pk_bf16_f32 v7, v14, v15
  v_fma_f32 v32, v32, s40, v246
  v_fma_f32 v33, v33, s40, v246
  v_mfma_f32_32x32x16_bf16 v[144:159], v[224:227], v[172:175], v[144:159]
  ds_read_b128 v[224:227], v240 offset:38048
  v_exp_f32 v32, v32
  v_fma_f32 v34, v34, s40, v246
  v_exp_f32 v33, v33
  v_fma_f32 v35, v35, s40, v246
  v_mfma_f32_32x32x16_bf16 v[144:159], v[228:231], v[204:207], v[144:159]
  ds_read_b128 v[228:231], v240 offset:38304
  s_waitcnt lgkmcnt(2)
  v_exp_f32 v34, v34
  v_fma_f32 v36, v36, s40, v246
  v_exp_f32 v35, v35
  v_fma_f32 v37, v37, s40, v246
  v_add_f32 v245, v245, v32
  v_mfma_f32_32x32x16_bf16 v[144:159], v[232:235], v[176:179], v[144:159]
  ds_read_b128 v[232:235], v240 offset:38080
  v_cvt_pk_bf16_f32 v8, v32, v33
  v_add_f32 v245, v245, v33
  v_exp_f32 v36, v36
  v_fma_f32 v38, v38, s40, v246
  v_exp_f32 v37, v37
  v_fma_f32 v39, v39, s40, v246
  v_mfma_f32_32x32x16_bf16 v[144:159], v[236:239], v[208:211], v[144:159]
  ds_read_b128 v[236:239], v240 offset:38336
  s_waitcnt lgkmcnt(2)
  v_add_f32 v245, v245, v34
  v_cvt_pk_bf16_f32 v9, v34, v35
  v_add_f32 v245, v245, v35
  v_exp_f32 v38, v38
  v_fma_f32 v40, v40, s40, v246
  v_mfma_f32_32x32x16_bf16 v[144:159], v[224:227], v[180:183], v[144:159]
  ds_read_b128 v[224:227], v240 offset:38112
  v_exp_f32 v39, v39
  v_fma_f32 v41, v41, s40, v246
  v_add_f32 v245, v245, v36
  v_cvt_pk_bf16_f32 v10, v36, v37
  v_add_f32 v245, v245, v37
  v_exp_f32 v40, v40
  v_mfma_f32_32x32x16_bf16 v[144:159], v[228:231], v[212:215], v[144:159]
  ds_read_b128 v[228:231], v240 offset:38368
  s_waitcnt lgkmcnt(2)
  v_fma_f32 v42, v42, s40, v246
  v_exp_f32 v41, v41
  v_fma_f32 v43, v43, s40, v246
  v_add_f32 v245, v245, v38
  v_cvt_pk_bf16_f32 v11, v38, v39
  v_add_f32 v245, v245, v39
  v_mfma_f32_32x32x16_bf16 v[144:159], v[232:235], v[184:187], v[144:159]
  s_barrier
  ds_read_b128 v[232:235], v242 offset:22528
  v_exp_f32 v42, v42
  v_fma_f32 v44, v44, s40, v246
  v_exp_f32 v43, v43
  v_fma_f32 v45, v45, s40, v246
  v_mfma_f32_32x32x16_bf16 v[144:159], v[236:239], v[216:219], v[144:159]
  ds_read_b128 v[236:239], v242 offset:22784
  s_waitcnt lgkmcnt(2)
  v_add_f32 v245, v245, v40
  v_cvt_pk_bf16_f32 v12, v40, v41
  v_add_f32 v245, v245, v41
  v_exp_f32 v44, v44
  v_fma_f32 v46, v46, s40, v246
  v_mfma_f32_32x32x16_bf16 v[144:159], v[224:227], v[188:191], v[144:159]
  ds_read_b128 v[224:227], v242 offset:22560
  v_exp_f32 v45, v45
  v_fma_f32 v47, v47, s40, v246
  v_add_f32 v245, v245, v42
  v_cvt_pk_bf16_f32 v13, v42, v43
  v_add_f32 v245, v245, v43
  v_exp_f32 v46, v46
  v_mfma_f32_32x32x16_bf16 v[144:159], v[228:231], v[220:223], v[144:159]
  ds_read_b128 v[228:231], v242 offset:22816
  s_waitcnt lgkmcnt(2)
  v_exp_f32 v47, v47
  v_add_f32 v245, v245, v44
  v_cvt_pk_bf16_f32 v14, v44, v45
  v_add_f32 v245, v245, v45
  v_add_f32 v245, v245, v46
  v_cvt_pk_bf16_f32 v15, v46, v47
  v_add_f32 v245, v245, v47
  v_mfma_f32_32x32x16_bf16 v[32:47], v[232:235], v[160:163], 0
  ds_read_b128 v[232:235], v242 offset:22592
  v_mfma_f32_32x32x16_bf16 v[32:47], v[236:239], v[192:195], v[32:47]
  ds_read_b128 v[236:239], v242 offset:22848
  s_waitcnt lgkmcnt(2)
  v_max3_f32 v248, v248, v144, v145
  v_max3_f32 v248, v248, v146, v147
  v_max3_f32 v248, v248, v148, v149
  v_max3_f32 v248, v248, v150, v151
  v_max3_f32 v248, v248, v152, v153
  v_mfma_f32_32x32x16_bf16 v[32:47], v[224:227], v[164:167], v[32:47]
  ds_read_b128 v[224:227], v242 offset:22624
  v_max3_f32 v248, v248, v154, v155
  v_max3_f32 v248, v248, v156, v157
  v_max3_f32 v248, v248, v158, v159
  v_mfma_f32_32x32x16_bf16 v[32:47], v[228:231], v[196:199], v[32:47]
  ds_read_b128 v[228:231], v242 offset:22880
  s_waitcnt lgkmcnt(2)
  v_mfma_f32_32x32x16_bf16 v[32:47], v[232:235], v[168:171], v[32:47]
  ds_read_b128 v[232:235], v242 offset:22656
  v_mfma_f32_32x32x16_bf16 v[32:47], v[236:239], v[200:203], v[32:47]
  ds_read_b128 v[236:239], v242 offset:22912
  s_waitcnt lgkmcnt(2)
  v_mfma_f32_32x32x16_bf16 v[32:47], v[224:227], v[172:175], v[32:47]
  ds_read_b128 v[224:227], v242 offset:22688
  v_mfma_f32_32x32x16_bf16 v[32:47], v[228:231], v[204:207], v[32:47]
  ds_read_b128 v[228:231], v242 offset:22944
  s_waitcnt lgkmcnt(2)
  v_mfma_f32_32x32x16_bf16 v[32:47], v[232:235], v[176:179], v[32:47]
  ds_read_b128 v[232:235], v242 offset:22720
  v_mfma_f32_32x32x16_bf16 v[32:47], v[236:239], v[208:211], v[32:47]
  ds_read_b128 v[236:239], v242 offset:22976
  s_waitcnt lgkmcnt(2)
  v_mfma_f32_32x32x16_bf16 v[32:47], v[224:227], v[180:183], v[32:47]
  ds_read_b128 v[224:227], v242 offset:22752
  v_mfma_f32_32x32x16_bf16 v[32:47], v[228:231], v[212:215], v[32:47]
  ds_read_b128 v[228:231], v242 offset:23008
  s_waitcnt lgkmcnt(2)
  v_xor_b32 v243, 0xc000, v241
  v_mfma_f32_32x32x16_bf16 v[32:47], v[232:235], v[184:187], v[32:47]
  s_barrier
  ds_read_b64_tr_b16 v[232:233], v243 offset:39424
  ds_read_b64_tr_b16 v[234:235], v243 offset:41472
  v_mfma_f32_32x32x16_bf16 v[32:47], v[236:239], v[216:219], v[32:47]
  ds_read_b64_tr_b16 v[236:237], v243 offset:43520
  ds_read_b64_tr_b16 v[238:239], v243 offset:45568
  s_waitcnt lgkmcnt(4)
  v_mfma_f32_32x32x16_bf16 v[32:47], v[224:227], v[188:191], v[32:47]
  ds_read_b64_tr_b16 v[224:225], v243 offset:47616
  ds_read_b64_tr_b16 v[226:227], v243 offset:49664
  v_mfma_f32_32x32x16_bf16 v[32:47], v[228:231], v[220:223], v[32:47]
  ds_read_b64_tr_b16 v[228:229], v243 offset:51712
  ds_read_b64_tr_b16 v[230:231], v243 offset:53760
  s_waitcnt lgkmcnt(4)
  v_xor_b32 v240, 0xc040, v241
  v_mfma_f32_32x32x16_bf16 v[160:175], v[232:235], v[128:131], 0
  ds_read_b64_tr_b16 v[232:233], v240 offset:39424
  ds_read_b64_tr_b16 v[234:235], v240 offset:41472
L_v:
  v_mfma_f32_32x32x16_bf16 v[160:175], v[236:239], v[132:135], v[160:175]
  ds_read_b64_tr_b16 v[236:237], v240 offset:43520
  ds_read_b64_tr_b16 v[238:239], v240 offset:45568
  s_waitcnt lgkmcnt(4)
  s_nop 0
  v_max3_f32 v248, v248, v32, v33
  v_max3_f32 v248, v248, v34, v35
  v_max3_f32 v248, v248, v36, v37
  v_max3_f32 v248, v248, v38, v39
  v_max3_f32 v248, v248, v40, v41
  v_mfma_f32_32x32x16_bf16 v[160:175], v[224:227], v[136:139], v[160:175]
  ds_read_b64_tr_b16 v[224:225], v240 offset:47616
  ds_read_b64_tr_b16 v[226:227], v240 offset:49664
  v_max3_f32 v248, v248, v42, v43
  v_max3_f32 v248, v248, v44, v45
  v_max3_f32 v248, v248, v46, v47
  v_mov_b32 v247, v248
  s_nop 1
  v_permlane32_swap_b32 v247, v248
  v_mfma_f32_32x32x16_bf16 v[160:175], v[228:231], v[140:143], v[160:175]
  ds_read_b64_tr_b16 v[228:229], v240 offset:51712
  ds_read_b64_tr_b16 v[230:231], v240 offset:53760
  s_waitcnt lgkmcnt(4)
  v_max_f32 v247, v247, v248
  v_mul_f32 v246, s41, v247
  v_fma_f32 v253, v244, s40, v246
  v_xor_b32 v242, 0xc080, v241
  v_mfma_f32_32x32x16_bf16 v[176:191], v[232:235], v[128:131], 0
  ds_read_b64_tr_b16 v[232:233], v242 offset:39424
  ds_read_b64_tr_b16 v[234:235], v242 offset:41472
  v_exp_f32 v253, v253
  v_mov_b32 v244, v247
  v_mul_f32 v245, v245, v253
  v_fma_f32 v64, v64, s40, v246
  v_mfma_f32_32x32x16_bf16 v[176:191], v[236:239], v[132:135], v[176:191]
  ds_read_b64_tr_b16 v[236:237], v242 offset:43520
  ds_read_b64_tr_b16 v[238:239], v242 offset:45568
  s_waitcnt lgkmcnt(4)
  v_fma_f32 v65, v65, s40, v246
  v_exp_f32 v64, v64
  v_fma_f32 v66, v66, s40, v246
  v_mfma_f32_32x32x16_bf16 v[176:191], v[224:227], v[136:139], v[176:191]
  ds_read_b64_tr_b16 v[224:225], v242 offset:47616
  ds_read_b64_tr_b16 v[226:227], v242 offset:49664
  v_exp_f32 v65, v65
  v_fma_f32 v67, v67, s40, v246
  v_exp_f32 v66, v66
  v_mfma_f32_32x32x16_bf16 v[176:191], v[228:231], v[140:143], v[176:191]
  ds_read_b64_tr_b16 v[228:229], v242 offset:51712
  ds_read_b64_tr_b16 v[230:231], v242 offset:53760
  s_waitcnt lgkmcnt(4)
  v_fma_f32 v68, v68, s40, v246
  v_exp_f32 v67, v67
  v_xor_b32 v243, 0xc0c0, v241
  v_mfma_f32_32x32x16_bf16 v[192:207], v[232:235], v[128:131], 0
  ds_read_b64_tr_b16 v[232:233], v243 offset:39424
  ds_read_b64_tr_b16 v[234:235], v243 offset:41472
  v_fma_f32 v69, v69, s40, v246
  v_add_f32 v245, v245, v64
  v_add_f32 v245, v245, v65
  v_cvt_pk_bf16_f32 v64, v64, v65
  v_exp_f32 v68, v68
  v_mfma_f32_32x32x16_bf16 v[192:207], v[236:239], v[132:135], v[192:207]
  ds_read_b64_tr_b16 v[236:237], v243 offset:43520
  ds_read_b64_tr_b16 v[238:239], v243 offset:45568
  s_waitcnt lgkmcnt(4)
  v_fma_f32 v70, v70, s40, v246
  v_exp_f32 v69, v69
  v_fma_f32 v71, v71, s40, v246
  v_mfma_f32_32x32x16_bf16 v[192:207], v[224:227], v[136:139], v[192:207]
  ds_read_b64_tr_b16 v[224:225], v243 offset:47616
  ds_read_b64_tr_b16 v[226:227], v243 offset:49664
  v_add_f32 v245, v245, v66
  v_add_f32 v245, v245, v67
  v_cvt_pk_bf16_f32 v65, v66, v67
  v_exp_f32 v70, v70
  v_mfma_f32_32x32x16_bf16 v[192:207], v[228:231], v[140:143], v[192:207]
  ds_read_b64_tr_b16 v[228:229], v243 offset:51712
  ds_read_b64_tr_b16 v[230:231], v243 offset:53760
  s_waitcnt lgkmcnt(4)
  v_fma_f32 v72, v72, s40, v246
  v_exp_f32 v71, v71
  v_xor_b32 v240, 0x0, v241
  v_mfma_f32_32x32x16_bf16 v[208:223], v[232:235], v[128:131], 0
  s_barrier
  ds_read_b64_tr_b16 v[232:233], v240 offset:20992
  ds_read_b64_tr_b16 v[234:235], v240 offset:23040
  v_fma_f32 v73, v73, s40, v246
  v_add_f32 v245, v245, v68
  v_add_f32 v245, v245, v69
  v_cvt_pk_bf16_f32 v66, v68, v69
  v_mfma_f32_32x32x16_bf16 v[208:223], v[236:239], v[132:135], v[208:223]
  ds_read_b64_tr_b16 v[236:237], v240 offset:25088
  ds_read_b64_tr_b16 v[238:239], v240 offset:27136
  s_waitcnt lgkmcnt(4)
  v_exp_f32 v72, v72
  v_fma_f32 v74, v74, s40, v246
  v_mfma_f32_32x32x16_bf16 v[208:223], v[224:227], v[136:139], v[208:223]
  ds_read_b64_tr_b16 v[224:225], v240 offset:29184
  ds_read_b64_tr_b16 v[226:227], v240 offset:31232
  v_exp_f32 v73, v73
  v_fma_f32 v75, v75, s40, v246
  v_add_f32 v245, v245, v70
  v_add_f32 v245, v245, v71
  v_mfma_f32_32x32x16_bf16 v[208:223], v[228:231], v[140:143], v[208:223]
  ds_read_b64_tr_b16 v[228:229], v240 offset:33280
  ds_read_b64_tr_b16 v[230:231], v240 offset:35328
  s_waitcnt lgkmcnt(4)
  v_cvt_pk_bf16_f32 v67, v70, v71
  v_exp_f32 v74, v74
  v_fma_f32 v76, v76, s40, v246
  v_xor_b32 v242, 0x40, v241
  v_mfma_f32_32x32x16_bf16 v[160:175], v[232:235], v[16:19], v[160:175]
  ds_read_b64_tr_b16 v[232:233], v242 offset:20992
  ds_read_b64_tr_b16 v[234:235], v242 offset:23040
  v_exp_f32 v75, v75
  v_fma_f32 v77, v77, s40, v246
  v_add_f32 v245, v245, v72
  v_add_f32 v245, v245, v73
  v_mfma_f32_32x32x16_bf16 v[160:175], v[236:239], v[20:23], v[160:175]
  ds_read_b64_tr_b16 v[236:237], v242 offset:25088
  ds_read_b64_tr_b16 v[238:239], v242 offset:27136
  s_waitcnt lgkmcnt(4)
  v_cvt_pk_bf16_f32 v68, v72, v73
  v_exp_f32 v76, v76
  v_fma_f32 v78, v78, s40, v246
  v_mfma_f32_32x32x16_bf16 v[160:175], v[224:227], v[24:27], v[160:175]
  ds_read_b64_tr_b16 v[224:225], v242 offset:29184
  ds_read_b64_tr_b16 v[226:227], v242 offset:31232
  v_exp_f32 v77, v77
  v_fma_f32 v79, v79, s40, v246
  v_add_f32 v245, v245, v74
  v_add_f32 v245, v245, v75
  v_mfma_f32_32x32x16_bf16 v[160:175], v[228:231], v[28:31], v[160:175]
  ds_read_b64_tr_b16 v[228:229], v242 offset:33280
  ds_read_b64_tr_b16 v[230:231], v242 offset:35328
  s_waitcnt lgkmcnt(4)
  v_cvt_pk_bf16_f32 v69, v74, v75
  v_exp_f32 v78, v78
  v_xor_b32 v243, 0x80, v241
  v_mfma_f32_32x32x16_bf16 v[176:191], v[232:235], v[16:19], v[176:191]
  ds_read_b64_tr_b16 v[232:233], v243 offset:20992
  ds_read_b64_tr_b16 v[234:235], v243 offset:23040
  v_exp_f32 v79, v79
  v_add_f32 v245, v245, v76
  v_add_f32 v245, v245, v77
  v_cvt_pk_bf16_f32 v70, v76, v77
  v_mfma_f32_32x32x16_bf16 v[176:191], v[236:239], v[20:23], v[176:191]
  ds_read_b64_tr_b16 v[236:237], v243 offset:25088
  ds_read_b64_tr_b16 v[238:239], v243 offset:27136
  s_waitcnt lgkmcnt(4)
  v_mul_f32 v160, v251, v160
  v_mul_f32 v161, v251, v161
  v_mul_f32 v162, v251, v162
  v_mul_f32 v163, v251, v163
  v_mfma_f32_32x32x16_bf16 v[176:191], v[224:227], v[24:27], v[176:191]
  ds_read_b64_tr_b16 v[224:225], v243 offset:29184
  ds_read_b64_tr_b16 v[226:227], v243 offset:31232
  v_mul_f32 v164, v251, v164
  v_mul_f32 v165, v251, v165
  v_mul_f32 v166, v251, v166
  v_mul_f32 v167, v251, v167
  v_mul_f32 v168, v251, v168
  v_mul_f32 v169, v251, v169
  v_mfma_f32_32x32x16_bf16 v[176:191], v[228:231], v[28:31], v[176:191]
  ds_read_b64_tr_b16 v[228:229], v243 offset:33280
  ds_read_b64_tr_b16 v[230:231], v243 offset:35328
  s_waitcnt lgkmcnt(4)
  v_mul_f32 v170, v251, v170
  v_mul_f32 v171, v251, v171
  v_mul_f32 v172, v251, v172
  v_xor_b32 v240, 0xc0, v241
  v_mfma_f32_32x32x16_bf16 v[192:207], v[232:235], v[16:19], v[192:207]
  ds_read_b64_tr_b16 v[232:233], v240 offset:20992
  ds_read_b64_tr_b16 v[234:235], v240 offset:23040
  v_mul_f32 v173, v251, v173
  v_mul_f32 v174, v251, v174
  v_mul_f32 v175, v251, v175
  v_add_f32 v245, v245, v78
  v_add_f32 v245, v245, v79
  v_mfma_f32_32x32x16_bf16 v[192:207], v[236:239], v[20:23], v[192:207]
  ds_read_b64_tr_b16 v[236:237], v240 offset:25088
  ds_read_b64_tr_b16 v[238:239], v240 offset:27136
  s_waitcnt lgkmcnt(4)
  v_mul_f32 v176, v251, v176
  v_mul_f32 v177, v251, v177
  v_mul_f32 v178, v251, v178
  v_mul_f32 v179, v251, v179
  v_mfma_f32_32x32x16_bf16 v[192:207], v[224:227], v[24:27], v[192:207]
  ds_read_b64_tr_b16 v[224:225], v240 offset:29184
  ds_read_b64_tr_b16 v[226:227], v240 offset:31232
  v_mul_f32 v180, v251, v180
  v_mul_f32 v181, v251, v181
  v_mul_f32 v182, v251, v182
  v_mul_f32 v183, v251, v183
  v_mul_f32 v184, v251, v184
  v_mul_f32 v185, v251, v185
  v_mfma_f32_32x32x16_bf16 v[192:207], v[228:231], v[28:31], v[192:207]
  ds_read_b64_tr_b16 v[228:229], v240 offset:33280
  ds_read_b64_tr_b16 v[230:231], v240 offset:35328
  s_waitcnt lgkmcnt(4)
  v_mul_f32 v186, v251, v186
  v_mul_f32 v187, v251, v187
  v_mul_f32 v188, v251, v188
  v_xor_b32 v242, 0x18000, v241
  v_mfma_f32_32x32x16_bf16 v[208:223], v[232:235], v[16:19], v[208:223]
  s_barrier
  ds_read_b64_tr_b16 v[232:233], v242 offset:24064
  ds_read_b64_tr_b16 v[234:235], v242 offset:26112
  v_mul_f32 v189, v251, v189
  v_mul_f32 v190, v251, v190
  v_mul_f32 v191, v251, v191
  v_mfma_f32_32x32x16_bf16 v[208:223], v[236:239], v[20:23], v[208:223]
  ds_read_b64_tr_b16 v[236:237], v242 offset:28160
  ds_read_b64_tr_b16 v[238:239], v242 offset:30208
  s_waitcnt lgkmcnt(4)
  v_mul_f32 v192, v251, v192
  v_mul_f32 v193, v251, v193
  v_mul_f32 v194, v251, v194
  v_mul_f32 v195, v251, v195
  v_mul_f32 v196, v251, v196
  v_mfma_f32_32x32x16_bf16 v[208:223], v[224:227], v[24:27], v[208:223]
  ds_read_b64_tr_b16 v[224:225], v242 offset:32256
  ds_read_b64_tr_b16 v[226:227], v242 offset:34304
  v_mul_f32 v197, v251, v197
  v_mul_f32 v198, v251, v198
  v_mul_f32 v199, v251, v199
  v_mul_f32 v200, v251, v200
  v_mul_f32 v201, v251, v201
  v_mfma_f32_32x32x16_bf16 v[208:223], v[228:231], v[28:31], v[208:223]
  ds_read_b64_tr_b16 v[228:229], v242 offset:36352
  ds_read_b64_tr_b16 v[230:231], v242 offset:38400
  s_waitcnt lgkmcnt(4)
  v_mul_f32 v202, v251, v202
  v_mul_f32 v203, v251, v203
  v_mul_f32 v204, v251, v204
  v_xor_b32 v243, 0x18040, v241
  v_mfma_f32_32x32x16_bf16 v[160:175], v[232:235], v[48:51], v[160:175]
  ds_read_b64_tr_b16 v[232:233], v243 offset:24064
  ds_read_b64_tr_b16 v[234:235], v243 offset:26112
  v_mul_f32 v205, v251, v205
  v_mul_f32 v206, v251, v206
  v_mul_f32 v207, v251, v207
  v_cvt_pk_bf16_f32 v71, v78, v79
  v_fma_f32 v96, v96, s40, v246
  v_fma_f32 v97, v97, s40, v246
  v_mfma_f32_32x32x16_bf16 v[160:175], v[236:239], v[52:55], v[160:175]
  ds_read_b64_tr_b16 v[236:237], v243 offset:28160
  ds_read_b64_tr_b16 v[238:239], v243 offset:30208
  s_waitcnt lgkmcnt(4)
  v_mul_f32 v208, v251, v208
  v_mul_f32 v209, v251, v209
  v_mul_f32 v210, v251, v210
  v_mul_f32 v211, v251, v211
  v_mfma_f32_32x32x16_bf16 v[160:175], v[224:227], v[56:59], v[160:175]
  ds_read_b64_tr_b16 v[224:225], v243 offset:32256
  ds_read_b64_tr_b16 v[226:227], v243 offset:34304
  v_mul_f32 v212, v251, v212
  v_mul_f32 v213, v251, v213
  v_mul_f32 v214, v251, v214
  v_mul_f32 v215, v251, v215
  v_mul_f32 v216, v251, v216
  v_mfma_f32_32x32x16_bf16 v[160:175], v[228:231], v[60:63], v[160:175]
  ds_read_b64_tr_b16 v[228:229], v243 offset:36352
  ds_read_b64_tr_b16 v[230:231], v243 offset:38400
  s_waitcnt lgkmcnt(4)
  v_mul_f32 v217, v251, v217
  v_mul_f32 v218, v251, v218
  v_mul_f32 v219, v251, v219
  v_xor_b32 v240, 0x18080, v241
  v_mfma_f32_32x32x16_bf16 v[176:191], v[232:235], v[48:51], v[176:191]
  ds_read_b64_tr_b16 v[232:233], v240 offset:24064
  ds_read_b64_tr_b16 v[234:235], v240 offset:26112
  v_mul_f32 v220, v251, v220
  v_mul_f32 v221, v251, v221
  v_mul_f32 v222, v251, v222
  v_mul_f32 v223, v251, v223
  v_exp_f32 v96, v96
  v_mfma_f32_32x32x16_bf16 v[176:191], v[236:239], v[52:55], v[176:191]
  ds_read_b64_tr_b16 v[236:237], v240 offset:28160
  ds_read_b64_tr_b16 v[238:239], v240 offset:30208
  s_waitcnt lgkmcnt(4)
  v_fma_f32 v98, v98, s40, v246
  v_exp_f32 v97, v97
  v_fma_f32 v99, v99, s40, v246
  v_mfma_f32_32x32x16_bf16 v[176:191], v[224:227], v[56:59], v[176:191]
  ds_read_b64_tr_b16 v[224:225], v240 offset:32256
  ds_read_b64_tr_b16 v[226:227], v240 offset:34304
  v_exp_f32 v98, v98
  v_fma_f32 v100, v100, s40, v246
  v_exp_f32 v99, v99
  v_mfma_f32_32x32x16_bf16 v[176:191], v[228:231], v[60:63], v[176:191]
  ds_read_b64_tr_b16 v[228:229], v240 offset:36352
  ds_read_b64_tr_b16 v[230:231], v240 offset:38400
  s_waitcnt lgkmcnt(4)
  v_fma_f32 v101, v101, s40, v246
  v_add_f32 v245, v245, v96
  v_cvt_pk_bf16_f32 v72, v96, v97
  v_add_f32 v245, v245, v97
  v_xor_b32 v242, 0x180c0, v241
  v_mfma_f32_32x32x16_bf16 v[192:207], v[232:235], v[48:51], v[192:207]
  ds_read_b64_tr_b16 v[232:233], v242 offset:24064
  ds_read_b64_tr_b16 v[234:235], v242 offset:26112
  v_exp_f32 v100, v100
  v_fma_f32 v102, v102, s40, v246
  v_exp_f32 v101, v101
  v_mfma_f32_32x32x16_bf16 v[192:207], v[236:239], v[52:55], v[192:207]
  ds_read_b64_tr_b16 v[236:237], v242 offset:28160
  ds_read_b64_tr_b16 v[238:239], v242 offset:30208
  s_waitcnt lgkmcnt(4)
  v_fma_f32 v103, v103, s40, v246
  v_add_f32 v245, v245, v98
  v_cvt_pk_bf16_f32 v73, v98, v99
  v_add_f32 v245, v245, v99
  v_mfma_f32_32x32x16_bf16 v[192:207], v[224:227], v[56:59], v[192:207]
  ds_read_b64_tr_b16 v[224:225], v242 offset:32256
  ds_read_b64_tr_b16 v[226:227], v242 offset:34304
  v_exp_f32 v102, v102
  v_fma_f32 v104, v104, s40, v246
  v_exp_f32 v103, v103
  v_fma_f32 v105, v105, s40, v246
  v_mfma_f32_32x32x16_bf16 v[192:207], v[228:231], v[60:63], v[192:207]
  ds_read_b64_tr_b16 v[228:229], v242 offset:36352
  ds_read_b64_tr_b16 v[230:231], v242 offset:38400
  s_waitcnt lgkmcnt(4)
  v_add_f32 v245, v245, v100
  v_cvt_pk_bf16_f32 v74, v100, v101
  v_add_f32 v245, v245, v101
  v_xor_b32 v243, 0x18000, v241
  v_mfma_f32_32x32x16_bf16 v[208:223], v[232:235], v[48:51], v[208:223]
  s_barrier
  ds_read_b64_tr_b16 v[232:233], v243 offset:7168
  ds_read_b64_tr_b16 v[234:235], v243 offset:9216
  v_exp_f32 v104, v104
  v_fma_f32 v106, v106, s40, v246
  v_mfma_f32_32x32x16_bf16 v[208:223], v[236:239], v[52:55], v[208:223]
  ds_read_b64_tr_b16 v[236:237], v243 offset:11264
  ds_read_b64_tr_b16 v[238:239], v243 offset:13312
  s_waitcnt lgkmcnt(4)
  v_exp_f32 v105, v105
  v_fma_f32 v107, v107, s40, v246
  v_add_f32 v245, v245, v102
  v_mfma_f32_32x32x16_bf16 v[208:223], v[224:227], v[56:59], v[208:223]
  ds_read_b64_tr_b16 v[224:225], v243 offset:15360
  ds_read_b64_tr_b16 v[226:227], v243 offset:17408
  v_cvt_pk_bf16_f32 v75, v102, v103
  v_add_f32 v245, v245, v103
  v_exp_f32 v106, v106
  v_fma_f32 v108, v108, s40, v246
  v_mfma_f32_32x32x16_bf16 v[208:223], v[228:231], v[60:63], v[208:223]
  ds_read_b64_tr_b16 v[228:229], v243 offset:19456
  ds_read_b64_tr_b16 v[230:231], v243 offset:21504
  s_waitcnt lgkmcnt(4)
  v_exp_f32 v107, v107
  v_fma_f32 v109, v109, s40, v246
  v_xor_b32 v240, 0x18040, v241
  v_mfma_f32_32x32x16_bf16 v[160:175], v[232:235], v[80:83], v[160:175]
  ds_read_b64_tr_b16 v[232:233], v240 offset:7168
  ds_read_b64_tr_b16 v[234:235], v240 offset:9216
  v_add_f32 v245, v245, v104
  v_cvt_pk_bf16_f32 v76, v104, v105
  v_add_f32 v245, v245, v105
  v_exp_f32 v108, v108
  v_mfma_f32_32x32x16_bf16 v[160:175], v[236:239], v[84:87], v[160:175]
  ds_read_b64_tr_b16 v[236:237], v240 offset:11264
  ds_read_b64_tr_b16 v[238:239], v240 offset:13312
  s_waitcnt lgkmcnt(4)
  v_fma_f32 v110, v110, s40, v246
  v_exp_f32 v109, v109
  v_fma_f32 v111, v111, s40, v246
  v_add_f32 v245, v245, v106
  v_mfma_f32_32x32x16_bf16 v[160:175], v[224:227], v[88:91], v[160:175]
  ds_read_b64_tr_b16 v[224:225], v240 offset:15360
  ds_read_b64_tr_b16 v[226:227], v240 offset:17408
  v_cvt_pk_bf16_f32 v77, v106, v107
  v_add_f32 v245, v245, v107
  v_exp_f32 v110, v110
  v_mfma_f32_32x32x16_bf16 v[160:175], v[228:231], v[92:95], v[160:175]
  ds_read_b64_tr_b16 v[228:229], v240 offset:19456
  ds_read_b64_tr_b16 v[230:231], v240 offset:21504
  s_waitcnt lgkmcnt(4)
  v_exp_f32 v111, v111
  v_add_f32 v245, v245, v108
  v_xor_b32 v242, 0x18080, v241
  v_mfma_f32_32x32x16_bf16 v[176:191], v[232:235], v[80:83], v[176:191]
  ds_read_b64_tr_b16 v[232:233], v242 offset:7168
  ds_read_b64_tr_b16 v[234:235], v242 offset:9216
  v_cvt_pk_bf16_f32 v78, v108, v109
  v_add_f32 v245, v245, v109
  v_add_f32 v245, v245, v110
  v_cvt_pk_bf16_f32 v79, v110, v111
  v_add_f32 v245, v245, v111
  v_fma_f32 v144, v144, s40, v246
  v_mfma_f32_32x32x16_bf16 v[176:191], v[236:239], v[84:87], v[176:191]
  ds_read_b64_tr_b16 v[236:237], v242 offset:11264
  ds_read_b64_tr_b16 v[238:239], v242 offset:13312
  s_waitcnt lgkmcnt(4)
  v_mul_f32 v160, v252, v160
  v_mul_f32 v161, v252, v161
  v_mul_f32 v162, v252, v162
  v_mul_f32 v163, v252, v163
  v_mfma_f32_32x32x16_bf16 v[176:191], v[224:227], v[88:91], v[176:191]
  ds_read_b64_tr_b16 v[224:225], v242 offset:15360
  ds_read_b64_tr_b16 v[226:227], v242 offset:17408
  v_mul_f32 v164, v252, v164
  v_mul_f32 v165, v252, v165
  v_mul_f32 v166, v252, v166
  v_mul_f32 v167, v252, v167
  v_mul_f32 v168, v252, v168
  v_mfma_f32_32x32x16_bf16 v[176:191], v[228:231], v[92:95], v[176:191]
  ds_read_b64_tr_b16 v[228:229], v242 offset:19456
  ds_read_b64_tr_b16 v[230:231], v242 offset:21504
  s_waitcnt lgkmcnt(4)
  v_mul_f32 v169, v252, v169
  v_mul_f32 v170, v252, v170
  v_mul_f32 v171, v252, v171
  v_mul_f32 v172, v252, v172
  v_xor_b32 v243, 0x180c0, v241
  v_mfma_f32_32x32x16_bf16 v[192:207], v[232:235], v[80:83], v[192:207]
  ds_read_b64_tr_b16 v[232:233], v243 offset:7168
  ds_read_b64_tr_b16 v[234:235], v243 offset:9216
  v_mul_f32 v173, v252, v173
  v_mul_f32 v174, v252, v174
  v_mul_f32 v175, v252, v175
  v_fma_f32 v145, v145, s40, v246
  v_mfma_f32_32x32x16_bf16 v[192:207], v[236:239], v[84:87], v[192:207]
  ds_read_b64_tr_b16 v[236:237], v243 offset:11264
  ds_read_b64_tr_b16 v[238:239], v243 offset:13312
  s_waitcnt lgkmcnt(4)
  v_mul_f32 v176, v252, v176
  v_mul_f32 v177, v252, v177
  v_mul_f32 v178, v252, v178
  v_mul_f32 v179, v252, v179
  v_mfma_f32_32x32x16_bf16 v[192:207], v[224:227], v[88:91], v[192:207]
  ds_read_b64_tr_b16 v[224:225], v243 offset:15360
  ds_read_b64_tr_b16 v[226:227], v243 offset:17408
  v_mul_f32 v180, v252, v180
  v_mul_f32 v181, v252, v181
  v_mul_f32 v182, v252, v182
  v_mul_f32 v183, v252, v183
  v_mul_f32 v184, v252, v184
  v_mul_f32 v185, v252, v185
  v_mfma_f32_32x32x16_bf16 v[192:207], v[228:231], v[92:95], v[192:207]
  ds_read_b64_tr_b16 v[228:229], v243 offset:19456
  ds_read_b64_tr_b16 v[230:231], v243 offset:21504
  s_waitcnt lgkmcnt(4)
  v_mul_f32 v186, v252, v186
  v_mul_f32 v187, v252, v187
  v_mul_f32 v188, v252, v188
  v_xor_b32 v240, 0xc000, v241
  v_mfma_f32_32x32x16_bf16 v[208:223], v[232:235], v[80:83], v[208:223]
  s_barrier
  ds_read_b64_tr_b16 v[232:233], v240 offset:5632
  ds_read_b64_tr_b16 v[234:235], v240 offset:7680
  v_mul_f32 v189, v252, v189
  v_mul_f32 v190, v252, v190
  v_mul_f32 v191, v252, v191
  v_mfma_f32_32x32x16_bf16 v[208:223], v[236:239], v[84:87], v[208:223]
  ds_read_b64_tr_b16 v[236:237], v240 offset:9728
  ds_read_b64_tr_b16 v[238:239], v240 offset:11776
  s_waitcnt lgkmcnt(4)
  v_mul_f32 v192, v252, v192
  v_mul_f32 v193, v252, v193
  v_mul_f32 v194, v252, v194
  v_mul_f32 v195, v252, v195
  v_mul_f32 v196, v252, v196
  v_mfma_f32_32x32x16_bf16 v[208:223], v[224:227], v[88:91], v[208:223]
  ds_read_b64_tr_b16 v[224:225], v240 offset:13824
  ds_read_b64_tr_b16 v[226:227], v240 offset:15872
  v_mul_f32 v197, v252, v197
  v_mul_f32 v198, v252, v198
  v_mul_f32 v199, v252, v199
  v_mul_f32 v200, v252, v200
  v_mul_f32 v201, v252, v201
  v_mfma_f32_32x32x16_bf16 v[208:223], v[228:231], v[92:95], v[208:223]
  ds_read_b64_tr_b16 v[228:229], v240 offset:17920
  ds_read_b64_tr_b16 v[230:231], v240 offset:19968
  s_waitcnt lgkmcnt(4)
  v_mul_f32 v202, v252, v202
  v_mul_f32 v203, v252, v203
  v_mul_f32 v204, v252, v204
  v_xor_b32 v242, 0xc040, v241
  v_mfma_f32_32x32x16_bf16 v[160:175], v[232:235], v[112:115], v[160:175]
  ds_read_b64_tr_b16 v[232:233], v242 offset:5632
  ds_read_b64_tr_b16 v[234:235], v242 offset:7680
  v_mul_f32 v205, v252, v205
  v_mul_f32 v206, v252, v206
  v_mul_f32 v207, v252, v207
  v_exp_f32 v144, v144
  v_fma_f32 v146, v146, s40, v246
  v_mfma_f32_32x32x16_bf16 v[160:175], v[236:239], v[116:119], v[160:175]
  ds_read_b64_tr_b16 v[236:237], v242 offset:9728
  ds_read_b64_tr_b16 v[238:239], v242 offset:11776
  s_waitcnt lgkmcnt(4)
  v_mul_f32 v208, v252, v208
  v_mul_f32 v209, v252, v209
  v_mul_f32 v210, v252, v210
  v_mul_f32 v211, v252, v211
  v_mfma_f32_32x32x16_bf16 v[160:175], v[224:227], v[120:123], v[160:175]
  ds_read_b64_tr_b16 v[224:225], v242 offset:13824
  ds_read_b64_tr_b16 v[226:227], v242 offset:15872
  v_mul_f32 v212, v252, v212
  v_mul_f32 v213, v252, v213
  v_mul_f32 v214, v252, v214
  v_mul_f32 v215, v252, v215
  v_mul_f32 v216, v252, v216
  v_mfma_f32_32x32x16_bf16 v[160:175], v[228:231], v[124:127], v[160:175]
  ds_read_b64_tr_b16 v[228:229], v242 offset:17920
  ds_read_b64_tr_b16 v[230:231], v242 offset:19968
  s_waitcnt lgkmcnt(4)
  v_mul_f32 v217, v252, v217
  v_mul_f32 v218, v252, v218
  v_mul_f32 v219, v252, v219
  v_mul_f32 v220, v252, v220
  v_xor_b32 v243, 0xc080, v241
  v_mfma_f32_32x32x16_bf16 v[176:191], v[232:235], v[112:115], v[176:191]
  ds_read_b64_tr_b16 v[232:233], v243 offset:5632
  ds_read_b64_tr_b16 v[234:235], v243 offset:7680
  v_mul_f32 v221, v252, v221
  v_mul_f32 v222, v252, v222
  v_mul_f32 v223, v252, v223
  v_exp_f32 v145, v145
  v_mfma_f32_32x32x16_bf16 v[176:191], v[236:239], v[116:119], v[176:191]
  ds_read_b64_tr_b16 v[236:237], v243 offset:9728
  ds_read_b64_tr_b16 v[238:239], v243 offset:11776
  s_waitcnt lgkmcnt(4)
  v_fma_f32 v147, v147, s40, v246
  v_exp_f32 v146, v146
  v_fma_f32 v148, v148, s40, v246
  v_mfma_f32_32x32x16_bf16 v[176:191], v[224:227], v[120:123], v[176:191]
  ds_read_b64_tr_b16 v[224:225], v243 offset:13824
  ds_read_b64_tr_b16 v[226:227], v243 offset:15872
  v_exp_f32 v147, v147
  v_fma_f32 v149, v149, s40, v246
  v_add_f32 v245, v245, v144
  v_add_f32 v245, v245, v145
  v_cvt_pk_bf16_f32 v144, v144, v145
  v_mfma_f32_32x32x16_bf16 v[176:191], v[228:231], v[124:127], v[176:191]
  ds_read_b64_tr_b16 v[228:229], v243 offset:17920
  ds_read_b64_tr_b16 v[230:231], v243 offset:19968
  s_waitcnt lgkmcnt(4)
  v_exp_f32 v148, v148
  v_fma_f32 v150, v150, s40, v246
  v_xor_b32 v240, 0xc0c0, v241
  v_mfma_f32_32x32x16_bf16 v[192:207], v[232:235], v[112:115], v[192:207]
  ds_read_b64_tr_b16 v[232:233], v240 offset:5632
  ds_read_b64_tr_b16 v[234:235], v240 offset:7680
  v_exp_f32 v149, v149
  v_fma_f32 v151, v151, s40, v246
  v_add_f32 v245, v245, v146
  v_add_f32 v245, v245, v147
  v_cvt_pk_bf16_f32 v145, v146, v147
  v_mfma_f32_32x32x16_bf16 v[192:207], v[236:239], v[116:119], v[192:207]
  ds_read_b64_tr_b16 v[236:237], v240 offset:9728
  ds_read_b64_tr_b16 v[238:239], v240 offset:11776
  s_waitcnt lgkmcnt(4)
  v_exp_f32 v150, v150
  v_fma_f32 v152, v152, s40, v246
  v_mfma_f32_32x32x16_bf16 v[192:207], v[224:227], v[120:123], v[192:207]
  ds_read_b64_tr_b16 v[224:225], v240 offset:13824
  ds_read_b64_tr_b16 v[226:227], v240 offset:15872
  v_exp_f32 v151, v151
  v_fma_f32 v153, v153, s40, v246
  v_add_f32 v245, v245, v148
  v_add_f32 v245, v245, v149
  v_mfma_f32_32x32x16_bf16 v[192:207], v[228:231], v[124:127], v[192:207]
  ds_read_b64_tr_b16 v[228:229], v240 offset:17920
  ds_read_b64_tr_b16 v[230:231], v240 offset:19968
  s_waitcnt lgkmcnt(4)
  v_cvt_pk_bf16_f32 v146, v148, v149
  v_exp_f32 v152, v152
  v_fma_f32 v154, v154, s40, v246
  v_xor_b32 v242, 0x18000, v241
  v_mfma_f32_32x32x16_bf16 v[208:223], v[232:235], v[112:115], v[208:223]
  s_barrier
  ds_read_b64_tr_b16 v[232:233], v242 offset:40960
  ds_read_b64_tr_b16 v[234:235], v242 offset:43008
  v_exp_f32 v153, v153
  v_fma_f32 v155, v155, s40, v246
  v_mfma_f32_32x32x16_bf16 v[208:223], v[236:239], v[116:119], v[208:223]
  ds_read_b64_tr_b16 v[236:237], v242 offset:45056
  ds_read_b64_tr_b16 v[238:239], v242 offset:47104
  s_waitcnt lgkmcnt(4)
  v_add_f32 v245, v245, v150
  v_add_f32 v245, v245, v151
  v_cvt_pk_bf16_f32 v147, v150, v151
  v_mfma_f32_32x32x16_bf16 v[208:223], v[224:227], v[120:123], v[208:223]
  ds_read_b64_tr_b16 v[224:225], v242 offset:49152
  ds_read_b64_tr_b16 v[226:227], v242 offset:51200
  v_exp_f32 v154, v154
  v_fma_f32 v156, v156, s40, v246
  v_exp_f32 v155, v155
  v_fma_f32 v157, v157, s40, v246
  v_mfma_f32_32x32x16_bf16 v[208:223], v[228:231], v[124:127], v[208:223]
  ds_read_b64_tr_b16 v[228:229], v242 offset:53248
  ds_read_b64_tr_b16 v[230:231], v242 offset:55296
  s_waitcnt lgkmcnt(4)
  v_add_f32 v245, v245, v152
  v_add_f32 v245, v245, v153
  v_cvt_pk_bf16_f32 v148, v152, v153
  v_xor_b32 v243, 0x18040, v241
  v_mfma_f32_32x32x16_bf16 v[160:175], v[232:235], v[0:3], v[160:175]
  ds_read_b64_tr_b16 v[232:233], v243 offset:40960
  ds_read_b64_tr_b16 v[234:235], v243 offset:43008
  v_exp_f32 v156, v156
  v_fma_f32 v158, v158, s40, v246
  v_exp_f32 v157, v157
  v_fma_f32 v159, v159, s40, v246
  v_mfma_f32_32x32x16_bf16 v[160:175], v[236:239], v[4:7], v[160:175]
  ds_read_b64_tr_b16 v[236:237], v243 offset:45056
  ds_read_b64_tr_b16 v[238:239], v243 offset:47104
  s_waitcnt lgkmcnt(4)
  v_add_f32 v245, v245, v154
  v_add_f32 v245, v245, v155
  v_cvt_pk_bf16_f32 v149, v154, v155
  v_mfma_f32_32x32x16_bf16 v[160:175], v[224:227], v[8:11], v[160:175]
  ds_read_b64_tr_b16 v[224:225], v243 offset:49152
  ds_read_b64_tr_b16 v[226:227], v243 offset:51200
  v_exp_f32 v158, v158
  v_exp_f32 v159, v159
  v_add_f32 v245, v245, v156
  v_mfma_f32_32x32x16_bf16 v[160:175], v[228:231], v[12:15], v[160:175]
  ds_read_b64_tr_b16 v[228:229], v243 offset:53248
  ds_read_b64_tr_b16 v[230:231], v243 offset:55296
  s_waitcnt lgkmcnt(4)
  v_add_f32 v245, v245, v157
  v_cvt_pk_bf16_f32 v150, v156, v157
  v_add_f32 v245, v245, v158
  v_add_f32 v245, v245, v159
  v_xor_b32 v240, 0x18080, v241
  v_mfma_f32_32x32x16_bf16 v[176:191], v[232:235], v[0:3], v[176:191]
  ds_read_b64_tr_b16 v[232:233], v240 offset:40960
  ds_read_b64_tr_b16 v[234:235], v240 offset:43008
  v_cvt_pk_bf16_f32 v151, v158, v159
  v_fma_f32 v32, v32, s40, v246
  v_fma_f32 v33, v33, s40, v246
  v_exp_f32 v32, v32
  v_mfma_f32_32x32x16_bf16 v[176:191], v[236:239], v[4:7], v[176:191]
  ds_read_b64_tr_b16 v[236:237], v240 offset:45056
  ds_read_b64_tr_b16 v[238:239], v240 offset:47104
  s_waitcnt lgkmcnt(4)
  v_mul_f32 v160, v253, v160
  v_mul_f32 v161, v253, v161
  v_mul_f32 v162, v253, v162
  v_mul_f32 v163, v253, v163
  v_mul_f32 v164, v253, v164
  v_mfma_f32_32x32x16_bf16 v[176:191], v[224:227], v[8:11], v[176:191]
  ds_read_b64_tr_b16 v[224:225], v240 offset:49152
  ds_read_b64_tr_b16 v[226:227], v240 offset:51200
  v_mul_f32 v165, v253, v165
  v_mul_f32 v166, v253, v166
  v_mul_f32 v167, v253, v167
  v_mul_f32 v168, v253, v168
  v_mul_f32 v169, v253, v169
  v_mfma_f32_32x32x16_bf16 v[176:191], v[228:231], v[12:15], v[176:191]
  ds_read_b64_tr_b16 v[228:229], v240 offset:53248
  ds_read_b64_tr_b16 v[230:231], v240 offset:55296
  s_waitcnt lgkmcnt(4)
  v_mul_f32 v170, v253, v170
  v_mul_f32 v171, v253, v171
  v_mul_f32 v172, v253, v172
  v_mul_f32 v173, v253, v173
  v_xor_b32 v242, 0x180c0, v241
  v_mfma_f32_32x32x16_bf16 v[192:207], v[232:235], v[0:3], v[192:207]
  ds_read_b64_tr_b16 v[232:233], v242 offset:40960
  ds_read_b64_tr_b16 v[234:235], v242 offset:43008
  v_mul_f32 v174, v253, v174
  v_mul_f32 v175, v253, v175
  v_fma_f32 v34, v34, s40, v246
  v_exp_f32 v33, v33
  v_mfma_f32_32x32x16_bf16 v[192:207], v[236:239], v[4:7], v[192:207]
  ds_read_b64_tr_b16 v[236:237], v242 offset:45056
  ds_read_b64_tr_b16 v[238:239], v242 offset:47104
  s_waitcnt lgkmcnt(4)
  v_mul_f32 v176, v253, v176
  v_mul_f32 v177, v253, v177
  v_mul_f32 v178, v253, v178
  v_mul_f32 v179, v253, v179
  v_mfma_f32_32x32x16_bf16 v[192:207], v[224:227], v[8:11], v[192:207]
  ds_read_b64_tr_b16 v[224:225], v242 offset:49152
  ds_read_b64_tr_b16 v[226:227], v242 offset:51200
  v_mul_f32 v180, v253, v180
  v_mul_f32 v181, v253, v181
  v_mul_f32 v182, v253, v182
  v_mul_f32 v183, v253, v183
  v_mul_f32 v184, v253, v184
  v_mul_f32 v185, v253, v185
  v_mfma_f32_32x32x16_bf16 v[192:207], v[228:231], v[12:15], v[192:207]
  ds_read_b64_tr_b16 v[228:229], v242 offset:53248
  ds_read_b64_tr_b16 v[230:231], v242 offset:55296
  s_waitcnt lgkmcnt(4)
  v_mul_f32 v186, v253, v186
  v_mul_f32 v187, v253, v187
  v_mul_f32 v188, v253, v188
  v_xor_b32 v243, 0x0, v241
  v_mfma_f32_32x32x16_bf16 v[208:223], v[232:235], v[0:3], v[208:223]
  s_barrier
  ds_read_b64_tr_b16 v[232:233], v243 offset:4096
  ds_read_b64_tr_b16 v[234:235], v243 offset:6144
  v_mul_f32 v189, v253, v189
  v_mul_f32 v190, v253, v190
  v_mul_f32 v191, v253, v191
  v_fma_f32 v35, v35, s40, v246
  v_mfma_f32_32x32x16_bf16 v[208:223], v[236:239], v[4:7], v[208:223]
  ds_read_b64_tr_b16 v[236:237], v243 offset:8192
  ds_read_b64_tr_b16 v[238:239], v243 offset:10240
  s_waitcnt lgkmcnt(4)
  v_mul_f32 v192, v253, v192
  v_mul_f32 v193, v253, v193
  v_mul_f32 v194, v253, v194
  v_mul_f32 v195, v253, v195
  v_mfma_f32_32x32x16_bf16 v[208:223], v[224:227], v[8:11], v[208:223]
  ds_read_b64_tr_b16 v[224:225], v243 offset:12288
  ds_read_b64_tr_b16 v[226:227], v243 offset:14336
  v_mul_f32 v196, v253, v196
  v_mul_f32 v197, v253, v197
  v_mul_f32 v198, v253, v198
  v_mul_f32 v199, v253, v199
  v_mul_f32 v200, v253, v200
  v_mul_f32 v201, v253, v201
  v_mfma_f32_32x32x16_bf16 v[208:223], v[228:231], v[12:15], v[208:223]
  ds_read_b64_tr_b16 v[228:229], v243 offset:16384
  ds_read_b64_tr_b16 v[230:231], v243 offset:18432
  s_waitcnt lgkmcnt(4)
  v_mul_f32 v202, v253, v202
  v_mul_f32 v203, v253, v203
  v_mul_f32 v204, v253, v204
  v_xor_b32 v240, 0x40, v241
  v_mfma_f32_32x32x16_bf16 v[160:175], v[232:235], v[64:67], v[160:175]
  ds_read_b64_tr_b16 v[232:233], v240 offset:4096
  ds_read_b64_tr_b16 v[234:235], v240 offset:6144
  v_mul_f32 v205, v253, v205
  v_mul_f32 v206, v253, v206
  v_mul_f32 v207, v253, v207
  v_exp_f32 v34, v34
  v_mfma_f32_32x32x16_bf16 v[160:175], v[236:239], v[68:71], v[160:175]
  ds_read_b64_tr_b16 v[236:237], v240 offset:8192
  ds_read_b64_tr_b16 v[238:239], v240 offset:10240
  s_waitcnt lgkmcnt(4)
  v_mul_f32 v208, v253, v208
  v_mul_f32 v209, v253, v209
  v_mul_f32 v210, v253, v210
  v_mul_f32 v211, v253, v211
  v_mul_f32 v212, v253, v212
  v_mfma_f32_32x32x16_bf16 v[160:175], v[224:227], v[72:75], v[160:175]
  ds_read_b64_tr_b16 v[224:225], v240 offset:12288
  ds_read_b64_tr_b16 v[226:227], v240 offset:14336
  v_mul_f32 v213, v253, v213
  v_mul_f32 v214, v253, v214
  v_mul_f32 v215, v253, v215
  v_mul_f32 v216, v253, v216
  v_mul_f32 v217, v253, v217
  v_mfma_f32_32x32x16_bf16 v[160:175], v[228:231], v[76:79], v[160:175]
  ds_read_b64_tr_b16 v[228:229], v240 offset:16384
  ds_read_b64_tr_b16 v[230:231], v240 offset:18432
  s_waitcnt lgkmcnt(4)
  v_mul_f32 v218, v253, v218
  v_mul_f32 v219, v253, v219
  v_mul_f32 v220, v253, v220
  v_mul_f32 v221, v253, v221
  v_xor_b32 v242, 0x80, v241
  v_mfma_f32_32x32x16_bf16 v[176:191], v[232:235], v[64:67], v[176:191]
  ds_read_b64_tr_b16 v[232:233], v242 offset:4096
  ds_read_b64_tr_b16 v[234:235], v242 offset:6144
  v_mul_f32 v222, v253, v222
  v_mul_f32 v223, v253, v223
  v_fma_f32 v36, v36, s40, v246
  v_exp_f32 v35, v35
  v_mfma_f32_32x32x16_bf16 v[176:191], v[236:239], v[68:71], v[176:191]
  ds_read_b64_tr_b16 v[236:237], v242 offset:8192
  ds_read_b64_tr_b16 v[238:239], v242 offset:10240
  s_waitcnt lgkmcnt(4)
  v_fma_f32 v37, v37, s40, v246
  v_add_f32 v245, v245, v32
  v_cvt_pk_bf16_f32 v152, v32, v33
  v_add_f32 v245, v245, v33
  v_mfma_f32_32x32x16_bf16 v[176:191], v[224:227], v[72:75], v[176:191]
  ds_read_b64_tr_b16 v[224:225], v242 offset:12288
  ds_read_b64_tr_b16 v[226:227], v242 offset:14336
  v_exp_f32 v36, v36
  v_fma_f32 v38, v38, s40, v246
  v_exp_f32 v37, v37
  v_mfma_f32_32x32x16_bf16 v[176:191], v[228:231], v[76:79], v[176:191]
  ds_read_b64_tr_b16 v[228:229], v242 offset:16384
  ds_read_b64_tr_b16 v[230:231], v242 offset:18432
  s_waitcnt lgkmcnt(4)
  v_fma_f32 v39, v39, s40, v246
  v_add_f32 v245, v245, v34
  v_cvt_pk_bf16_f32 v153, v34, v35
  v_add_f32 v245, v245, v35
  v_xor_b32 v243, 0xc0, v241
  v_mfma_f32_32x32x16_bf16 v[192:207], v[232:235], v[64:67], v[192:207]
  ds_read_b64_tr_b16 v[232:233], v243 offset:4096
  ds_read_b64_tr_b16 v[234:235], v243 offset:6144
  v_exp_f32 v38, v38
  v_fma_f32 v40, v40, s40, v246
  v_exp_f32 v39, v39
  v_mfma_f32_32x32x16_bf16 v[192:207], v[236:239], v[68:71], v[192:207]
  ds_read_b64_tr_b16 v[236:237], v243 offset:8192
  ds_read_b64_tr_b16 v[238:239], v243 offset:10240
  s_waitcnt lgkmcnt(4)
  v_fma_f32 v41, v41, s40, v246
  v_add_f32 v245, v245, v36
  v_cvt_pk_bf16_f32 v154, v36, v37
  v_add_f32 v245, v245, v37
  v_mfma_f32_32x32x16_bf16 v[192:207], v[224:227], v[72:75], v[192:207]
  ds_read_b64_tr_b16 v[224:225], v243 offset:12288
  ds_read_b64_tr_b16 v[226:227], v243 offset:14336
  v_exp_f32 v40, v40
  v_fma_f32 v42, v42, s40, v246
  v_exp_f32 v41, v41
  v_mfma_f32_32x32x16_bf16 v[192:207], v[228:231], v[76:79], v[192:207]
  ds_read_b64_tr_b16 v[228:229], v243 offset:16384
  ds_read_b64_tr_b16 v[230:231], v243 offset:18432
  s_waitcnt lgkmcnt(4)
  v_fma_f32 v43, v43, s40, v246
  v_add_f32 v245, v245, v38
  v_cvt_pk_bf16_f32 v155, v38, v39
  v_add_f32 v245, v245, v39
  v_xor_b32 v240, 0x0, v241
  v_mfma_f32_32x32x16_bf16 v[208:223], v[232:235], v[64:67], v[208:223]
  s_barrier
  ds_read_b64_tr_b16 v[232:233], v240 offset:37888
  ds_read_b64_tr_b16 v[234:235], v240 offset:39936
  v_exp_f32 v42, v42
  v_fma_f32 v44, v44, s40, v246
  v_mfma_f32_32x32x16_bf16 v[208:223], v[236:239], v[68:71], v[208:223]
  ds_read_b64_tr_b16 v[236:237], v240 offset:41984
  ds_read_b64_tr_b16 v[238:239], v240 offset:44032
  s_waitcnt lgkmcnt(4)
  v_exp_f32 v43, v43
  v_fma_f32 v45, v45, s40, v246
  v_add_f32 v245, v245, v40
  v_cvt_pk_bf16_f32 v156, v40, v41
  v_mfma_f32_32x32x16_bf16 v[208:223], v[224:227], v[72:75], v[208:223]
  ds_read_b64_tr_b16 v[224:225], v240 offset:46080
  ds_read_b64_tr_b16 v[226:227], v240 offset:48128
  v_add_f32 v245, v245, v41
  v_exp_f32 v44, v44
  v_fma_f32 v46, v46, s40, v246
  v_exp_f32 v45, v45
  v_mfma_f32_32x32x16_bf16 v[208:223], v[228:231], v[76:79], v[208:223]
  ds_read_b64_tr_b16 v[228:229], v240 offset:50176
  ds_read_b64_tr_b16 v[230:231], v240 offset:52224
  s_waitcnt lgkmcnt(4)
  v_fma_f32 v47, v47, s40, v246
  v_add_f32 v245, v245, v42
  v_cvt_pk_bf16_f32 v157, v42, v43
  v_xor_b32 v242, 0x40, v241
  v_mfma_f32_32x32x16_bf16 v[160:175], v[232:235], v[144:147], v[160:175]
  ds_read_b64_tr_b16 v[232:233], v242 offset:37888
  ds_read_b64_tr_b16 v[234:235], v242 offset:39936
  v_add_f32 v245, v245, v43
  v_exp_f32 v46, v46
  v_exp_f32 v47, v47
  v_add_f32 v245, v245, v44
  v_mfma_f32_32x32x16_bf16 v[160:175], v[236:239], v[148:151], v[160:175]
  ds_read_b64_tr_b16 v[236:237], v242 offset:41984
  ds_read_b64_tr_b16 v[238:239], v242 offset:44032
  s_waitcnt lgkmcnt(4)
  v_cvt_pk_bf16_f32 v158, v44, v45
  v_add_f32 v245, v245, v45
  v_add_f32 v245, v245, v46
  v_cvt_pk_bf16_f32 v159, v46, v47
  v_add_f32 v245, v245, v47
  v_mfma_f32_32x32x16_bf16 v[160:175], v[224:227], v[152:155], v[160:175]
  ds_read_b64_tr_b16 v[224:225], v242 offset:46080
  ds_read_b64_tr_b16 v[226:227], v242 offset:48128
  v_mov_b32 v247, v245
  s_nop 1
  v_permlane32_swap_b32 v247, v245
  v_add_f32 v245, v245, v247
  v_mfma_f32_32x32x16_bf16 v[160:175], v[228:231], v[156:159], v[160:175]
  ds_read_b64_tr_b16 v[228:229], v242 offset:50176
  ds_read_b64_tr_b16 v[230:231], v242 offset:52224
  s_waitcnt lgkmcnt(4)
  v_rcp_f32 v245, v245
  v_xor_b32 v243, 0x80, v241
  v_mfma_f32_32x32x16_bf16 v[176:191], v[232:235], v[144:147], v[176:191]
  ds_read_b64_tr_b16 v[232:233], v243 offset:37888
  ds_read_b64_tr_b16 v[234:235], v243 offset:39936
  v_mfma_f32_32x32x16_bf16 v[176:191], v[236:239], v[148:151], v[176:191]
  ds_read_b64_tr_b16 v[236:237], v243 offset:41984
  ds_read_b64_tr_b16 v[238:239], v243 offset:44032
  s_waitcnt lgkmcnt(4)
  v_cvt_pk_bf16_f32 v32, v160, v161
  v_cvt_pk_bf16_f32 v33, v162, v163
  v_cvt_pk_bf16_f32 v34, v164, v165
  v_mfma_f32_32x32x16_bf16 v[176:191], v[224:227], v[152:155], v[176:191]
  ds_read_b64_tr_b16 v[224:225], v243 offset:46080
  ds_read_b64_tr_b16 v[226:227], v243 offset:48128
  v_cvt_pk_bf16_f32 v35, v166, v167
  v_cvt_pk_bf16_f32 v36, v168, v169
  v_cvt_pk_bf16_f32 v37, v170, v171
  v_cvt_pk_bf16_f32 v38, v172, v173
  v_mfma_f32_32x32x16_bf16 v[176:191], v[228:231], v[156:159], v[176:191]
  ds_read_b64_tr_b16 v[228:229], v243 offset:50176
  ds_read_b64_tr_b16 v[230:231], v243 offset:52224
  s_waitcnt lgkmcnt(4)
  v_cvt_pk_bf16_f32 v39, v174, v175
  v_xor_b32 v240, 0xc0, v241
  v_mfma_f32_32x32x16_bf16 v[192:207], v[232:235], v[144:147], v[192:207]
  ds_read_b64_tr_b16 v[232:233], v240 offset:37888
  ds_read_b64_tr_b16 v[234:235], v240 offset:39936
  v_mfma_f32_32x32x16_bf16 v[192:207], v[236:239], v[148:151], v[192:207]
  ds_read_b64_tr_b16 v[236:237], v240 offset:41984
  ds_read_b64_tr_b16 v[238:239], v240 offset:44032
  s_waitcnt lgkmcnt(4)
  v_cvt_pk_bf16_f32 v40, v176, v177
  v_cvt_pk_bf16_f32 v41, v178, v179
  v_cvt_pk_bf16_f32 v42, v180, v181
  v_mfma_f32_32x32x16_bf16 v[192:207], v[224:227], v[152:155], v[192:207]
  ds_read_b64_tr_b16 v[224:225], v240 offset:46080
  ds_read_b64_tr_b16 v[226:227], v240 offset:48128
  v_cvt_pk_bf16_f32 v43, v182, v183
  v_cvt_pk_bf16_f32 v44, v184, v185
  v_cvt_pk_bf16_f32 v45, v186, v187
  v_cvt_pk_bf16_f32 v46, v188, v189
  v_mfma_f32_32x32x16_bf16 v[192:207], v[228:231], v[156:159], v[192:207]
  ds_read_b64_tr_b16 v[228:229], v240 offset:50176
  ds_read_b64_tr_b16 v[230:231], v240 offset:52224
  s_waitcnt lgkmcnt(4)
  v_cvt_pk_bf16_f32 v47, v190, v191
  v_xor_b32 v242, 0xc000, v241
  v_mfma_f32_32x32x16_bf16 v[208:223], v[232:235], v[144:147], v[208:223]
  s_barrier
  ds_read_b64_tr_b16 v[232:233], v242 offset:22528
  ds_read_b64_tr_b16 v[234:235], v242 offset:24576
  v_mfma_f32_32x32x16_bf16 v[208:223], v[236:239], v[148:151], v[208:223]
  ds_read_b64_tr_b16 v[236:237], v242 offset:26624
  ds_read_b64_tr_b16 v[238:239], v242 offset:28672
  s_waitcnt lgkmcnt(4)
  v_cvt_pk_bf16_f32 v96, v192, v193
  v_cvt_pk_bf16_f32 v97, v194, v195
  v_cvt_pk_bf16_f32 v98, v196, v197
  v_mfma_f32_32x32x16_bf16 v[208:223], v[224:227], v[152:155], v[208:223]
  ds_read_b64_tr_b16 v[224:225], v242 offset:30720
  ds_read_b64_tr_b16 v[226:227], v242 offset:32768
  v_cvt_pk_bf16_f32 v99, v198, v199
  v_cvt_pk_bf16_f32 v100, v200, v201
  v_cvt_pk_bf16_f32 v101, v202, v203
  v_cvt_pk_bf16_f32 v102, v204, v205
  v_mfma_f32_32x32x16_bf16 v[208:223], v[228:231], v[156:159], v[208:223]
  ds_read_b64_tr_b16 v[228:229], v242 offset:34816
  ds_read_b64_tr_b16 v[230:231], v242 offset:36864
  s_waitcnt lgkmcnt(4)
  v_cvt_pk_bf16_f32 v103, v206, v207
  v_xor_b32 v243, 0xc040, v241
  v_mfma_f32_32x32x16_bf16 v[160:175], v[232:235], v[128:131], 0
  ds_read_b64_tr_b16 v[232:233], v243 offset:22528
  ds_read_b64_tr_b16 v[234:235], v243 offset:24576
  v_mfma_f32_32x32x16_bf16 v[160:175], v[236:239], v[132:135], v[160:175]
  ds_read_b64_tr_b16 v[236:237], v243 offset:26624
  ds_read_b64_tr_b16 v[238:239], v243 offset:28672
  s_waitcnt lgkmcnt(4)
  v_cvt_pk_bf16_f32 v104, v208, v209
  v_cvt_pk_bf16_f32 v105, v210, v211
  v_cvt_pk_bf16_f32 v106, v212, v213
  v_mfma_f32_32x32x16_bf16 v[160:175], v[224:227], v[136:139], v[160:175]
  ds_read_b64_tr_b16 v[224:225], v243 offset:30720
  ds_read_b64_tr_b16 v[226:227], v243 offset:32768
  v_cvt_pk_bf16_f32 v107, v214, v215
  v_cvt_pk_bf16_f32 v108, v216, v217
  v_cvt_pk_bf16_f32 v109, v218, v219
  v_cvt_pk_bf16_f32 v110, v220, v221
  v_mfma_f32_32x32x16_bf16 v[160:175], v[228:231], v[140:143], v[160:175]
  ds_read_b64_tr_b16 v[228:229], v243 offset:34816
  ds_read_b64_tr_b16 v[230:231], v243 offset:36864
  s_waitcnt lgkmcnt(4)
  v_cvt_pk_bf16_f32 v111, v222, v223
  v_xor_b32 v240, 0xc080, v241
  v_mfma_f32_32x32x16_bf16 v[176:191], v[232:235], v[128:131], 0
  ds_read_b64_tr_b16 v[232:233], v240 offset:22528
  ds_read_b64_tr_b16 v[234:235], v240 offset:24576
  v_mfma_f32_32x32x16_bf16 v[176:191], v[236:239], v[132:135], v[176:191]
  ds_read_b64_tr_b16 v[236:237], v240 offset:26624
  ds_read_b64_tr_b16 v[238:239], v240 offset:28672
  s_waitcnt lgkmcnt(4)
  v_mfma_f32_32x32x16_bf16 v[176:191], v[224:227], v[136:139], v[176:191]
  ds_read_b64_tr_b16 v[224:225], v240 offset:30720
  ds_read_b64_tr_b16 v[226:227], v240 offset:32768
  v_mfma_f32_32x32x16_bf16 v[176:191], v[228:231], v[140:143], v[176:191]
  ds_read_b64_tr_b16 v[228:229], v240 offset:34816
  ds_read_b64_tr_b16 v[230:231], v240 offset:36864
  s_waitcnt lgkmcnt(4)
  v_xor_b32 v242, 0xc0c0, v241
  v_mfma_f32_32x32x16_bf16 v[192:207], v[232:235], v[128:131], 0
  ds_read_b64_tr_b16 v[232:233], v242 offset:22528
  ds_read_b64_tr_b16 v[234:235], v242 offset:24576
  s_waitcnt vmcnt(0)
  s_mov_b64 exec, s[44:45]
  global_load_dword v250, v249, s[58:59] sc1
  s_mov_b64 exec, -1
  v_mfma_f32_32x32x16_bf16 v[192:207], v[236:239], v[132:135], v[192:207]
  ds_read_b64_tr_b16 v[236:237], v242 offset:26624
  ds_read_b64_tr_b16 v[238:239], v242 offset:28672
  s_waitcnt lgkmcnt(4)
  v_mfma_f32_32x32x16_bf16 v[192:207], v[224:227], v[136:139], v[192:207]
  ds_read_b64_tr_b16 v[224:225], v242 offset:30720
  ds_read_b64_tr_b16 v[226:227], v242 offset:32768
  v_mfma_f32_32x32x16_bf16 v[192:207], v[228:231], v[140:143], v[192:207]
  ds_read_b64_tr_b16 v[228:229], v242 offset:34816
  ds_read_b64_tr_b16 v[230:231], v242 offset:36864
  s_waitcnt lgkmcnt(4)
  v_xor_b32 v243, 0xc000, v241
  v_mfma_f32_32x32x16_bf16 v[208:223], v[232:235], v[128:131], 0
  s_barrier
  ds_read_b64_tr_b16 v[232:233], v243 offset:39424
  ds_read_b64_tr_b16 v[234:235], v243 offset:41472
  v_mfma_f32_32x32x16_bf16 v[208:223], v[236:239], v[132:135], v[208:223]
  ds_read_b64_tr_b16 v[236:237], v243 offset:43520
  ds_read_b64_tr_b16 v[238:239], v243 offset:45568
  s_waitcnt lgkmcnt(4)
  v_mfma_f32_32x32x16_bf16 v[208:223], v[224:227], v[136:139], v[208:223]
  ds_read_b64_tr_b16 v[224:225], v243 offset:47616
  ds_read_b64_tr_b16 v[226:227], v243 offset:49664
  v_mfma_f32_32x32x16_bf16 v[208:223], v[228:231], v[140:143], v[208:223]
  ds_read_b64_tr_b16 v[228:229], v243 offset:51712
  ds_read_b64_tr_b16 v[230:231], v243 offset:53760
  s_waitcnt lgkmcnt(4)
  v_xor_b32 v240, 0xc040, v241
  v_mfma_f32_32x32x16_bf16 v[160:175], v[232:235], v[16:19], v[160:175]
  ds_read_b64_tr_b16 v[232:233], v240 offset:39424
  ds_read_b64_tr_b16 v[234:235], v240 offset:41472
  v_mfma_f32_32x32x16_bf16 v[160:175], v[236:239], v[20:23], v[160:175]
  ds_read_b64_tr_b16 v[236:237], v240 offset:43520
  ds_read_b64_tr_b16 v[238:239], v240 offset:45568
  s_waitcnt lgkmcnt(4)
  v_mfma_f32_32x32x16_bf16 v[160:175], v[224:227], v[24:27], v[160:175]
  ds_read_b64_tr_b16 v[224:225], v240 offset:47616
  ds_read_b64_tr_b16 v[226:227], v240 offset:49664
  v_mfma_f32_32x32x16_bf16 v[160:175], v[228:231], v[28:31], v[160:175]
  ds_read_b64_tr_b16 v[228:229], v240 offset:51712
  ds_read_b64_tr_b16 v[230:231], v240 offset:53760
  s_waitcnt lgkmcnt(4)
  v_xor_b32 v242, 0xc080, v241
  v_mfma_f32_32x32x16_bf16 v[176:191], v[232:235], v[16:19], v[176:191]
  ds_read_b64_tr_b16 v[232:233], v242 offset:39424
  ds_read_b64_tr_b16 v[234:235], v242 offset:41472
  v_mfma_f32_32x32x16_bf16 v[176:191], v[236:239], v[20:23], v[176:191]
  ds_read_b64_tr_b16 v[236:237], v242 offset:43520
  ds_read_b64_tr_b16 v[238:239], v242 offset:45568
  s_waitcnt lgkmcnt(4)
  s_nop 0
  v_mul_f32 v160, v251, v160
  v_mul_f32 v161, v251, v161
  v_mul_f32 v162, v251, v162
  v_mfma_f32_32x32x16_bf16 v[176:191], v[224:227], v[24:27], v[176:191]
  ds_read_b64_tr_b16 v[224:225], v242 offset:47616
  ds_read_b64_tr_b16 v[226:227], v242 offset:49664
  v_mul_f32 v163, v251, v163
  v_mul_f32 v164, v251, v164
  v_mul_f32 v165, v251, v165
  v_mul_f32 v166, v251, v166
  v_mfma_f32_32x32x16_bf16 v[176:191], v[228:231], v[28:31], v[176:191]
  ds_read_b64_tr_b16 v[228:229], v242 offset:51712
  ds_read_b64_tr_b16 v[230:231], v242 offset:53760
  s_waitcnt lgkmcnt(4)
  v_mul_f32 v167, v251, v167
  v_mul_f32 v168, v251, v168
  v_xor_b32 v243, 0xc0c0, v241
  v_mfma_f32_32x32x16_bf16 v[192:207], v[232:235], v[16:19], v[192:207]
  ds_read_b64_tr_b16 v[232:233], v243 offset:39424
  ds_read_b64_tr_b16 v[234:235], v243 offset:41472
  v_mul_f32 v169, v251, v169
  v_mul_f32 v170, v251, v170
  v_mul_f32 v171, v251, v171
  v_mul_f32 v172, v251, v172
  v_mfma_f32_32x32x16_bf16 v[192:207], v[236:239], v[20:23], v[192:207]
  ds_read_b64_tr_b16 v[236:237], v243 offset:43520
  ds_read_b64_tr_b16 v[238:239], v243 offset:45568
  s_waitcnt lgkmcnt(4)
  v_mul_f32 v173, v251, v173
  v_mul_f32 v174, v251, v174
  v_mul_f32 v175, v251, v175
  v_mfma_f32_32x32x16_bf16 v[192:207], v[224:227], v[24:27], v[192:207]
  ds_read_b64_tr_b16 v[224:225], v243 offset:47616
  ds_read_b64_tr_b16 v[226:227], v243 offset:49664
  v_mul_f32 v176, v251, v176
  v_mul_f32 v177, v251, v177
  v_mul_f32 v178, v251, v178
  v_mul_f32 v179, v251, v179
  v_mfma_f32_32x32x16_bf16 v[192:207], v[228:231], v[28:31], v[192:207]
  ds_read_b64_tr_b16 v[228:229], v243 offset:51712
  ds_read_b64_tr_b16 v[230:231], v243 offset:53760
  s_waitcnt lgkmcnt(4)
  v_mul_f32 v180, v251, v180
  v_mul_f32 v181, v251, v181
  v_xor_b32 v240, 0x0, v241
  v_mfma_f32_32x32x16_bf16 v[208:223], v[232:235], v[16:19], v[208:223]
  s_barrier
  ds_read_b64_tr_b16 v[232:233], v240 offset:20992
  ds_read_b64_tr_b16 v[234:235], v240 offset:23040
  v_mul_f32 v182, v251, v182
  v_mul_f32 v183, v251, v183
  v_mfma_f32_32x32x16_bf16 v[208:223], v[236:239], v[20:23], v[208:223]
  ds_read_b64_tr_b16 v[236:237], v240 offset:25088
  ds_read_b64_tr_b16 v[238:239], v240 offset:27136
  s_waitcnt lgkmcnt(4)
  v_mul_f32 v184, v251, v184
  v_mul_f32 v185, v251, v185
  v_mul_f32 v186, v251, v186
  v_mfma_f32_32x32x16_bf16 v[208:223], v[224:227], v[24:27], v[208:223]
  ds_read_b64_tr_b16 v[224:225], v240 offset:29184
  ds_read_b64_tr_b16 v[226:227], v240 offset:31232
  v_mul_f32 v187, v251, v187
  v_mul_f32 v188, v251, v188
  v_mul_f32 v189, v251, v189
  v_mul_f32 v190, v251, v190
  v_mfma_f32_32x32x16_bf16 v[208:223], v[228:231], v[28:31], v[208:223]
  ds_read_b64_tr_b16 v[228:229], v240 offset:33280
  ds_read_b64_tr_b16 v[230:231], v240 offset:35328
  s_waitcnt lgkmcnt(4)
  v_mul_f32 v191, v251, v191
  v_mul_f32 v192, v251, v192
  v_xor_b32 v242, 0x40, v241
  v_mfma_f32_32x32x16_bf16 v[160:175], v[232:235], v[48:51], v[160:175]
  ds_read_b64_tr_b16 v[232:233], v242 offset:20992
  ds_read_b64_tr_b16 v[234:235], v242 offset:23040
  v_mul_f32 v193, v251, v193
  v_mul_f32 v194, v251, v194
  v_mul_f32 v195, v251, v195
  v_mul_f32 v196, v251, v196
  v_mfma_f32_32x32x16_bf16 v[160:175], v[236:239], v[52:55], v[160:175]
  ds_read_b64_tr_b16 v[236:237], v242 offset:25088
  ds_read_b64_tr_b16 v[238:239], v242 offset:27136
  s_waitcnt lgkmcnt(4)
  v_mul_f32 v197, v251, v197
  v_mul_f32 v198, v251, v198
  v_mul_f32 v199, v251, v199
  v_mfma_f32_32x32x16_bf16 v[160:175], v[224:227], v[56:59], v[160:175]
  ds_read_b64_tr_b16 v[224:225], v242 offset:29184
  ds_read_b64_tr_b16 v[226:227], v242 offset:31232
  v_mul_f32 v200, v251, v200
  v_mul_f32 v201, v251, v201
  v_mul_f32 v202, v251, v202
  v_mul_f32 v203, v251, v203
  v_mfma_f32_32x32x16_bf16 v[160:175], v[228:231], v[60:63], v[160:175]
  ds_read_b64_tr_b16 v[228:229], v242 offset:33280
  ds_read_b64_tr_b16 v[230:231], v242 offset:35328
  s_waitcnt lgkmcnt(4)
  v_mul_f32 v204, v251, v204
  v_mul_f32 v205, v251, v205
  v_xor_b32 v243, 0x80, v241
  v_mfma_f32_32x32x16_bf16 v[176:191], v[232:235], v[48:51], v[176:191]
  ds_read_b64_tr_b16 v[232:233], v243 offset:20992
  ds_read_b64_tr_b16 v[234:235], v243 offset:23040
  v_mul_f32 v206, v251, v206
  v_mul_f32 v207, v251, v207
  v_mul_f32 v208, v251, v208
  v_mul_f32 v209, v251, v209
  v_mfma_f32_32x32x16_bf16 v[176:191], v[236:239], v[52:55], v[176:191]
  ds_read_b64_tr_b16 v[236:237], v243 offset:25088
  ds_read_b64_tr_b16 v[238:239], v243 offset:27136
  s_waitcnt lgkmcnt(4)
  v_mul_f32 v210, v251, v210
  v_mul_f32 v211, v251, v211
  v_mul_f32 v212, v251, v212
  v_mfma_f32_32x32x16_bf16 v[176:191], v[224:227], v[56:59], v[176:191]
  ds_read_b64_tr_b16 v[224:225], v243 offset:29184
  ds_read_b64_tr_b16 v[226:227], v243 offset:31232
  v_mul_f32 v213, v251, v213
  v_mul_f32 v214, v251, v214
  v_mul_f32 v215, v251, v215
  v_mul_f32 v216, v251, v216
  v_mfma_f32_32x32x16_bf16 v[176:191], v[228:231], v[60:63], v[176:191]
  ds_read_b64_tr_b16 v[228:229], v243 offset:33280
  ds_read_b64_tr_b16 v[230:231], v243 offset:35328
  s_waitcnt lgkmcnt(4)
  v_mul_f32 v217, v251, v217
  v_mul_f32 v218, v251, v218
  v_xor_b32 v240, 0xc0, v241
  v_mfma_f32_32x32x16_bf16 v[192:207], v[232:235], v[48:51], v[192:207]
  ds_read_b64_tr_b16 v[232:233], v240 offset:20992
  ds_read_b64_tr_b16 v[234:235], v240 offset:23040
  v_mul_f32 v219, v251, v219
  v_mul_f32 v220, v251, v220
  v_mul_f32 v221, v251, v221
  v_mul_f32 v222, v251, v222
  v_mfma_f32_32x32x16_bf16 v[192:207], v[236:239], v[52:55], v[192:207]
  ds_read_b64_tr_b16 v[236:237], v240 offset:25088
  ds_read_b64_tr_b16 v[238:239], v240 offset:27136
  s_waitcnt lgkmcnt(4)
  v_mul_f32 v223, v251, v223
  v_mfma_f32_32x32x16_bf16 v[192:207], v[224:227], v[56:59], v[192:207]
  ds_read_b64_tr_b16 v[224:225], v240 offset:29184
  ds_read_b64_tr_b16 v[226:227], v240 offset:31232
  v_mfma_f32_32x32x16_bf16 v[192:207], v[228:231], v[60:63], v[192:207]
  ds_read_b64_tr_b16 v[228:229], v240 offset:33280
  ds_read_b64_tr_b16 v[230:231], v240 offset:35328
  s_waitcnt lgkmcnt(4)
  v_xor_b32 v242, 0x18000, v241
  v_mfma_f32_32x32x16_bf16 v[208:223], v[232:235], v[48:51], v[208:223]
  s_barrier
  ds_read_b64_tr_b16 v[232:233], v242 offset:24064
  ds_read_b64_tr_b16 v[234:235], v242 offset:26112
  v_mfma_f32_32x32x16_bf16 v[208:223], v[236:239], v[52:55], v[208:223]
  ds_read_b64_tr_b16 v[236:237], v242 offset:28160
  ds_read_b64_tr_b16 v[238:239], v242 offset:30208
  s_waitcnt lgkmcnt(4)
  v_mfma_f32_32x32x16_bf16 v[208:223], v[224:227], v[56:59], v[208:223]
  ds_read_b64_tr_b16 v[224:225], v242 offset:32256
  ds_read_b64_tr_b16 v[226:227], v242 offset:34304
  v_mfma_f32_32x32x16_bf16 v[208:223], v[228:231], v[60:63], v[208:223]
  ds_read_b64_tr_b16 v[228:229], v242 offset:36352
  ds_read_b64_tr_b16 v[230:231], v242 offset:38400
  s_waitcnt lgkmcnt(4)
  v_xor_b32 v243, 0x18040, v241
  v_mfma_f32_32x32x16_bf16 v[160:175], v[232:235], v[80:83], v[160:175]
  ds_read_b64_tr_b16 v[232:233], v243 offset:24064
  ds_read_b64_tr_b16 v[234:235], v243 offset:26112
  v_mfma_f32_32x32x16_bf16 v[160:175], v[236:239], v[84:87], v[160:175]
  ds_read_b64_tr_b16 v[236:237], v243 offset:28160
  ds_read_b64_tr_b16 v[238:239], v243 offset:30208
  s_waitcnt lgkmcnt(4)
  v_mfma_f32_32x32x16_bf16 v[160:175], v[224:227], v[88:91], v[160:175]
  ds_read_b64_tr_b16 v[224:225], v243 offset:32256
  ds_read_b64_tr_b16 v[226:227], v243 offset:34304
  v_mfma_f32_32x32x16_bf16 v[160:175], v[228:231], v[92:95], v[160:175]
  ds_read_b64_tr_b16 v[228:229], v243 offset:36352
  ds_read_b64_tr_b16 v[230:231], v243 offset:38400
  s_waitcnt lgkmcnt(4)
  v_xor_b32 v240, 0x18080, v241
  v_mfma_f32_32x32x16_bf16 v[176:191], v[232:235], v[80:83], v[176:191]
  ds_read_b64_tr_b16 v[232:233], v240 offset:24064
  ds_read_b64_tr_b16 v[234:235], v240 offset:26112
  v_mfma_f32_32x32x16_bf16 v[176:191], v[236:239], v[84:87], v[176:191]
  ds_read_b64_tr_b16 v[236:237], v240 offset:28160
  ds_read_b64_tr_b16 v[238:239], v240 offset:30208
  s_waitcnt lgkmcnt(4)
  s_nop 0
  v_mul_f32 v160, v252, v160
  v_mul_f32 v161, v252, v161
  v_mul_f32 v162, v252, v162
  v_mfma_f32_32x32x16_bf16 v[176:191], v[224:227], v[88:91], v[176:191]
  ds_read_b64_tr_b16 v[224:225], v240 offset:32256
  ds_read_b64_tr_b16 v[226:227], v240 offset:34304
  v_mul_f32 v163, v252, v163
  v_mul_f32 v164, v252, v164
  v_mul_f32 v165, v252, v165
  v_mul_f32 v166, v252, v166
  v_mfma_f32_32x32x16_bf16 v[176:191], v[228:231], v[92:95], v[176:191]
  ds_read_b64_tr_b16 v[228:229], v240 offset:36352
  ds_read_b64_tr_b16 v[230:231], v240 offset:38400
  s_waitcnt lgkmcnt(4)
  v_mul_f32 v167, v252, v167
  v_mul_f32 v168, v252, v168
  v_xor_b32 v242, 0x180c0, v241
  v_mfma_f32_32x32x16_bf16 v[192:207], v[232:235], v[80:83], v[192:207]
  ds_read_b64_tr_b16 v[232:233], v242 offset:24064
  ds_read_b64_tr_b16 v[234:235], v242 offset:26112
  v_mul_f32 v169, v252, v169
  v_mul_f32 v170, v252, v170
  v_mul_f32 v171, v252, v171
  v_mul_f32 v172, v252, v172
  v_mfma_f32_32x32x16_bf16 v[192:207], v[236:239], v[84:87], v[192:207]
  ds_read_b64_tr_b16 v[236:237], v242 offset:28160
  ds_read_b64_tr_b16 v[238:239], v242 offset:30208
  s_waitcnt lgkmcnt(4)
  v_mul_f32 v173, v252, v173
  v_mul_f32 v174, v252, v174
  v_mul_f32 v175, v252, v175
  v_mfma_f32_32x32x16_bf16 v[192:207], v[224:227], v[88:91], v[192:207]
  ds_read_b64_tr_b16 v[224:225], v242 offset:32256
  ds_read_b64_tr_b16 v[226:227], v242 offset:34304
  v_mul_f32 v176, v252, v176
  v_mul_f32 v177, v252, v177
  v_mul_f32 v178, v252, v178
  v_mul_f32 v179, v252, v179
  v_mfma_f32_32x32x16_bf16 v[192:207], v[228:231], v[92:95], v[192:207]
  ds_read_b64_tr_b16 v[228:229], v242 offset:36352
  ds_read_b64_tr_b16 v[230:231], v242 offset:38400
  s_waitcnt lgkmcnt(4)
  v_mul_f32 v180, v252, v180
  v_mul_f32 v181, v252, v181
  v_xor_b32 v243, 0x18000, v241
  v_mfma_f32_32x32x16_bf16 v[208:223], v[232:235], v[80:83], v[208:223]
  s_barrier
  ds_read_b64_tr_b16 v[232:233], v243 offset:7168
  ds_read_b64_tr_b16 v[234:235], v243 offset:9216
  v_mul_f32 v182, v252, v182
  v_mul_f32 v183, v252, v183
  v_mfma_f32_32x32x16_bf16 v[208:223], v[236:239], v[84:87], v[208:223]
  ds_read_b64_tr_b16 v[236:237], v243 offset:11264
  ds_read_b64_tr_b16 v[238:239], v243 offset:13312
  s_waitcnt lgkmcnt(4)
  v_mul_f32 v184, v252, v184
  v_mul_f32 v185, v252, v185
  v_mul_f32 v186, v252, v186
  v_mfma_f32_32x32x16_bf16 v[208:223], v[224:227], v[88:91], v[208:223]
  ds_read_b64_tr_b16 v[224:225], v243 offset:15360
  ds_read_b64_tr_b16 v[226:227], v243 offset:17408
  v_mul_f32 v187, v252, v187
  v_mul_f32 v188, v252, v188
  v_mul_f32 v189, v252, v189
  v_mul_f32 v190, v252, v190
  v_mfma_f32_32x32x16_bf16 v[208:223], v[228:231], v[92:95], v[208:223]
  ds_read_b64_tr_b16 v[228:229], v243 offset:19456
  ds_read_b64_tr_b16 v[230:231], v243 offset:21504
  s_waitcnt lgkmcnt(4)
  v_mul_f32 v191, v252, v191
  v_mul_f32 v192, v252, v192
  v_xor_b32 v240, 0x18040, v241
  v_mfma_f32_32x32x16_bf16 v[160:175], v[232:235], v[112:115], v[160:175]
  ds_read_b64_tr_b16 v[232:233], v240 offset:7168
  ds_read_b64_tr_b16 v[234:235], v240 offset:9216
  v_mul_f32 v193, v252, v193
  v_mul_f32 v194, v252, v194
  v_mul_f32 v195, v252, v195
  v_mul_f32 v196, v252, v196
  v_mfma_f32_32x32x16_bf16 v[160:175], v[236:239], v[116:119], v[160:175]
  ds_read_b64_tr_b16 v[236:237], v240 offset:11264
  ds_read_b64_tr_b16 v[238:239], v240 offset:13312
  s_waitcnt lgkmcnt(4)
  v_mul_f32 v197, v252, v197
  v_mul_f32 v198, v252, v198
  v_mul_f32 v199, v252, v199
  v_mfma_f32_32x32x16_bf16 v[160:175], v[224:227], v[120:123], v[160:175]
  ds_read_b64_tr_b16 v[224:225], v240 offset:15360
  ds_read_b64_tr_b16 v[226:227], v240 offset:17408
  v_mul_f32 v200, v252, v200
  v_mul_f32 v201, v252, v201
  v_mul_f32 v202, v252, v202
  v_mul_f32 v203, v252, v203
  v_mfma_f32_32x32x16_bf16 v[160:175], v[228:231], v[124:127], v[160:175]
  ds_read_b64_tr_b16 v[228:229], v240 offset:19456
  ds_read_b64_tr_b16 v[230:231], v240 offset:21504
  s_waitcnt lgkmcnt(4)
  v_mul_f32 v204, v252, v204
  v_mul_f32 v205, v252, v205
  v_xor_b32 v242, 0x18080, v241
  v_mfma_f32_32x32x16_bf16 v[176:191], v[232:235], v[112:115], v[176:191]
  ds_read_b64_tr_b16 v[232:233], v242 offset:7168
  ds_read_b64_tr_b16 v[234:235], v242 offset:9216
  v_mul_f32 v206, v252, v206
  v_mul_f32 v207, v252, v207
  v_mul_f32 v208, v252, v208
  v_mul_f32 v209, v252, v209
  v_mfma_f32_32x32x16_bf16 v[176:191], v[236:239], v[116:119], v[176:191]
  ds_read_b64_tr_b16 v[236:237], v242 offset:11264
  ds_read_b64_tr_b16 v[238:239], v242 offset:13312
  s_waitcnt lgkmcnt(4)
  v_mul_f32 v210, v252, v210
  v_mul_f32 v211, v252, v211
  v_mul_f32 v212, v252, v212
  v_mfma_f32_32x32x16_bf16 v[176:191], v[224:227], v[120:123], v[176:191]
  ds_read_b64_tr_b16 v[224:225], v242 offset:15360
  ds_read_b64_tr_b16 v[226:227], v242 offset:17408
  v_mul_f32 v213, v252, v213
  v_mul_f32 v214, v252, v214
  v_mul_f32 v215, v252, v215
  v_mul_f32 v216, v252, v216
  v_mfma_f32_32x32x16_bf16 v[176:191], v[228:231], v[124:127], v[176:191]
  ds_read_b64_tr_b16 v[228:229], v242 offset:19456
  ds_read_b64_tr_b16 v[230:231], v242 offset:21504
  s_waitcnt lgkmcnt(4)
  v_mul_f32 v217, v252, v217
  v_mul_f32 v218, v252, v218
  v_xor_b32 v243, 0x180c0, v241
  v_mfma_f32_32x32x16_bf16 v[192:207], v[232:235], v[112:115], v[192:207]
  ds_read_b64_tr_b16 v[232:233], v243 offset:7168
  ds_read_b64_tr_b16 v[234:235], v243 offset:9216
  v_mul_f32 v219, v252, v219
  v_mul_f32 v220, v252, v220
  v_mul_f32 v221, v252, v221
  v_mul_f32 v222, v252, v222
  v_mfma_f32_32x32x16_bf16 v[192:207], v[236:239], v[116:119], v[192:207]
  ds_read_b64_tr_b16 v[236:237], v243 offset:11264
  ds_read_b64_tr_b16 v[238:239], v243 offset:13312
  s_waitcnt lgkmcnt(4)
  v_mul_f32 v223, v252, v223
  v_mfma_f32_32x32x16_bf16 v[192:207], v[224:227], v[120:123], v[192:207]
  ds_read_b64_tr_b16 v[224:225], v243 offset:15360
  ds_read_b64_tr_b16 v[226:227], v243 offset:17408
  v_mfma_f32_32x32x16_bf16 v[192:207], v[228:231], v[124:127], v[192:207]
  ds_read_b64_tr_b16 v[228:229], v243 offset:19456
  ds_read_b64_tr_b16 v[230:231], v243 offset:21504
  s_waitcnt lgkmcnt(4)
  v_xor_b32 v240, 0xc000, v241
  v_mfma_f32_32x32x16_bf16 v[208:223], v[232:235], v[112:115], v[208:223]
  s_barrier
  ds_read_b64_tr_b16 v[232:233], v240 offset:5632
  ds_read_b64_tr_b16 v[234:235], v240 offset:7680
  v_mfma_f32_32x32x16_bf16 v[208:223], v[236:239], v[116:119], v[208:223]
  ds_read_b64_tr_b16 v[236:237], v240 offset:9728
  ds_read_b64_tr_b16 v[238:239], v240 offset:11776
  s_waitcnt lgkmcnt(4)
  v_mfma_f32_32x32x16_bf16 v[208:223], v[224:227], v[120:123], v[208:223]
  ds_read_b64_tr_b16 v[224:225], v240 offset:13824
  ds_read_b64_tr_b16 v[226:227], v240 offset:15872
  v_mfma_f32_32x32x16_bf16 v[208:223], v[228:231], v[124:127], v[208:223]
  ds_read_b64_tr_b16 v[228:229], v240 offset:17920
  ds_read_b64_tr_b16 v[230:231], v240 offset:19968
  s_waitcnt lgkmcnt(4)
  v_xor_b32 v242, 0xc040, v241
  v_mfma_f32_32x32x16_bf16 v[160:175], v[232:235], v[0:3], v[160:175]
  ds_read_b64_tr_b16 v[232:233], v242 offset:5632
  ds_read_b64_tr_b16 v[234:235], v242 offset:7680
  v_xor_b32 v48, 0x0, v254
  v_xor_b32 v49, 0x40, v254
  v_xor_b32 v50, 0xc000, v254
  v_xor_b32 v51, 0xc040, v254
  v_mfma_f32_32x32x16_bf16 v[160:175], v[236:239], v[4:7], v[160:175]
  ds_read_b64_tr_b16 v[236:237], v242 offset:9728
  ds_read_b64_tr_b16 v[238:239], v242 offset:11776
  s_waitcnt lgkmcnt(4)
  v_xor_b32 v52, 0x18000, v254
  v_xor_b32 v53, 0x18040, v254
  v_add_u32 v54, s17, v255
  v_mfma_f32_32x32x16_bf16 v[160:175], v[224:227], v[8:11], v[160:175]
  ds_read_b64_tr_b16 v[224:225], v242 offset:13824
  ds_read_b64_tr_b16 v[226:227], v242 offset:15872
  v_mfma_f32_32x32x16_bf16 v[160:175], v[228:231], v[12:15], v[160:175]
  ds_read_b64_tr_b16 v[228:229], v242 offset:17920
  ds_read_b64_tr_b16 v[230:231], v242 offset:19968
  s_waitcnt lgkmcnt(4)
  v_xor_b32 v243, 0xc080, v241
  v_mfma_f32_32x32x16_bf16 v[176:191], v[232:235], v[0:3], v[176:191]
  ds_read_b64_tr_b16 v[232:233], v243 offset:5632
  ds_read_b64_tr_b16 v[234:235], v243 offset:7680
  v_mfma_f32_32x32x16_bf16 v[176:191], v[236:239], v[4:7], v[176:191]
  ds_read_b64_tr_b16 v[236:237], v243 offset:9728
  ds_read_b64_tr_b16 v[238:239], v243 offset:11776
  s_waitcnt lgkmcnt(4)
  s_nop 0
  v_mul_f32 v160, v253, v160
  v_mul_f32 v161, v253, v161
  v_mul_f32 v162, v253, v162
  v_mfma_f32_32x32x16_bf16 v[176:191], v[224:227], v[8:11], v[176:191]
  ds_read_b64_tr_b16 v[224:225], v243 offset:13824
  ds_read_b64_tr_b16 v[226:227], v243 offset:15872
  v_mul_f32 v163, v253, v163
  v_mul_f32 v164, v253, v164
  v_mul_f32 v165, v253, v165
  v_mul_f32 v166, v253, v166
  v_mfma_f32_32x32x16_bf16 v[176:191], v[228:231], v[12:15], v[176:191]
  ds_read_b64_tr_b16 v[228:229], v243 offset:17920
  ds_read_b64_tr_b16 v[230:231], v243 offset:19968
  s_waitcnt lgkmcnt(4)
  v_mul_f32 v167, v253, v167
  v_mul_f32 v168, v253, v168
  v_xor_b32 v240, 0xc0c0, v241
  v_mfma_f32_32x32x16_bf16 v[192:207], v[232:235], v[0:3], v[192:207]
  ds_read_b64_tr_b16 v[232:233], v240 offset:5632
  ds_read_b64_tr_b16 v[234:235], v240 offset:7680
  v_mul_f32 v169, v253, v169
  v_mul_f32 v170, v253, v170
  v_mul_f32 v171, v253, v171
  v_mul_f32 v172, v253, v172
  v_mfma_f32_32x32x16_bf16 v[192:207], v[236:239], v[4:7], v[192:207]
  ds_read_b64_tr_b16 v[236:237], v240 offset:9728
  ds_read_b64_tr_b16 v[238:239], v240 offset:11776
  s_waitcnt lgkmcnt(4)
  v_mul_f32 v173, v253, v173
  v_mul_f32 v174, v253, v174
  v_mul_f32 v175, v253, v175
  v_mfma_f32_32x32x16_bf16 v[192:207], v[224:227], v[8:11], v[192:207]
  ds_read_b64_tr_b16 v[224:225], v240 offset:13824
  ds_read_b64_tr_b16 v[226:227], v240 offset:15872
  v_mul_f32 v176, v253, v176
  v_mul_f32 v177, v253, v177
  v_mul_f32 v178, v253, v178
  v_mul_f32 v179, v253, v179
  v_mfma_f32_32x32x16_bf16 v[192:207], v[228:231], v[12:15], v[192:207]
  ds_read_b64_tr_b16 v[228:229], v240 offset:17920
  ds_read_b64_tr_b16 v[230:231], v240 offset:19968
  s_waitcnt lgkmcnt(4)
  v_mul_f32 v180, v253, v180
  v_mul_f32 v181, v253, v181
  v_xor_b32 v242, 0x18000, v241
  v_mfma_f32_32x32x16_bf16 v[208:223], v[232:235], v[0:3], v[208:223]
  s_barrier
  ds_read_b64_tr_b16 v[232:233], v242 offset:40960
  ds_read_b64_tr_b16 v[234:235], v242 offset:43008
  v_mul_f32 v182, v253, v182
  v_mul_f32 v183, v253, v183
  v_mfma_f32_32x32x16_bf16 v[208:223], v[236:239], v[4:7], v[208:223]
  ds_read_b64_tr_b16 v[236:237], v242 offset:45056
  ds_read_b64_tr_b16 v[238:239], v242 offset:47104
  s_waitcnt lgkmcnt(4)
  v_mul_f32 v184, v253, v184
  v_mul_f32 v185, v253, v185
  v_mul_f32 v186, v253, v186
  v_mfma_f32_32x32x16_bf16 v[208:223], v[224:227], v[8:11], v[208:223]
  ds_read_b64_tr_b16 v[224:225], v242 offset:49152
  ds_read_b64_tr_b16 v[226:227], v242 offset:51200
  v_mul_f32 v187, v253, v187
  v_mul_f32 v188, v253, v188
  v_mul_f32 v189, v253, v189
  v_mul_f32 v190, v253, v190
  v_mfma_f32_32x32x16_bf16 v[208:223], v[228:231], v[12:15], v[208:223]
  ds_read_b64_tr_b16 v[228:229], v242 offset:53248
  ds_read_b64_tr_b16 v[230:231], v242 offset:55296
  s_waitcnt lgkmcnt(4)
  v_mul_f32 v191, v253, v191
  v_mul_f32 v192, v253, v192
  v_xor_b32 v243, 0x18040, v241
  v_mfma_f32_32x32x16_bf16 v[160:175], v[232:235], v[64:67], v[160:175]
  ds_read_b64_tr_b16 v[232:233], v243 offset:40960
  ds_read_b64_tr_b16 v[234:235], v243 offset:43008
  v_mul_f32 v193, v253, v193
  v_mul_f32 v194, v253, v194
  v_mul_f32 v195, v253, v195
  v_mul_f32 v196, v253, v196
  v_mfma_f32_32x32x16_bf16 v[160:175], v[236:239], v[68:71], v[160:175]
  ds_read_b64_tr_b16 v[236:237], v243 offset:45056
  ds_read_b64_tr_b16 v[238:239], v243 offset:47104
  s_waitcnt lgkmcnt(4)
  v_mul_f32 v197, v253, v197
  v_mul_f32 v198, v253, v198
  v_mul_f32 v199, v253, v199
  v_mfma_f32_32x32x16_bf16 v[160:175], v[224:227], v[72:75], v[160:175]
  ds_read_b64_tr_b16 v[224:225], v243 offset:49152
  ds_read_b64_tr_b16 v[226:227], v243 offset:51200
  v_mul_f32 v200, v253, v200
  v_mul_f32 v201, v253, v201
  v_mul_f32 v202, v253, v202
  v_mul_f32 v203, v253, v203
  v_mfma_f32_32x32x16_bf16 v[160:175], v[228:231], v[76:79], v[160:175]
  ds_read_b64_tr_b16 v[228:229], v243 offset:53248
  ds_read_b64_tr_b16 v[230:231], v243 offset:55296
  s_waitcnt lgkmcnt(4)
  v_mul_f32 v204, v253, v204
  v_mul_f32 v205, v253, v205
  v_xor_b32 v240, 0x18080, v241
  v_mfma_f32_32x32x16_bf16 v[176:191], v[232:235], v[64:67], v[176:191]
  ds_read_b64_tr_b16 v[232:233], v240 offset:40960
  ds_read_b64_tr_b16 v[234:235], v240 offset:43008
  v_mul_f32 v206, v253, v206
  v_mul_f32 v207, v253, v207
  v_mul_f32 v208, v253, v208
  v_mul_f32 v209, v253, v209
  v_mfma_f32_32x32x16_bf16 v[176:191], v[236:239], v[68:71], v[176:191]
  ds_read_b64_tr_b16 v[236:237], v240 offset:45056
  ds_read_b64_tr_b16 v[238:239], v240 offset:47104
  s_waitcnt lgkmcnt(4)
  v_mul_f32 v210, v253, v210
  v_mul_f32 v211, v253, v211
  v_mul_f32 v212, v253, v212
  v_mfma_f32_32x32x16_bf16 v[176:191], v[224:227], v[72:75], v[176:191]
  ds_read_b64_tr_b16 v[224:225], v240 offset:49152
  ds_read_b64_tr_b16 v[226:227], v240 offset:51200
  v_mul_f32 v213, v253, v213
  v_mul_f32 v214, v253, v214
  v_mul_f32 v215, v253, v215
  v_mul_f32 v216, v253, v216
  v_mfma_f32_32x32x16_bf16 v[176:191], v[228:231], v[76:79], v[176:191]
  ds_read_b64_tr_b16 v[228:229], v240 offset:53248
  ds_read_b64_tr_b16 v[230:231], v240 offset:55296
  s_waitcnt lgkmcnt(4)
  v_mul_f32 v217, v253, v217
  v_mul_f32 v218, v253, v218
  v_xor_b32 v242, 0x180c0, v241
  v_mfma_f32_32x32x16_bf16 v[192:207], v[232:235], v[64:67], v[192:207]
  ds_read_b64_tr_b16 v[232:233], v242 offset:40960
  ds_read_b64_tr_b16 v[234:235], v242 offset:43008
  s_waitcnt vmcnt(0)
  v_mov_b32 v249, s14
  v_lshlrev_b32 v249, 2, v249
  s_mov_b64 exec, 1
  ds_write_b32 v249, v250
  s_mov_b64 exec, -1
  v_mul_f32 v219, v253, v219
  v_mul_f32 v220, v253, v220
  v_mul_f32 v221, v253, v221
  v_mul_f32 v222, v253, v222
  v_mfma_f32_32x32x16_bf16 v[192:207], v[236:239], v[68:71], v[192:207]
  ds_read_b64_tr_b16 v[236:237], v242 offset:45056
  ds_read_b64_tr_b16 v[238:239], v242 offset:47104
  s_waitcnt lgkmcnt(5)
  v_mul_f32 v223, v253, v223
  v_mfma_f32_32x32x16_bf16 v[192:207], v[224:227], v[72:75], v[192:207]
  ds_read_b64_tr_b16 v[224:225], v242 offset:49152
  ds_read_b64_tr_b16 v[226:227], v242 offset:51200
  v_mfma_f32_32x32x16_bf16 v[192:207], v[228:231], v[76:79], v[192:207]
  ds_read_b64_tr_b16 v[228:229], v242 offset:53248
  ds_read_b64_tr_b16 v[230:231], v242 offset:55296
  s_waitcnt lgkmcnt(4)
  v_xor_b32 v243, 0x0, v241
  v_mfma_f32_32x32x16_bf16 v[208:223], v[232:235], v[64:67], v[208:223]
  s_barrier
  ds_read_b64_tr_b16 v[232:233], v243 offset:4096
  ds_read_b64_tr_b16 v[234:235], v243 offset:6144
  v_mfma_f32_32x32x16_bf16 v[208:223], v[236:239], v[68:71], v[208:223]
  ds_read_b64_tr_b16 v[236:237], v243 offset:8192
  ds_read_b64_tr_b16 v[238:239], v243 offset:10240
  s_waitcnt lgkmcnt(4)
  v_mfma_f32_32x32x16_bf16 v[208:223], v[224:227], v[72:75], v[208:223]
  ds_read_b64_tr_b16 v[224:225], v243 offset:12288
  ds_read_b64_tr_b16 v[226:227], v243 offset:14336
  v_mfma_f32_32x32x16_bf16 v[208:223], v[228:231], v[76:79], v[208:223]
  ds_read_b64_tr_b16 v[228:229], v243 offset:16384
  ds_read_b64_tr_b16 v[230:231], v243 offset:18432
  s_waitcnt lgkmcnt(4)
  v_xor_b32 v240, 0x40, v241
  v_mfma_f32_32x32x16_bf16 v[160:175], v[232:235], v[144:147], v[160:175]
  ds_read_b64_tr_b16 v[232:233], v240 offset:4096
  ds_read_b64_tr_b16 v[234:235], v240 offset:6144
  v_mfma_f32_32x32x16_bf16 v[160:175], v[236:239], v[148:151], v[160:175]
  ds_read_b64_tr_b16 v[236:237], v240 offset:8192
  ds_read_b64_tr_b16 v[238:239], v240 offset:10240
  s_waitcnt lgkmcnt(4)
  v_mfma_f32_32x32x16_bf16 v[160:175], v[224:227], v[152:155], v[160:175]
  ds_read_b64_tr_b16 v[224:225], v240 offset:12288
  ds_read_b64_tr_b16 v[226:227], v240 offset:14336
  v_mfma_f32_32x32x16_bf16 v[160:175], v[228:231], v[156:159], v[160:175]
  ds_read_b64_tr_b16 v[228:229], v240 offset:16384
  ds_read_b64_tr_b16 v[230:231], v240 offset:18432
  s_waitcnt lgkmcnt(4)
  v_xor_b32 v242, 0x80, v241
  v_mfma_f32_32x32x16_bf16 v[176:191], v[232:235], v[144:147], v[176:191]
  ds_read_b64_tr_b16 v[232:233], v242 offset:4096
  ds_read_b64_tr_b16 v[234:235], v242 offset:6144
  v_mfma_f32_32x32x16_bf16 v[176:191], v[236:239], v[148:151], v[176:191]
  ds_read_b64_tr_b16 v[236:237], v242 offset:8192
  ds_read_b64_tr_b16 v[238:239], v242 offset:10240
  s_waitcnt lgkmcnt(4)
  s_nop 0
  v_cvt_pk_bf16_f32 v128, v160, v161
  v_cvt_pk_bf16_f32 v129, v162, v163
  v_cvt_pk_bf16_f32 v130, v164, v165
  v_mfma_f32_32x32x16_bf16 v[176:191], v[224:227], v[152:155], v[176:191]
  ds_read_b64_tr_b16 v[224:225], v242 offset:12288
  ds_read_b64_tr_b16 v[226:227], v242 offset:14336
  v_cvt_pk_bf16_f32 v131, v166, v167
  v_cvt_pk_bf16_f32 v132, v168, v169
  v_cvt_pk_bf16_f32 v133, v170, v171
  v_cvt_pk_bf16_f32 v134, v172, v173
  v_mfma_f32_32x32x16_bf16 v[176:191], v[228:231], v[156:159], v[176:191]
  ds_read_b64_tr_b16 v[228:229], v242 offset:16384
  ds_read_b64_tr_b16 v[230:231], v242 offset:18432
  s_waitcnt lgkmcnt(4)
  v_cvt_pk_bf16_f32 v135, v174, v175
  v_xor_b32 v243, 0xc0, v241
  v_mfma_f32_32x32x16_bf16 v[192:207], v[232:235], v[144:147], v[192:207]
  ds_read_b64_tr_b16 v[232:233], v243 offset:4096
  ds_read_b64_tr_b16 v[234:235], v243 offset:6144
  v_mfma_f32_32x32x16_bf16 v[192:207], v[236:239], v[148:151], v[192:207]
  ds_read_b64_tr_b16 v[236:237], v243 offset:8192
  ds_read_b64_tr_b16 v[238:239], v243 offset:10240
  s_waitcnt lgkmcnt(4)
  v_cvt_pk_bf16_f32 v136, v176, v177
  v_cvt_pk_bf16_f32 v137, v178, v179
  v_cvt_pk_bf16_f32 v138, v180, v181
  v_mfma_f32_32x32x16_bf16 v[192:207], v[224:227], v[152:155], v[192:207]
  ds_read_b64_tr_b16 v[224:225], v243 offset:12288
  ds_read_b64_tr_b16 v[226:227], v243 offset:14336
  v_cvt_pk_bf16_f32 v139, v182, v183
  v_cvt_pk_bf16_f32 v140, v184, v185
  v_cvt_pk_bf16_f32 v141, v186, v187
  v_cvt_pk_bf16_f32 v142, v188, v189
  v_mfma_f32_32x32x16_bf16 v[192:207], v[228:231], v[156:159], v[192:207]
  ds_read_b64_tr_b16 v[228:229], v243 offset:16384
  ds_read_b64_tr_b16 v[230:231], v243 offset:18432
  s_barrier
  ds_read_b64_tr_b16 v[80:81], v48 offset:37888
  ds_read_b64_tr_b16 v[82:83], v48 offset:38912
  s_waitcnt lgkmcnt(6)
  v_mfma_f32_32x32x16_bf16 v[208:223], v[232:235], v[144:147], v[208:223]
  ds_read_b64_tr_b16 v[232:233], v48 offset:39936
  ds_read_b64_tr_b16 v[234:235], v48 offset:40960
  v_cvt_pk_bf16_f32 v143, v190, v191
  v_mfma_f32_32x32x16_bf16 v[208:223], v[236:239], v[148:151], v[208:223]
  ds_read_b64_tr_b16 v[236:237], v48 offset:41984
  ds_read_b64_tr_b16 v[238:239], v48 offset:43008
  s_waitcnt lgkmcnt(6)
  v_cvt_pk_bf16_f32 v16, v192, v193
  v_cvt_pk_bf16_f32 v17, v194, v195
  v_cvt_pk_bf16_f32 v18, v196, v197
  v_mfma_f32_32x32x16_bf16 v[208:223], v[224:227], v[152:155], v[208:223]
  ds_read_b64_tr_b16 v[224:225], v48 offset:44032
  ds_read_b64_tr_b16 v[226:227], v48 offset:45056
  v_cvt_pk_bf16_f32 v19, v198, v199
  v_cvt_pk_bf16_f32 v20, v200, v201
  v_cvt_pk_bf16_f32 v21, v202, v203
  v_cvt_pk_bf16_f32 v22, v204, v205
  v_mfma_f32_32x32x16_bf16 v[208:223], v[228:231], v[156:159], v[208:223]
  ds_read_b64_tr_b16 v[228:229], v48 offset:46080
  ds_read_b64_tr_b16 v[230:231], v48 offset:47104
  s_waitcnt lgkmcnt(6)
L_o:
  v_cvt_pk_bf16_f32 v23, v206, v207
  v_mfma_f32_32x32x16_bf16 v[112:127], v[80:83], v[32:35], 0
  ds_read_b64_tr_b16 v[84:85], v48 offset:48128
  ds_read_b64_tr_b16 v[86:87], v48 offset:49152
  v_mfma_f32_32x32x16_bf16 v[112:127], v[232:235], v[36:39], v[112:127]
  ds_read_b64_tr_b16 v[80:81], v48 offset:50176
  ds_read_b64_tr_b16 v[82:83], v48 offset:51200
  s_waitcnt lgkmcnt(6)
  s_nop 0
  v_cvt_pk_bf16_f32 v24, v208, v209
  v_cvt_pk_bf16_f32 v25, v210, v211
  v_cvt_pk_bf16_f32 v26, v212, v213
  v_mfma_f32_32x32x16_bf16 v[112:127], v[236:239], v[40:43], v[112:127]
  ds_read_b64_tr_b16 v[232:233], v48 offset:52224
  ds_read_b64_tr_b16 v[234:235], v48 offset:53248
  v_cvt_pk_bf16_f32 v27, v214, v215
  v_cvt_pk_bf16_f32 v28, v216, v217
  v_cvt_pk_bf16_f32 v29, v218, v219
  v_cvt_pk_bf16_f32 v30, v220, v221
  v_mfma_f32_32x32x16_bf16 v[112:127], v[224:227], v[44:47], v[112:127]
  s_barrier
  ds_read_b64_tr_b16 v[236:237], v50 offset:22528
  ds_read_b64_tr_b16 v[238:239], v50 offset:23552
  s_waitcnt lgkmcnt(6)
  v_cvt_pk_bf16_f32 v31, v222, v223
  v_mfma_f32_32x32x16_bf16 v[112:127], v[228:231], v[96:99], v[112:127]
  ds_read_b64_tr_b16 v[224:225], v50 offset:24576
  ds_read_b64_tr_b16 v[226:227], v50 offset:25600
  v_mfma_f32_32x32x16_bf16 v[112:127], v[84:87], v[100:103], v[112:127]
  ds_read_b64_tr_b16 v[228:229], v50 offset:26624
  ds_read_b64_tr_b16 v[230:231], v50 offset:27648
  s_waitcnt lgkmcnt(6)
  v_mfma_f32_32x32x16_bf16 v[112:127], v[80:83], v[104:107], v[112:127]
  ds_read_b64_tr_b16 v[84:85], v50 offset:28672
  ds_read_b64_tr_b16 v[86:87], v50 offset:29696
  v_mfma_f32_32x32x16_bf16 v[112:127], v[232:235], v[108:111], v[112:127]
  ds_read_b64_tr_b16 v[80:81], v50 offset:30720
  ds_read_b64_tr_b16 v[82:83], v50 offset:31744
  s_waitcnt lgkmcnt(6)
  v_mfma_f32_32x32x16_bf16 v[112:127], v[236:239], v[128:131], v[112:127]
  ds_read_b64_tr_b16 v[232:233], v50 offset:32768
  ds_read_b64_tr_b16 v[234:235], v50 offset:33792
  v_mfma_f32_32x32x16_bf16 v[112:127], v[224:227], v[132:135], v[112:127]
  ds_read_b64_tr_b16 v[236:237], v50 offset:34816
  ds_read_b64_tr_b16 v[238:239], v50 offset:35840
  s_waitcnt lgkmcnt(6)
  v_mfma_f32_32x32x16_bf16 v[112:127], v[228:231], v[136:139], v[112:127]
  ds_read_b64_tr_b16 v[224:225], v50 offset:36864
  ds_read_b64_tr_b16 v[226:227], v50 offset:37888
  v_mfma_f32_32x32x16_bf16 v[112:127], v[84:87], v[140:143], v[112:127]
  ds_read_b64_tr_b16 v[228:229], v49 offset:37888
  ds_read_b64_tr_b16 v[230:231], v49 offset:38912
  s_waitcnt lgkmcnt(6)
  v_mfma_f32_32x32x16_bf16 v[112:127], v[80:83], v[16:19], v[112:127]
  ds_read_b64_tr_b16 v[84:85], v49 offset:39936
  ds_read_b64_tr_b16 v[86:87], v49 offset:40960
  v_mfma_f32_32x32x16_bf16 v[112:127], v[232:235], v[20:23], v[112:127]
  ds_read_b64_tr_b16 v[80:81], v49 offset:41984
  ds_read_b64_tr_b16 v[82:83], v49 offset:43008
  s_waitcnt lgkmcnt(6)
  v_mfma_f32_32x32x16_bf16 v[112:127], v[236:239], v[24:27], v[112:127]
  ds_read_b64_tr_b16 v[232:233], v49 offset:44032
  ds_read_b64_tr_b16 v[234:235], v49 offset:45056
  v_mfma_f32_32x32x16_bf16 v[112:127], v[224:227], v[28:31], v[112:127]
  ds_read_b64_tr_b16 v[236:237], v49 offset:46080
  ds_read_b64_tr_b16 v[238:239], v49 offset:47104
  s_waitcnt lgkmcnt(6)
  v_mfma_f32_32x32x16_bf16 v[0:15], v[228:231], v[32:35], 0
  ds_read_b64_tr_b16 v[224:225], v49 offset:48128
  ds_read_b64_tr_b16 v[226:227], v49 offset:49152
  v_mfma_f32_32x32x16_bf16 v[0:15], v[84:87], v[36:39], v[0:15]
  ds_read_b64_tr_b16 v[228:229], v49 offset:50176
  ds_read_b64_tr_b16 v[230:231], v49 offset:51200
  s_waitcnt lgkmcnt(6)
  s_nop 1
  v_mul_f32 v112, v245, v112
  v_mul_f32 v113, v245, v113
  v_cvt_pk_bf16_f32 v112, v112, v113
  v_mfma_f32_32x32x16_bf16 v[0:15], v[80:83], v[40:43], v[0:15]
  ds_read_b64_tr_b16 v[84:85], v49 offset:52224
  ds_read_b64_tr_b16 v[86:87], v49 offset:53248
  v_mul_f32 v114, v245, v114
  v_mul_f32 v115, v245, v115
  v_cvt_pk_bf16_f32 v113, v114, v115
  v_mul_f32 v116, v245, v116
  v_mfma_f32_32x32x16_bf16 v[0:15], v[232:235], v[44:47], v[0:15]
  ds_read_b64_tr_b16 v[80:81], v51 offset:22528
  ds_read_b64_tr_b16 v[82:83], v51 offset:23552
  s_waitcnt lgkmcnt(6)
  v_mul_f32 v117, v245, v117
  v_cvt_pk_bf16_f32 v114, v116, v117
  v_mul_f32 v118, v245, v118
  v_mfma_f32_32x32x16_bf16 v[0:15], v[236:239], v[96:99], v[0:15]
  ds_read_b64_tr_b16 v[232:233], v51 offset:24576
  ds_read_b64_tr_b16 v[234:235], v51 offset:25600
  v_mul_f32 v119, v245, v119
  v_cvt_pk_bf16_f32 v115, v118, v119
  v_mul_f32 v120, v245, v120
  v_mul_f32 v121, v245, v121
  v_mfma_f32_32x32x16_bf16 v[0:15], v[224:227], v[100:103], v[0:15]
  ds_read_b64_tr_b16 v[236:237], v51 offset:26624
  ds_read_b64_tr_b16 v[238:239], v51 offset:27648
  s_cbranch_vccz L_ow0_0a
  ds_write_b128 v54, v[112:115] offset:0
L_ow0_0a:
  s_cbranch_vccnz L_ow0_0b
  buffer_store_dwordx4 v[112:115], v255, s[24:27], s48 offen offset:0 sc1
L_ow0_0b:
  s_waitcnt lgkmcnt(6)
  v_cvt_pk_bf16_f32 v120, v120, v121
  v_mfma_f32_32x32x16_bf16 v[0:15], v[228:231], v[104:107], v[0:15]
  ds_read_b64_tr_b16 v[224:225], v51 offset:28672
  ds_read_b64_tr_b16 v[226:227], v51 offset:29696
  v_mul_f32 v122, v245, v122
  v_mul_f32 v123, v245, v123
  v_cvt_pk_bf16_f32 v121, v122, v123
  v_mul_f32 v124, v245, v124
  v_mfma_f32_32x32x16_bf16 v[0:15], v[84:87], v[108:111], v[0:15]
  ds_read_b64_tr_b16 v[228:229], v51 offset:30720
  ds_read_b64_tr_b16 v[230:231], v51 offset:31744
  s_waitcnt lgkmcnt(6)
  v_mul_f32 v125, v245, v125
  v_cvt_pk_bf16_f32 v122, v124, v125
  v_mul_f32 v126, v245, v126
  v_mfma_f32_32x32x16_bf16 v[0:15], v[80:83], v[128:131], v[0:15]
  ds_read_b64_tr_b16 v[84:85], v51 offset:32768
  ds_read_b64_tr_b16 v[86:87], v51 offset:33792
  v_mul_f32 v127, v245, v127
  v_cvt_pk_bf16_f32 v123, v126, v127
  v_mfma_f32_32x32x16_bf16 v[0:15], v[232:235], v[132:135], v[0:15]
  ds_read_b64_tr_b16 v[80:81], v51 offset:34816
  ds_read_b64_tr_b16 v[82:83], v51 offset:35840
  buffer_store_dwordx4 v[120:123], v255, s[24:27], s48 offen offset:1024 sc1
  s_waitcnt lgkmcnt(6)
  v_mfma_f32_32x32x16_bf16 v[0:15], v[236:239], v[136:139], v[0:15]
  ds_read_b64_tr_b16 v[232:233], v51 offset:36864
  ds_read_b64_tr_b16 v[234:235], v51 offset:37888
  v_mfma_f32_32x32x16_bf16 v[0:15], v[224:227], v[140:143], v[0:15]
  s_barrier
  ds_read_b64_tr_b16 v[236:237], v50 offset:39424
  ds_read_b64_tr_b16 v[238:239], v50 offset:40448
  s_waitcnt lgkmcnt(6)
  v_mfma_f32_32x32x16_bf16 v[0:15], v[228:231], v[16:19], v[0:15]
  ds_read_b64_tr_b16 v[224:225], v50 offset:41472
  ds_read_b64_tr_b16 v[226:227], v50 offset:42496
  v_mfma_f32_32x32x16_bf16 v[0:15], v[84:87], v[20:23], v[0:15]
  ds_read_b64_tr_b16 v[228:229], v50 offset:43520
  ds_read_b64_tr_b16 v[230:231], v50 offset:44544
  s_waitcnt lgkmcnt(6)
  v_mfma_f32_32x32x16_bf16 v[0:15], v[80:83], v[24:27], v[0:15]
  ds_read_b64_tr_b16 v[84:85], v50 offset:45568
  ds_read_b64_tr_b16 v[86:87], v50 offset:46592
  v_mfma_f32_32x32x16_bf16 v[0:15], v[232:235], v[28:31], v[0:15]
  ds_read_b64_tr_b16 v[80:81], v50 offset:47616
  ds_read_b64_tr_b16 v[82:83], v50 offset:48640
  s_waitcnt lgkmcnt(6)
  v_mfma_f32_32x32x16_bf16 v[112:127], v[236:239], v[32:35], 0
  ds_read_b64_tr_b16 v[232:233], v50 offset:49664
  ds_read_b64_tr_b16 v[234:235], v50 offset:50688
  v_mfma_f32_32x32x16_bf16 v[112:127], v[224:227], v[36:39], v[112:127]
  ds_read_b64_tr_b16 v[236:237], v50 offset:51712
  ds_read_b64_tr_b16 v[238:239], v50 offset:52736
  s_waitcnt lgkmcnt(6)
  s_nop 1
  v_mul_f32 v0, v245, v0
  v_mul_f32 v1, v245, v1
  v_cvt_pk_bf16_f32 v0, v0, v1
  v_mfma_f32_32x32x16_bf16 v[112:127], v[228:231], v[40:43], v[112:127]
  ds_read_b64_tr_b16 v[224:225], v50 offset:53760
  ds_read_b64_tr_b16 v[226:227], v50 offset:54784
  v_mul_f32 v2, v245, v2
  v_mul_f32 v3, v245, v3
  v_cvt_pk_bf16_f32 v1, v2, v3
  v_mul_f32 v4, v245, v4
  v_mfma_f32_32x32x16_bf16 v[112:127], v[84:87], v[44:47], v[112:127]
  ds_read_b64_tr_b16 v[228:229], v48 offset:20992
  ds_read_b64_tr_b16 v[230:231], v48 offset:22016
  s_waitcnt lgkmcnt(6)
  v_mul_f32 v5, v245, v5
  v_cvt_pk_bf16_f32 v2, v4, v5
  v_mul_f32 v6, v245, v6
  v_mfma_f32_32x32x16_bf16 v[112:127], v[80:83], v[96:99], v[112:127]
  ds_read_b64_tr_b16 v[84:85], v48 offset:23040
  ds_read_b64_tr_b16 v[86:87], v48 offset:24064
  v_mul_f32 v7, v245, v7
  v_cvt_pk_bf16_f32 v3, v6, v7
  v_mul_f32 v8, v245, v8
  v_mul_f32 v9, v245, v9
  v_mfma_f32_32x32x16_bf16 v[112:127], v[232:235], v[100:103], v[112:127]
  ds_read_b64_tr_b16 v[80:81], v48 offset:25088
  ds_read_b64_tr_b16 v[82:83], v48 offset:26112
  buffer_store_dwordx4 v[0:3], v255, s[24:27], s48 offen offset:2048 sc1
  s_waitcnt lgkmcnt(6)
  v_cvt_pk_bf16_f32 v8, v8, v9
  v_mfma_f32_32x32x16_bf16 v[112:127], v[236:239], v[104:107], v[112:127]
  ds_read_b64_tr_b16 v[232:233], v48 offset:27136
  ds_read_b64_tr_b16 v[234:235], v48 offset:28160
  v_mul_f32 v10, v245, v10
  v_mul_f32 v11, v245, v11
  v_cvt_pk_bf16_f32 v9, v10, v11
  v_mul_f32 v12, v245, v12
  v_mfma_f32_32x32x16_bf16 v[112:127], v[224:227], v[108:111], v[112:127]
  ds_read_b64_tr_b16 v[236:237], v48 offset:29184
  ds_read_b64_tr_b16 v[238:239], v48 offset:30208
  s_waitcnt lgkmcnt(6)
  v_mul_f32 v13, v245, v13
  v_cvt_pk_bf16_f32 v10, v12, v13
  v_mul_f32 v14, v245, v14
  v_mfma_f32_32x32x16_bf16 v[112:127], v[228:231], v[128:131], v[112:127]
  ds_read_b64_tr_b16 v[224:225], v48 offset:31232
  ds_read_b64_tr_b16 v[226:227], v48 offset:32256
  v_mul_f32 v15, v245, v15
  v_cvt_pk_bf16_f32 v11, v14, v15
  v_mfma_f32_32x32x16_bf16 v[112:127], v[84:87], v[132:135], v[112:127]
  ds_read_b64_tr_b16 v[228:229], v48 offset:33280
  ds_read_b64_tr_b16 v[230:231], v48 offset:34304
  buffer_store_dwordx4 v[8:11], v255, s[24:27], s48 offen offset:3072 sc1
  s_waitcnt lgkmcnt(6)
  v_mfma_f32_32x32x16_bf16 v[112:127], v[80:83], v[136:139], v[112:127]
  ds_read_b64_tr_b16 v[84:85], v48 offset:35328
  ds_read_b64_tr_b16 v[86:87], v48 offset:36352
  v_mfma_f32_32x32x16_bf16 v[112:127], v[232:235], v[140:143], v[112:127]
  ds_read_b64_tr_b16 v[80:81], v51 offset:39424
  ds_read_b64_tr_b16 v[82:83], v51 offset:40448
  s_waitcnt lgkmcnt(6)
  v_mfma_f32_32x32x16_bf16 v[112:127], v[236:239], v[16:19], v[112:127]
  ds_read_b64_tr_b16 v[232:233], v51 offset:41472
  ds_read_b64_tr_b16 v[234:235], v51 offset:42496
  v_mfma_f32_32x32x16_bf16 v[112:127], v[224:227], v[20:23], v[112:127]
  ds_read_b64_tr_b16 v[236:237], v51 offset:43520
  ds_read_b64_tr_b16 v[238:239], v51 offset:44544
  s_waitcnt lgkmcnt(6)
  v_mfma_f32_32x32x16_bf16 v[112:127], v[228:231], v[24:27], v[112:127]
  ds_read_b64_tr_b16 v[224:225], v51 offset:45568
  ds_read_b64_tr_b16 v[226:227], v51 offset:46592
  v_mfma_f32_32x32x16_bf16 v[112:127], v[84:87], v[28:31], v[112:127]
  ds_read_b64_tr_b16 v[228:229], v51 offset:47616
  ds_read_b64_tr_b16 v[230:231], v51 offset:48640
  s_waitcnt lgkmcnt(6)
  v_mfma_f32_32x32x16_bf16 v[0:15], v[80:83], v[32:35], 0
  ds_read_b64_tr_b16 v[84:85], v51 offset:49664
  ds_read_b64_tr_b16 v[86:87], v51 offset:50688
  v_mfma_f32_32x32x16_bf16 v[0:15], v[232:235], v[36:39], v[0:15]
  ds_read_b64_tr_b16 v[80:81], v51 offset:51712
  ds_read_b64_tr_b16 v[82:83], v51 offset:52736
  s_waitcnt lgkmcnt(6)
  s_nop 1
  v_mul_f32 v112, v245, v112
  v_mul_f32 v113, v245, v113
  v_cvt_pk_bf16_f32 v112, v112, v113
  v_mfma_f32_32x32x16_bf16 v[0:15], v[236:239], v[40:43], v[0:15]
  ds_read_b64_tr_b16 v[232:233], v51 offset:53760
  ds_read_b64_tr_b16 v[234:235], v51 offset:54784
  v_mul_f32 v114, v245, v114
  v_mul_f32 v115, v245, v115
  v_cvt_pk_bf16_f32 v113, v114, v115
  v_mul_f32 v116, v245, v116
  v_mfma_f32_32x32x16_bf16 v[0:15], v[224:227], v[44:47], v[0:15]
  ds_read_b64_tr_b16 v[236:237], v49 offset:20992
  ds_read_b64_tr_b16 v[238:239], v49 offset:22016
  s_waitcnt lgkmcnt(6)
  v_mul_f32 v117, v245, v117
  v_cvt_pk_bf16_f32 v114, v116, v117
  v_mul_f32 v118, v245, v118
  v_mfma_f32_32x32x16_bf16 v[0:15], v[228:231], v[96:99], v[0:15]
  ds_read_b64_tr_b16 v[224:225], v49 offset:23040
  ds_read_b64_tr_b16 v[226:227], v49 offset:24064
  v_mul_f32 v119, v245, v119
  v_cvt_pk_bf16_f32 v115, v118, v119
  v_mul_f32 v120, v245, v120
  v_mul_f32 v121, v245, v121
  v_mfma_f32_32x32x16_bf16 v[0:15], v[84:87], v[100:103], v[0:15]
  ds_read_b64_tr_b16 v[228:229], v49 offset:25088
  ds_read_b64_tr_b16 v[230:231], v49 offset:26112
  s_cbranch_vccz L_ow2_0a
  ds_write_b128 v54, v[112:115] offset:1024
L_ow2_0a:
  s_cbranch_vccnz L_ow2_0b
  buffer_store_dwordx4 v[112:115], v255, s[24:27], s49 offen offset:0 sc1
L_ow2_0b:
  s_waitcnt lgkmcnt(6)
  v_cvt_pk_bf16_f32 v120, v120, v121
  v_mfma_f32_32x32x16_bf16 v[0:15], v[80:83], v[104:107], v[0:15]
  ds_read_b64_tr_b16 v[84:85], v49 offset:27136
  ds_read_b64_tr_b16 v[86:87], v49 offset:28160
  v_mul_f32 v122, v245, v122
  v_mul_f32 v123, v245, v123
  v_cvt_pk_bf16_f32 v121, v122, v123
  v_mul_f32 v124, v245, v124
  v_mfma_f32_32x32x16_bf16 v[0:15], v[232:235], v[108:111], v[0:15]
  ds_read_b64_tr_b16 v[80:81], v49 offset:29184
  ds_read_b64_tr_b16 v[82:83], v49 offset:30208
  s_waitcnt lgkmcnt(6)
  v_mul_f32 v125, v245, v125
  v_cvt_pk_bf16_f32 v122, v124, v125
  v_mul_f32 v126, v245, v126
  v_mfma_f32_32x32x16_bf16 v[0:15], v[236:239], v[128:131], v[0:15]
  ds_read_b64_tr_b16 v[232:233], v49 offset:31232
  ds_read_b64_tr_b16 v[234:235], v49 offset:32256
  v_mul_f32 v127, v245, v127
  v_cvt_pk_bf16_f32 v123, v126, v127
  v_mfma_f32_32x32x16_bf16 v[0:15], v[224:227], v[132:135], v[0:15]
  ds_read_b64_tr_b16 v[236:237], v49 offset:33280
  ds_read_b64_tr_b16 v[238:239], v49 offset:34304
  buffer_store_dwordx4 v[120:123], v255, s[24:27], s49 offen offset:1024 sc1
  s_waitcnt lgkmcnt(6)
  v_mfma_f32_32x32x16_bf16 v[0:15], v[228:231], v[136:139], v[0:15]
  ds_read_b64_tr_b16 v[224:225], v49 offset:35328
  ds_read_b64_tr_b16 v[226:227], v49 offset:36352
  v_mfma_f32_32x32x16_bf16 v[0:15], v[84:87], v[140:143], v[0:15]
  s_barrier
  ds_read_b64_tr_b16 v[228:229], v52 offset:24064
  ds_read_b64_tr_b16 v[230:231], v52 offset:25088
  s_waitcnt lgkmcnt(6)
  v_mfma_f32_32x32x16_bf16 v[0:15], v[80:83], v[16:19], v[0:15]
  ds_read_b64_tr_b16 v[84:85], v52 offset:26112
  ds_read_b64_tr_b16 v[86:87], v52 offset:27136
  v_mfma_f32_32x32x16_bf16 v[0:15], v[232:235], v[20:23], v[0:15]
  ds_read_b64_tr_b16 v[80:81], v52 offset:28160
  ds_read_b64_tr_b16 v[82:83], v52 offset:29184
  s_waitcnt lgkmcnt(6)
  v_mfma_f32_32x32x16_bf16 v[0:15], v[236:239], v[24:27], v[0:15]
  ds_read_b64_tr_b16 v[232:233], v52 offset:30208
  ds_read_b64_tr_b16 v[234:235], v52 offset:31232
  v_mfma_f32_32x32x16_bf16 v[0:15], v[224:227], v[28:31], v[0:15]
  ds_read_b64_tr_b16 v[236:237], v52 offset:32256
  ds_read_b64_tr_b16 v[238:239], v52 offset:33280
  s_waitcnt lgkmcnt(6)
  v_mfma_f32_32x32x16_bf16 v[112:127], v[228:231], v[32:35], 0
  ds_read_b64_tr_b16 v[224:225], v52 offset:34304
  ds_read_b64_tr_b16 v[226:227], v52 offset:35328
  v_mfma_f32_32x32x16_bf16 v[112:127], v[84:87], v[36:39], v[112:127]
  ds_read_b64_tr_b16 v[228:229], v52 offset:36352
  ds_read_b64_tr_b16 v[230:231], v52 offset:37376
  s_waitcnt lgkmcnt(6)
  s_nop 1
  v_mul_f32 v0, v245, v0
  v_mul_f32 v1, v245, v1
  v_cvt_pk_bf16_f32 v0, v0, v1
  v_mfma_f32_32x32x16_bf16 v[112:127], v[80:83], v[40:43], v[112:127]
  ds_read_b64_tr_b16 v[84:85], v52 offset:38400
  ds_read_b64_tr_b16 v[86:87], v52 offset:39424
  v_mul_f32 v2, v245, v2
  v_mul_f32 v3, v245, v3
  v_cvt_pk_bf16_f32 v1, v2, v3
  v_mul_f32 v4, v245, v4
  v_mfma_f32_32x32x16_bf16 v[112:127], v[232:235], v[44:47], v[112:127]
  ds_read_b64_tr_b16 v[80:81], v52 offset:7168
  ds_read_b64_tr_b16 v[82:83], v52 offset:8192
  s_waitcnt lgkmcnt(6)
  v_mul_f32 v5, v245, v5
  v_cvt_pk_bf16_f32 v2, v4, v5
  v_mul_f32 v6, v245, v6
  v_mfma_f32_32x32x16_bf16 v[112:127], v[236:239], v[96:99], v[112:127]
  ds_read_b64_tr_b16 v[232:233], v52 offset:9216
  ds_read_b64_tr_b16 v[234:235], v52 offset:10240
  v_mul_f32 v7, v245, v7
  v_cvt_pk_bf16_f32 v3, v6, v7
  v_mul_f32 v8, v245, v8
  v_mul_f32 v9, v245, v9
  v_mfma_f32_32x32x16_bf16 v[112:127], v[224:227], v[100:103], v[112:127]
  ds_read_b64_tr_b16 v[236:237], v52 offset:11264
  ds_read_b64_tr_b16 v[238:239], v52 offset:12288
  buffer_store_dwordx4 v[0:3], v255, s[24:27], s49 offen offset:2048 sc1
  s_waitcnt lgkmcnt(6)
  v_cvt_pk_bf16_f32 v8, v8, v9
  v_mfma_f32_32x32x16_bf16 v[112:127], v[228:231], v[104:107], v[112:127]
  ds_read_b64_tr_b16 v[224:225], v52 offset:13312
  ds_read_b64_tr_b16 v[226:227], v52 offset:14336
  v_mul_f32 v10, v245, v10
  v_mul_f32 v11, v245, v11
  v_cvt_pk_bf16_f32 v9, v10, v11
  v_mul_f32 v12, v245, v12
  v_mfma_f32_32x32x16_bf16 v[112:127], v[84:87], v[108:111], v[112:127]
  ds_read_b64_tr_b16 v[228:229], v52 offset:15360
  ds_read_b64_tr_b16 v[230:231], v52 offset:16384
  s_waitcnt lgkmcnt(6)
  v_mul_f32 v13, v245, v13
  v_cvt_pk_bf16_f32 v10, v12, v13
  v_mul_f32 v14, v245, v14
  v_mfma_f32_32x32x16_bf16 v[112:127], v[80:83], v[128:131], v[112:127]
  ds_read_b64_tr_b16 v[84:85], v52 offset:17408
  ds_read_b64_tr_b16 v[86:87], v52 offset:18432
  v_mul_f32 v15, v245, v15
  v_cvt_pk_bf16_f32 v11, v14, v15
  v_mfma_f32_32x32x16_bf16 v[112:127], v[232:235], v[132:135], v[112:127]
  ds_read_b64_tr_b16 v[80:81], v52 offset:19456
  ds_read_b64_tr_b16 v[82:83], v52 offset:20480
  buffer_store_dwordx4 v[8:11], v255, s[24:27], s49 offen offset:3072 sc1
  s_waitcnt lgkmcnt(6)
  v_mfma_f32_32x32x16_bf16 v[112:127], v[236:239], v[136:139], v[112:127]
  ds_read_b64_tr_b16 v[232:233], v52 offset:21504
  ds_read_b64_tr_b16 v[234:235], v52 offset:22528
  v_mfma_f32_32x32x16_bf16 v[112:127], v[224:227], v[140:143], v[112:127]
  ds_read_b64_tr_b16 v[236:237], v53 offset:24064
  ds_read_b64_tr_b16 v[238:239], v53 offset:25088
  s_waitcnt lgkmcnt(6)
  v_mfma_f32_32x32x16_bf16 v[112:127], v[228:231], v[16:19], v[112:127]
  ds_read_b64_tr_b16 v[224:225], v53 offset:26112
  ds_read_b64_tr_b16 v[226:227], v53 offset:27136
  v_mfma_f32_32x32x16_bf16 v[112:127], v[84:87], v[20:23], v[112:127]
  ds_read_b64_tr_b16 v[228:229], v53 offset:28160
  ds_read_b64_tr_b16 v[230:231], v53 offset:29184
  s_waitcnt lgkmcnt(6)
  v_mfma_f32_32x32x16_bf16 v[112:127], v[80:83], v[24:27], v[112:127]
  ds_read_b64_tr_b16 v[84:85], v53 offset:30208
  ds_read_b64_tr_b16 v[86:87], v53 offset:31232
  v_mfma_f32_32x32x16_bf16 v[112:127], v[232:235], v[28:31], v[112:127]
  ds_read_b64_tr_b16 v[80:81], v53 offset:32256
  ds_read_b64_tr_b16 v[82:83], v53 offset:33280
  s_waitcnt lgkmcnt(6)
  v_mfma_f32_32x32x16_bf16 v[0:15], v[236:239], v[32:35], 0
  ds_read_b64_tr_b16 v[232:233], v53 offset:34304
  ds_read_b64_tr_b16 v[234:235], v53 offset:35328
  v_mfma_f32_32x32x16_bf16 v[0:15], v[224:227], v[36:39], v[0:15]
  ds_read_b64_tr_b16 v[236:237], v53 offset:36352
  ds_read_b64_tr_b16 v[238:239], v53 offset:37376
  s_waitcnt lgkmcnt(6)
  s_nop 1
  v_mul_f32 v112, v245, v112
  v_mul_f32 v113, v245, v113
  v_cvt_pk_bf16_f32 v112, v112, v113
  v_mfma_f32_32x32x16_bf16 v[0:15], v[228:231], v[40:43], v[0:15]
  ds_read_b64_tr_b16 v[224:225], v53 offset:38400
  ds_read_b64_tr_b16 v[226:227], v53 offset:39424
  v_mul_f32 v114, v245, v114
  v_mul_f32 v115, v245, v115
  v_cvt_pk_bf16_f32 v113, v114, v115
  v_mul_f32 v116, v245, v116
  v_mfma_f32_32x32x16_bf16 v[0:15], v[84:87], v[44:47], v[0:15]
  ds_read_b64_tr_b16 v[228:229], v53 offset:7168
  ds_read_b64_tr_b16 v[230:231], v53 offset:8192
  s_waitcnt lgkmcnt(6)
  v_mul_f32 v117, v245, v117
  v_cvt_pk_bf16_f32 v114, v116, v117
  v_mul_f32 v118, v245, v118
  v_mfma_f32_32x32x16_bf16 v[0:15], v[80:83], v[96:99], v[0:15]
  ds_read_b64_tr_b16 v[84:85], v53 offset:9216
  ds_read_b64_tr_b16 v[86:87], v53 offset:10240
  v_mul_f32 v119, v245, v119
  v_cvt_pk_bf16_f32 v115, v118, v119
  v_mul_f32 v120, v245, v120
  v_mul_f32 v121, v245, v121
  v_mfma_f32_32x32x16_bf16 v[0:15], v[232:235], v[100:103], v[0:15]
  ds_read_b64_tr_b16 v[80:81], v53 offset:11264
  ds_read_b64_tr_b16 v[82:83], v53 offset:12288
  s_cbranch_vccz L_ow4_0a
  ds_write_b128 v54, v[112:115] offset:2048
L_ow4_0a:
  s_cbranch_vccnz L_ow4_0b
  buffer_store_dwordx4 v[112:115], v255, s[24:27], s50 offen offset:0 sc1
L_ow4_0b:
  s_waitcnt lgkmcnt(6)
  v_cvt_pk_bf16_f32 v120, v120, v121
  v_mfma_f32_32x32x16_bf16 v[0:15], v[236:239], v[104:107], v[0:15]
  ds_read_b64_tr_b16 v[232:233], v53 offset:13312
  ds_read_b64_tr_b16 v[234:235], v53 offset:14336
  v_mul_f32 v122, v245, v122
  v_mul_f32 v123, v245, v123
  v_cvt_pk_bf16_f32 v121, v122, v123
  v_mul_f32 v124, v245, v124
  v_mfma_f32_32x32x16_bf16 v[0:15], v[224:227], v[108:111], v[0:15]
  ds_read_b64_tr_b16 v[236:237], v53 offset:15360
  ds_read_b64_tr_b16 v[238:239], v53 offset:16384
  s_waitcnt lgkmcnt(6)
  v_mul_f32 v125, v245, v125
  v_cvt_pk_bf16_f32 v122, v124, v125
  v_mul_f32 v126, v245, v126
  v_mfma_f32_32x32x16_bf16 v[0:15], v[228:231], v[128:131], v[0:15]
  ds_read_b64_tr_b16 v[224:225], v53 offset:17408
  ds_read_b64_tr_b16 v[226:227], v53 offset:18432
  v_mul_f32 v127, v245, v127
  v_cvt_pk_bf16_f32 v123, v126, v127
  v_mfma_f32_32x32x16_bf16 v[0:15], v[84:87], v[132:135], v[0:15]
  ds_read_b64_tr_b16 v[228:229], v53 offset:19456
  ds_read_b64_tr_b16 v[230:231], v53 offset:20480
  buffer_store_dwordx4 v[120:123], v255, s[24:27], s50 offen offset:1024 sc1
  s_waitcnt lgkmcnt(6)
  v_mfma_f32_32x32x16_bf16 v[0:15], v[80:83], v[136:139], v[0:15]
  ds_read_b64_tr_b16 v[84:85], v53 offset:21504
  ds_read_b64_tr_b16 v[86:87], v53 offset:22528
  v_mfma_f32_32x32x16_bf16 v[0:15], v[232:235], v[140:143], v[0:15]
  s_barrier
  ds_read_b64_tr_b16 v[80:81], v50 offset:5632
  ds_read_b64_tr_b16 v[82:83], v50 offset:6656
  s_waitcnt lgkmcnt(6)
  v_mfma_f32_32x32x16_bf16 v[0:15], v[236:239], v[16:19], v[0:15]
  ds_read_b64_tr_b16 v[232:233], v50 offset:7680
  ds_read_b64_tr_b16 v[234:235], v50 offset:8704
  v_mfma_f32_32x32x16_bf16 v[0:15], v[224:227], v[20:23], v[0:15]
  ds_read_b64_tr_b16 v[236:237], v50 offset:9728
  ds_read_b64_tr_b16 v[238:239], v50 offset:10752
  s_waitcnt lgkmcnt(6)
  v_mfma_f32_32x32x16_bf16 v[0:15], v[228:231], v[24:27], v[0:15]
  ds_read_b64_tr_b16 v[224:225], v50 offset:11776
  ds_read_b64_tr_b16 v[226:227], v50 offset:12800
  v_mfma_f32_32x32x16_bf16 v[0:15], v[84:87], v[28:31], v[0:15]
  ds_read_b64_tr_b16 v[228:229], v50 offset:13824
  ds_read_b64_tr_b16 v[230:231], v50 offset:14848
  s_waitcnt lgkmcnt(6)
  v_mfma_f32_32x32x16_bf16 v[112:127], v[80:83], v[32:35], 0
  ds_read_b64_tr_b16 v[84:85], v50 offset:15872
  ds_read_b64_tr_b16 v[86:87], v50 offset:16896
  v_mfma_f32_32x32x16_bf16 v[112:127], v[232:235], v[36:39], v[112:127]
  ds_read_b64_tr_b16 v[80:81], v50 offset:17920
  ds_read_b64_tr_b16 v[82:83], v50 offset:18944
  s_waitcnt lgkmcnt(6)
  s_nop 1
  v_mul_f32 v0, v245, v0
  v_mul_f32 v1, v245, v1
  v_cvt_pk_bf16_f32 v0, v0, v1
  v_mfma_f32_32x32x16_bf16 v[112:127], v[236:239], v[40:43], v[112:127]
  ds_read_b64_tr_b16 v[232:233], v50 offset:19968
  ds_read_b64_tr_b16 v[234:235], v50 offset:20992
  v_mul_f32 v2, v245, v2
  v_mul_f32 v3, v245, v3
  v_cvt_pk_bf16_f32 v1, v2, v3
  v_mul_f32 v4, v245, v4
  v_mfma_f32_32x32x16_bf16 v[112:127], v[224:227], v[44:47], v[112:127]
  ds_read_b64_tr_b16 v[236:237], v52 offset:40960
  ds_read_b64_tr_b16 v[238:239], v52 offset:41984
  s_waitcnt lgkmcnt(6)
  v_mul_f32 v5, v245, v5
  v_cvt_pk_bf16_f32 v2, v4, v5
  v_mul_f32 v6, v245, v6
  v_mfma_f32_32x32x16_bf16 v[112:127], v[228:231], v[96:99], v[112:127]
  ds_read_b64_tr_b16 v[224:225], v52 offset:43008
  ds_read_b64_tr_b16 v[226:227], v52 offset:44032
  v_mul_f32 v7, v245, v7
  v_cvt_pk_bf16_f32 v3, v6, v7
  v_mul_f32 v8, v245, v8
  v_mul_f32 v9, v245, v9
  v_mfma_f32_32x32x16_bf16 v[112:127], v[84:87], v[100:103], v[112:127]
  ds_read_b64_tr_b16 v[228:229], v52 offset:45056
  ds_read_b64_tr_b16 v[230:231], v52 offset:46080
  buffer_store_dwordx4 v[0:3], v255, s[24:27], s50 offen offset:2048 sc1
  s_waitcnt lgkmcnt(6)
  v_cvt_pk_bf16_f32 v8, v8, v9
  v_mfma_f32_32x32x16_bf16 v[112:127], v[80:83], v[104:107], v[112:127]
  ds_read_b64_tr_b16 v[84:85], v52 offset:47104
  ds_read_b64_tr_b16 v[86:87], v52 offset:48128
  v_mul_f32 v10, v245, v10
  v_mul_f32 v11, v245, v11
  v_cvt_pk_bf16_f32 v9, v10, v11
  v_mul_f32 v12, v245, v12
  v_mfma_f32_32x32x16_bf16 v[112:127], v[232:235], v[108:111], v[112:127]
  ds_read_b64_tr_b16 v[80:81], v52 offset:49152
  ds_read_b64_tr_b16 v[82:83], v52 offset:50176
  s_waitcnt lgkmcnt(6)
  v_mul_f32 v13, v245, v13
  v_cvt_pk_bf16_f32 v10, v12, v13
  v_mul_f32 v14, v245, v14
  v_mfma_f32_32x32x16_bf16 v[112:127], v[236:239], v[128:131], v[112:127]
  ds_read_b64_tr_b16 v[232:233], v52 offset:51200
  ds_read_b64_tr_b16 v[234:235], v52 offset:52224
  v_mul_f32 v15, v245, v15
  v_cvt_pk_bf16_f32 v11, v14, v15
  v_mfma_f32_32x32x16_bf16 v[112:127], v[224:227], v[132:135], v[112:127]
  ds_read_b64_tr_b16 v[236:237], v52 offset:53248
  ds_read_b64_tr_b16 v[238:239], v52 offset:54272
  buffer_store_dwordx4 v[8:11], v255, s[24:27], s50 offen offset:3072 sc1
  s_waitcnt lgkmcnt(6)
  v_mfma_f32_32x32x16_bf16 v[112:127], v[228:231], v[136:139], v[112:127]
  ds_read_b64_tr_b16 v[224:225], v52 offset:55296
  ds_read_b64_tr_b16 v[226:227], v52 offset:56320
  v_mfma_f32_32x32x16_bf16 v[112:127], v[84:87], v[140:143], v[112:127]
  ds_read_b64_tr_b16 v[228:229], v51 offset:5632
  ds_read_b64_tr_b16 v[230:231], v51 offset:6656
  s_waitcnt lgkmcnt(6)
  v_mfma_f32_32x32x16_bf16 v[112:127], v[80:83], v[16:19], v[112:127]
  ds_read_b64_tr_b16 v[84:85], v51 offset:7680
  ds_read_b64_tr_b16 v[86:87], v51 offset:8704
  v_mfma_f32_32x32x16_bf16 v[112:127], v[232:235], v[20:23], v[112:127]
  ds_read_b64_tr_b16 v[80:81], v51 offset:9728
  ds_read_b64_tr_b16 v[82:83], v51 offset:10752
  s_waitcnt lgkmcnt(6)
  v_mfma_f32_32x32x16_bf16 v[112:127], v[236:239], v[24:27], v[112:127]
  ds_read_b64_tr_b16 v[232:233], v51 offset:11776
  ds_read_b64_tr_b16 v[234:235], v51 offset:12800
  v_mfma_f32_32x32x16_bf16 v[112:127], v[224:227], v[28:31], v[112:127]
  ds_read_b64_tr_b16 v[236:237], v51 offset:13824
  ds_read_b64_tr_b16 v[238:239], v51 offset:14848
  s_waitcnt lgkmcnt(6)
  v_mfma_f32_32x32x16_bf16 v[0:15], v[228:231], v[32:35], 0
  ds_read_b64_tr_b16 v[224:225], v51 offset:15872
  ds_read_b64_tr_b16 v[226:227], v51 offset:16896
  v_mfma_f32_32x32x16_bf16 v[0:15], v[84:87], v[36:39], v[0:15]
  ds_read_b64_tr_b16 v[228:229], v51 offset:17920
  ds_read_b64_tr_b16 v[230:231], v51 offset:18944
  s_waitcnt lgkmcnt(6)
  s_nop 1
  v_mul_f32 v112, v245, v112
  v_mul_f32 v113, v245, v113
  v_cvt_pk_bf16_f32 v112, v112, v113
  v_mfma_f32_32x32x16_bf16 v[0:15], v[80:83], v[40:43], v[0:15]
  ds_read_b64_tr_b16 v[84:85], v51 offset:19968
  ds_read_b64_tr_b16 v[86:87], v51 offset:20992
  v_mul_f32 v114, v245, v114
  v_mul_f32 v115, v245, v115
  v_cvt_pk_bf16_f32 v113, v114, v115
  v_mul_f32 v116, v245, v116
  v_mfma_f32_32x32x16_bf16 v[0:15], v[232:235], v[44:47], v[0:15]
  ds_read_b64_tr_b16 v[80:81], v53 offset:40960
  ds_read_b64_tr_b16 v[82:83], v53 offset:41984
  s_waitcnt lgkmcnt(6)
  v_mul_f32 v117, v245, v117
  v_cvt_pk_bf16_f32 v114, v116, v117
  v_mul_f32 v118, v245, v118
  v_mfma_f32_32x32x16_bf16 v[0:15], v[236:239], v[96:99], v[0:15]
  ds_read_b64_tr_b16 v[232:233], v53 offset:43008
  ds_read_b64_tr_b16 v[234:235], v53 offset:44032
  v_mul_f32 v119, v245, v119
  v_cvt_pk_bf16_f32 v115, v118, v119
  v_mul_f32 v120, v245, v120
  v_mul_f32 v121, v245, v121
  v_mfma_f32_32x32x16_bf16 v[0:15], v[224:227], v[100:103], v[0:15]
  ds_read_b64_tr_b16 v[236:237], v53 offset:45056
  ds_read_b64_tr_b16 v[238:239], v53 offset:46080
  s_cbranch_vccz L_ow6_0a
  ds_write_b128 v54, v[112:115] offset:3072
L_ow6_0a:
  s_cbranch_vccnz L_ow6_0b
  buffer_store_dwordx4 v[112:115], v255, s[24:27], s51 offen offset:0 sc1
L_ow6_0b:
  s_waitcnt lgkmcnt(6)
  v_cvt_pk_bf16_f32 v120, v120, v121
  v_mfma_f32_32x32x16_bf16 v[0:15], v[228:231], v[104:107], v[0:15]
  ds_read_b64_tr_b16 v[224:225], v53 offset:47104
  ds_read_b64_tr_b16 v[226:227], v53 offset:48128
  v_mul_f32 v122, v245, v122
  v_mul_f32 v123, v245, v123
  v_cvt_pk_bf16_f32 v121, v122, v123
  v_mul_f32 v124, v245, v124
  v_mfma_f32_32x32x16_bf16 v[0:15], v[84:87], v[108:111], v[0:15]
  ds_read_b64_tr_b16 v[228:229], v53 offset:49152
  ds_read_b64_tr_b16 v[230:231], v53 offset:50176
  s_waitcnt lgkmcnt(6)
  v_mul_f32 v125, v245, v125
  v_cvt_pk_bf16_f32 v122, v124, v125
  v_mul_f32 v126, v245, v126
  v_mfma_f32_32x32x16_bf16 v[0:15], v[80:83], v[128:131], v[0:15]
  ds_read_b64_tr_b16 v[84:85], v53 offset:51200
  ds_read_b64_tr_b16 v[86:87], v53 offset:52224
  v_mul_f32 v127, v245, v127
  v_cvt_pk_bf16_f32 v123, v126, v127
  v_mfma_f32_32x32x16_bf16 v[0:15], v[232:235], v[132:135], v[0:15]
  ds_read_b64_tr_b16 v[80:81], v53 offset:53248
  ds_read_b64_tr_b16 v[82:83], v53 offset:54272
  buffer_store_dwordx4 v[120:123], v255, s[24:27], s51 offen offset:1024 sc1
  s_waitcnt lgkmcnt(6)
  v_mfma_f32_32x32x16_bf16 v[0:15], v[236:239], v[136:139], v[0:15]
  ds_read_b64_tr_b16 v[232:233], v53 offset:55296
  ds_read_b64_tr_b16 v[234:235], v53 offset:56320
  v_mfma_f32_32x32x16_bf16 v[0:15], v[224:227], v[140:143], v[0:15]
  s_barrier
  ds_read_b64_tr_b16 v[236:237], v48 offset:4096
  ds_read_b64_tr_b16 v[238:239], v48 offset:5120
  s_waitcnt lgkmcnt(6)
  v_mfma_f32_32x32x16_bf16 v[0:15], v[228:231], v[16:19], v[0:15]
  ds_read_b64_tr_b16 v[224:225], v48 offset:6144
  ds_read_b64_tr_b16 v[226:227], v48 offset:7168
  v_mfma_f32_32x32x16_bf16 v[0:15], v[84:87], v[20:23], v[0:15]
  ds_read_b64_tr_b16 v[228:229], v48 offset:8192
  ds_read_b64_tr_b16 v[230:231], v48 offset:9216
  s_waitcnt lgkmcnt(6)
  v_mfma_f32_32x32x16_bf16 v[0:15], v[80:83], v[24:27], v[0:15]
  ds_read_b64_tr_b16 v[84:85], v48 offset:10240
  ds_read_b64_tr_b16 v[86:87], v48 offset:11264
  v_mfma_f32_32x32x16_bf16 v[0:15], v[232:235], v[28:31], v[0:15]
  ds_read_b64_tr_b16 v[80:81], v48 offset:12288
  ds_read_b64_tr_b16 v[82:83], v48 offset:13312
  s_waitcnt lgkmcnt(6)
  v_mfma_f32_32x32x16_bf16 v[112:127], v[236:239], v[32:35], 0
  ds_read_b64_tr_b16 v[232:233], v48 offset:14336
  ds_read_b64_tr_b16 v[234:235], v48 offset:15360
  v_mfma_f32_32x32x16_bf16 v[112:127], v[224:227], v[36:39], v[112:127]
  ds_read_b64_tr_b16 v[236:237], v48 offset:16384
  ds_read_b64_tr_b16 v[238:239], v48 offset:17408
  s_waitcnt lgkmcnt(6)
  s_nop 1
  v_mul_f32 v0, v245, v0
  v_mul_f32 v1, v245, v1
  v_cvt_pk_bf16_f32 v0, v0, v1
  v_mfma_f32_32x32x16_bf16 v[112:127], v[228:231], v[40:43], v[112:127]
  ds_read_b64_tr_b16 v[224:225], v48 offset:18432
  ds_read_b64_tr_b16 v[226:227], v48 offset:19456
  v_mul_f32 v2, v245, v2
  v_mul_f32 v3, v245, v3
  v_cvt_pk_bf16_f32 v1, v2, v3
  v_mul_f32 v4, v245, v4
  v_mfma_f32_32x32x16_bf16 v[112:127], v[84:87], v[44:47], v[112:127]
  ds_read_b64_tr_b16 v[228:229], v48 offset:37888
  ds_read_b64_tr_b16 v[230:231], v48 offset:38912
  s_waitcnt lgkmcnt(6)
  v_mul_f32 v5, v245, v5
  v_cvt_pk_bf16_f32 v2, v4, v5
  v_mul_f32 v6, v245, v6
  v_mfma_f32_32x32x16_bf16 v[112:127], v[80:83], v[96:99], v[112:127]
  ds_read_b64_tr_b16 v[84:85], v48 offset:39936
  ds_read_b64_tr_b16 v[86:87], v48 offset:40960
  v_mul_f32 v7, v245, v7
  v_cvt_pk_bf16_f32 v3, v6, v7
  v_mul_f32 v8, v245, v8
  v_mul_f32 v9, v245, v9
  v_mfma_f32_32x32x16_bf16 v[112:127], v[232:235], v[100:103], v[112:127]
  ds_read_b64_tr_b16 v[80:81], v48 offset:41984
  ds_read_b64_tr_b16 v[82:83], v48 offset:43008
  buffer_store_dwordx4 v[0:3], v255, s[24:27], s51 offen offset:2048 sc1
  s_waitcnt lgkmcnt(6)
  v_cvt_pk_bf16_f32 v8, v8, v9
  v_mfma_f32_32x32x16_bf16 v[112:127], v[236:239], v[104:107], v[112:127]
  ds_read_b64_tr_b16 v[232:233], v48 offset:44032
  ds_read_b64_tr_b16 v[234:235], v48 offset:45056
  v_mul_f32 v10, v245, v10
  v_mul_f32 v11, v245, v11
  v_cvt_pk_bf16_f32 v9, v10, v11
  v_mul_f32 v12, v245, v12
  v_mfma_f32_32x32x16_bf16 v[112:127], v[224:227], v[108:111], v[112:127]
  ds_read_b64_tr_b16 v[236:237], v48 offset:46080
  ds_read_b64_tr_b16 v[238:239], v48 offset:47104
  s_waitcnt lgkmcnt(6)
  v_mul_f32 v13, v245, v13
  v_cvt_pk_bf16_f32 v10, v12, v13
  v_mul_f32 v14, v245, v14
  v_mfma_f32_32x32x16_bf16 v[112:127], v[228:231], v[128:131], v[112:127]
  ds_read_b64_tr_b16 v[224:225], v48 offset:48128
  ds_read_b64_tr_b16 v[226:227], v48 offset:49152
  v_mul_f32 v15, v245, v15
  v_cvt_pk_bf16_f32 v11, v14, v15
  v_mfma_f32_32x32x16_bf16 v[112:127], v[84:87], v[132:135], v[112:127]
  ds_read_b64_tr_b16 v[228:229], v48 offset:50176
  ds_read_b64_tr_b16 v[230:231], v48 offset:51200
  buffer_store_dwordx4 v[8:11], v255, s[24:27], s51 offen offset:3072 sc1
  s_waitcnt lgkmcnt(6)
  v_mfma_f32_32x32x16_bf16 v[112:127], v[80:83], v[136:139], v[112:127]
  ds_read_b64_tr_b16 v[84:85], v48 offset:52224
  ds_read_b64_tr_b16 v[86:87], v48 offset:53248
  v_mfma_f32_32x32x16_bf16 v[112:127], v[232:235], v[140:143], v[112:127]
  ds_read_b64_tr_b16 v[80:81], v49 offset:4096
  ds_read_b64_tr_b16 v[82:83], v49 offset:5120
  s_waitcnt lgkmcnt(6)
  v_mfma_f32_32x32x16_bf16 v[112:127], v[236:239], v[16:19], v[112:127]
  ds_read_b64_tr_b16 v[232:233], v49 offset:6144
  ds_read_b64_tr_b16 v[234:235], v49 offset:7168
  v_mfma_f32_32x32x16_bf16 v[112:127], v[224:227], v[20:23], v[112:127]
  ds_read_b64_tr_b16 v[236:237], v49 offset:8192
  ds_read_b64_tr_b16 v[238:239], v49 offset:9216
  s_waitcnt lgkmcnt(6)
  v_mfma_f32_32x32x16_bf16 v[112:127], v[228:231], v[24:27], v[112:127]
  ds_read_b64_tr_b16 v[224:225], v49 offset:10240
  ds_read_b64_tr_b16 v[226:227], v49 offset:11264
  v_mfma_f32_32x32x16_bf16 v[112:127], v[84:87], v[28:31], v[112:127]
  ds_read_b64_tr_b16 v[228:229], v49 offset:12288
  ds_read_b64_tr_b16 v[230:231], v49 offset:13312
  s_waitcnt lgkmcnt(6)
  v_mfma_f32_32x32x16_bf16 v[0:15], v[80:83], v[32:35], 0
  ds_read_b64_tr_b16 v[84:85], v49 offset:14336
  ds_read_b64_tr_b16 v[86:87], v49 offset:15360
  v_mfma_f32_32x32x16_bf16 v[0:15], v[232:235], v[36:39], v[0:15]
  ds_read_b64_tr_b16 v[80:81], v49 offset:16384
  ds_read_b64_tr_b16 v[82:83], v49 offset:17408
  s_waitcnt lgkmcnt(6)
  s_nop 1
  v_mul_f32 v112, v245, v112
  v_mul_f32 v113, v245, v113
  v_cvt_pk_bf16_f32 v112, v112, v113
  v_mfma_f32_32x32x16_bf16 v[0:15], v[236:239], v[40:43], v[0:15]
  ds_read_b64_tr_b16 v[232:233], v49 offset:18432
  ds_read_b64_tr_b16 v[234:235], v49 offset:19456
  v_mul_f32 v114, v245, v114
  v_mul_f32 v115, v245, v115
  v_cvt_pk_bf16_f32 v113, v114, v115
  v_mul_f32 v116, v245, v116
  v_mfma_f32_32x32x16_bf16 v[0:15], v[224:227], v[44:47], v[0:15]
  ds_read_b64_tr_b16 v[236:237], v49 offset:37888
  ds_read_b64_tr_b16 v[238:239], v49 offset:38912
  s_waitcnt lgkmcnt(6)
  v_mul_f32 v117, v245, v117
  v_cvt_pk_bf16_f32 v114, v116, v117
  v_mul_f32 v118, v245, v118
  v_mfma_f32_32x32x16_bf16 v[0:15], v[228:231], v[96:99], v[0:15]
  ds_read_b64_tr_b16 v[224:225], v49 offset:39936
  ds_read_b64_tr_b16 v[226:227], v49 offset:40960
  v_mul_f32 v119, v245, v119
  v_cvt_pk_bf16_f32 v115, v118, v119
  v_mul_f32 v120, v245, v120
  v_mul_f32 v121, v245, v121
  v_mfma_f32_32x32x16_bf16 v[0:15], v[84:87], v[100:103], v[0:15]
  ds_read_b64_tr_b16 v[228:229], v49 offset:41984
  ds_read_b64_tr_b16 v[230:231], v49 offset:43008
  s_cbranch_vccz L_ow8_0a
  ds_write_b128 v54, v[112:115] offset:4096
L_ow8_0a:
  s_cbranch_vccnz L_ow8_0b
  buffer_store_dwordx4 v[112:115], v255, s[24:27], s52 offen offset:0 sc1
L_ow8_0b:
  s_waitcnt lgkmcnt(6)
  v_cvt_pk_bf16_f32 v120, v120, v121
  v_mfma_f32_32x32x16_bf16 v[0:15], v[80:83], v[104:107], v[0:15]
  ds_read_b64_tr_b16 v[84:85], v49 offset:44032
  ds_read_b64_tr_b16 v[86:87], v49 offset:45056
  v_mul_f32 v122, v245, v122
  v_mul_f32 v123, v245, v123
  v_cvt_pk_bf16_f32 v121, v122, v123
  v_mul_f32 v124, v245, v124
  v_mfma_f32_32x32x16_bf16 v[0:15], v[232:235], v[108:111], v[0:15]
  ds_read_b64_tr_b16 v[80:81], v49 offset:46080
  ds_read_b64_tr_b16 v[82:83], v49 offset:47104
  s_waitcnt lgkmcnt(6)
  v_mul_f32 v125, v245, v125
  v_cvt_pk_bf16_f32 v122, v124, v125
  v_mul_f32 v126, v245, v126
  v_mfma_f32_32x32x16_bf16 v[0:15], v[236:239], v[128:131], v[0:15]
  ds_read_b64_tr_b16 v[232:233], v49 offset:48128
  ds_read_b64_tr_b16 v[234:235], v49 offset:49152
  v_mul_f32 v127, v245, v127
  v_cvt_pk_bf16_f32 v123, v126, v127
  v_mfma_f32_32x32x16_bf16 v[0:15], v[224:227], v[132:135], v[0:15]
  ds_read_b64_tr_b16 v[236:237], v49 offset:50176
  ds_read_b64_tr_b16 v[238:239], v49 offset:51200
  buffer_store_dwordx4 v[120:123], v255, s[24:27], s52 offen offset:1024 sc1
  s_waitcnt lgkmcnt(6)
  v_mfma_f32_32x32x16_bf16 v[0:15], v[228:231], v[136:139], v[0:15]
  ds_read_b64_tr_b16 v[224:225], v49 offset:52224
  ds_read_b64_tr_b16 v[226:227], v49 offset:53248
  v_mfma_f32_32x32x16_bf16 v[0:15], v[84:87], v[140:143], v[0:15]
  s_barrier
  ds_read_b64_tr_b16 v[228:229], v50 offset:22528
  ds_read_b64_tr_b16 v[230:231], v50 offset:23552
  s_waitcnt lgkmcnt(6)
  v_mfma_f32_32x32x16_bf16 v[0:15], v[80:83], v[16:19], v[0:15]
  ds_read_b64_tr_b16 v[84:85], v50 offset:24576
  ds_read_b64_tr_b16 v[86:87], v50 offset:25600
  v_mfma_f32_32x32x16_bf16 v[0:15], v[232:235], v[20:23], v[0:15]
  ds_read_b64_tr_b16 v[80:81], v50 offset:26624
  ds_read_b64_tr_b16 v[82:83], v50 offset:27648
  s_waitcnt lgkmcnt(6)
  v_mfma_f32_32x32x16_bf16 v[0:15], v[236:239], v[24:27], v[0:15]
  ds_read_b64_tr_b16 v[232:233], v50 offset:28672
  ds_read_b64_tr_b16 v[234:235], v50 offset:29696
  v_mfma_f32_32x32x16_bf16 v[0:15], v[224:227], v[28:31], v[0:15]
  ds_read_b64_tr_b16 v[236:237], v50 offset:30720
  ds_read_b64_tr_b16 v[238:239], v50 offset:31744
  s_waitcnt lgkmcnt(6)
  v_mfma_f32_32x32x16_bf16 v[112:127], v[228:231], v[32:35], 0
  ds_read_b64_tr_b16 v[224:225], v50 offset:32768
  ds_read_b64_tr_b16 v[226:227], v50 offset:33792
  v_mfma_f32_32x32x16_bf16 v[112:127], v[84:87], v[36:39], v[112:127]
  ds_read_b64_tr_b16 v[228:229], v50 offset:34816
  ds_read_b64_tr_b16 v[230:231], v50 offset:35840
  s_waitcnt lgkmcnt(6)
  s_nop 1
  v_mul_f32 v0, v245, v0
  v_mul_f32 v1, v245, v1
  v_cvt_pk_bf16_f32 v0, v0, v1
  v_mfma_f32_32x32x16_bf16 v[112:127], v[80:83], v[40:43], v[112:127]
  ds_read_b64_tr_b16 v[84:85], v50 offset:36864
  ds_read_b64_tr_b16 v[86:87], v50 offset:37888
  v_mul_f32 v2, v245, v2
  v_mul_f32 v3, v245, v3
  v_cvt_pk_bf16_f32 v1, v2, v3
  v_mul_f32 v4, v245, v4
  v_mfma_f32_32x32x16_bf16 v[112:127], v[232:235], v[44:47], v[112:127]
  ds_read_b64_tr_b16 v[80:81], v50 offset:39424
  ds_read_b64_tr_b16 v[82:83], v50 offset:40448
  s_waitcnt lgkmcnt(6)
  v_mul_f32 v5, v245, v5
  v_cvt_pk_bf16_f32 v2, v4, v5
  v_mul_f32 v6, v245, v6
  v_mfma_f32_32x32x16_bf16 v[112:127], v[236:239], v[96:99], v[112:127]
  ds_read_b64_tr_b16 v[232:233], v50 offset:41472
  ds_read_b64_tr_b16 v[234:235], v50 offset:42496
  v_mul_f32 v7, v245, v7
  v_cvt_pk_bf16_f32 v3, v6, v7
  v_mul_f32 v8, v245, v8
  v_mul_f32 v9, v245, v9
  v_mfma_f32_32x32x16_bf16 v[112:127], v[224:227], v[100:103], v[112:127]
  ds_read_b64_tr_b16 v[236:237], v50 offset:43520
  ds_read_b64_tr_b16 v[238:239], v50 offset:44544
  buffer_store_dwordx4 v[0:3], v255, s[24:27], s52 offen offset:2048 sc1
  s_waitcnt lgkmcnt(6)
  v_cvt_pk_bf16_f32 v8, v8, v9
  v_mfma_f32_32x32x16_bf16 v[112:127], v[228:231], v[104:107], v[112:127]
  ds_read_b64_tr_b16 v[224:225], v50 offset:45568
  ds_read_b64_tr_b16 v[226:227], v50 offset:46592
  v_mul_f32 v10, v245, v10
  v_mul_f32 v11, v245, v11
  v_cvt_pk_bf16_f32 v9, v10, v11
  v_mul_f32 v12, v245, v12
  v_mfma_f32_32x32x16_bf16 v[112:127], v[84:87], v[108:111], v[112:127]
  ds_read_b64_tr_b16 v[228:229], v50 offset:47616
  ds_read_b64_tr_b16 v[230:231], v50 offset:48640
  s_waitcnt lgkmcnt(6)
  v_mul_f32 v13, v245, v13
  v_cvt_pk_bf16_f32 v10, v12, v13
  v_mul_f32 v14, v245, v14
  v_mfma_f32_32x32x16_bf16 v[112:127], v[80:83], v[128:131], v[112:127]
  ds_read_b64_tr_b16 v[84:85], v50 offset:49664
  ds_read_b64_tr_b16 v[86:87], v50 offset:50688
  v_mul_f32 v15, v245, v15
  v_cvt_pk_bf16_f32 v11, v14, v15
  v_mfma_f32_32x32x16_bf16 v[112:127], v[232:235], v[132:135], v[112:127]
  ds_read_b64_tr_b16 v[80:81], v50 offset:51712
  ds_read_b64_tr_b16 v[82:83], v50 offset:52736
  buffer_store_dwordx4 v[8:11], v255, s[24:27], s52 offen offset:3072 sc1
  s_waitcnt lgkmcnt(6)
  v_mfma_f32_32x32x16_bf16 v[112:127], v[236:239], v[136:139], v[112:127]
  ds_read_b64_tr_b16 v[232:233], v50 offset:53760
  ds_read_b64_tr_b16 v[234:235], v50 offset:54784
  v_mfma_f32_32x32x16_bf16 v[112:127], v[224:227], v[140:143], v[112:127]
  ds_read_b64_tr_b16 v[236:237], v51 offset:22528
  ds_read_b64_tr_b16 v[238:239], v51 offset:23552
  s_waitcnt lgkmcnt(6)
  v_mfma_f32_32x32x16_bf16 v[112:127], v[228:231], v[16:19], v[112:127]
  ds_read_b64_tr_b16 v[224:225], v51 offset:24576
  ds_read_b64_tr_b16 v[226:227], v51 offset:25600
  v_mfma_f32_32x32x16_bf16 v[112:127], v[84:87], v[20:23], v[112:127]
  ds_read_b64_tr_b16 v[228:229], v51 offset:26624
  ds_read_b64_tr_b16 v[230:231], v51 offset:27648
  s_waitcnt lgkmcnt(6)
  v_mfma_f32_32x32x16_bf16 v[112:127], v[80:83], v[24:27], v[112:127]
  ds_read_b64_tr_b16 v[84:85], v51 offset:28672
  ds_read_b64_tr_b16 v[86:87], v51 offset:29696
  v_mfma_f32_32x32x16_bf16 v[112:127], v[232:235], v[28:31], v[112:127]
  ds_read_b64_tr_b16 v[80:81], v51 offset:30720
  ds_read_b64_tr_b16 v[82:83], v51 offset:31744
  s_waitcnt lgkmcnt(6)
  v_mfma_f32_32x32x16_bf16 v[0:15], v[236:239], v[32:35], 0
  ds_read_b64_tr_b16 v[232:233], v51 offset:32768
  ds_read_b64_tr_b16 v[234:235], v51 offset:33792
  v_mfma_f32_32x32x16_bf16 v[0:15], v[224:227], v[36:39], v[0:15]
  ds_read_b64_tr_b16 v[236:237], v51 offset:34816
  ds_read_b64_tr_b16 v[238:239], v51 offset:35840
  s_waitcnt lgkmcnt(6)
  s_nop 1
  v_mul_f32 v112, v245, v112
  v_mul_f32 v113, v245, v113
  v_cvt_pk_bf16_f32 v112, v112, v113
  v_mfma_f32_32x32x16_bf16 v[0:15], v[228:231], v[40:43], v[0:15]
  ds_read_b64_tr_b16 v[224:225], v51 offset:36864
  ds_read_b64_tr_b16 v[226:227], v51 offset:37888
  v_mul_f32 v114, v245, v114
  v_mul_f32 v115, v245, v115
  v_cvt_pk_bf16_f32 v113, v114, v115
  v_mul_f32 v116, v245, v116
  v_mfma_f32_32x32x16_bf16 v[0:15], v[84:87], v[44:47], v[0:15]
  ds_read_b64_tr_b16 v[228:229], v51 offset:39424
  ds_read_b64_tr_b16 v[230:231], v51 offset:40448
  s_waitcnt lgkmcnt(6)
  v_mul_f32 v117, v245, v117
  v_cvt_pk_bf16_f32 v114, v116, v117
  v_mul_f32 v118, v245, v118
  v_mfma_f32_32x32x16_bf16 v[0:15], v[80:83], v[96:99], v[0:15]
  ds_read_b64_tr_b16 v[84:85], v51 offset:41472
  ds_read_b64_tr_b16 v[86:87], v51 offset:42496
  v_mul_f32 v119, v245, v119
  v_cvt_pk_bf16_f32 v115, v118, v119
  v_mul_f32 v120, v245, v120
  v_mul_f32 v121, v245, v121
  v_mfma_f32_32x32x16_bf16 v[0:15], v[232:235], v[100:103], v[0:15]
  ds_read_b64_tr_b16 v[80:81], v51 offset:43520
  ds_read_b64_tr_b16 v[82:83], v51 offset:44544
  s_cbranch_vccz L_ow10_0a
  ds_write_b128 v54, v[112:115] offset:5120
L_ow10_0a:
  s_cbranch_vccnz L_ow10_0b
  buffer_store_dwordx4 v[112:115], v255, s[24:27], s53 offen offset:0 sc1
L_ow10_0b:
  s_waitcnt lgkmcnt(6)
  v_cvt_pk_bf16_f32 v120, v120, v121
  v_mfma_f32_32x32x16_bf16 v[0:15], v[236:239], v[104:107], v[0:15]
  ds_read_b64_tr_b16 v[232:233], v51 offset:45568
  ds_read_b64_tr_b16 v[234:235], v51 offset:46592
  v_mul_f32 v122, v245, v122
  v_mul_f32 v123, v245, v123
  v_cvt_pk_bf16_f32 v121, v122, v123
  v_mul_f32 v124, v245, v124
  v_mfma_f32_32x32x16_bf16 v[0:15], v[224:227], v[108:111], v[0:15]
  ds_read_b64_tr_b16 v[236:237], v51 offset:47616
  ds_read_b64_tr_b16 v[238:239], v51 offset:48640
  s_waitcnt lgkmcnt(6)
  v_mul_f32 v125, v245, v125
  v_cvt_pk_bf16_f32 v122, v124, v125
  v_mul_f32 v126, v245, v126
  v_mfma_f32_32x32x16_bf16 v[0:15], v[228:231], v[128:131], v[0:15]
  ds_read_b64_tr_b16 v[224:225], v51 offset:49664
  ds_read_b64_tr_b16 v[226:227], v51 offset:50688
  v_mul_f32 v127, v245, v127
  v_cvt_pk_bf16_f32 v123, v126, v127
  v_mfma_f32_32x32x16_bf16 v[0:15], v[84:87], v[132:135], v[0:15]
  ds_read_b64_tr_b16 v[228:229], v51 offset:51712
  ds_read_b64_tr_b16 v[230:231], v51 offset:52736
  buffer_store_dwordx4 v[120:123], v255, s[24:27], s53 offen offset:1024 sc1
  s_waitcnt lgkmcnt(6)
  v_mfma_f32_32x32x16_bf16 v[0:15], v[80:83], v[136:139], v[0:15]
  ds_read_b64_tr_b16 v[84:85], v51 offset:53760
  ds_read_b64_tr_b16 v[86:87], v51 offset:54784
  v_mfma_f32_32x32x16_bf16 v[0:15], v[232:235], v[140:143], v[0:15]
  s_barrier
  ds_read_b64_tr_b16 v[80:81], v48 offset:20992
  ds_read_b64_tr_b16 v[82:83], v48 offset:22016
  s_waitcnt lgkmcnt(6)
  v_mfma_f32_32x32x16_bf16 v[0:15], v[236:239], v[16:19], v[0:15]
  ds_read_b64_tr_b16 v[232:233], v48 offset:23040
  ds_read_b64_tr_b16 v[234:235], v48 offset:24064
  v_mfma_f32_32x32x16_bf16 v[0:15], v[224:227], v[20:23], v[0:15]
  ds_read_b64_tr_b16 v[236:237], v48 offset:25088
  ds_read_b64_tr_b16 v[238:239], v48 offset:26112
  s_waitcnt lgkmcnt(6)
  v_mfma_f32_32x32x16_bf16 v[0:15], v[228:231], v[24:27], v[0:15]
  ds_read_b64_tr_b16 v[224:225], v48 offset:27136
  ds_read_b64_tr_b16 v[226:227], v48 offset:28160
  v_mfma_f32_32x32x16_bf16 v[0:15], v[84:87], v[28:31], v[0:15]
  ds_read_b64_tr_b16 v[228:229], v48 offset:29184
  ds_read_b64_tr_b16 v[230:231], v48 offset:30208
  s_waitcnt lgkmcnt(6)
  v_mfma_f32_32x32x16_bf16 v[112:127], v[80:83], v[32:35], 0
  ds_read_b64_tr_b16 v[84:85], v48 offset:31232
  ds_read_b64_tr_b16 v[86:87], v48 offset:32256
  v_mfma_f32_32x32x16_bf16 v[112:127], v[232:235], v[36:39], v[112:127]
  ds_read_b64_tr_b16 v[80:81], v48 offset:33280
  ds_read_b64_tr_b16 v[82:83], v48 offset:34304
  s_waitcnt lgkmcnt(6)
  s_nop 1
  v_mul_f32 v0, v245, v0
  v_mul_f32 v1, v245, v1
  v_cvt_pk_bf16_f32 v0, v0, v1
  v_mfma_f32_32x32x16_bf16 v[112:127], v[236:239], v[40:43], v[112:127]
  ds_read_b64_tr_b16 v[232:233], v48 offset:35328
  ds_read_b64_tr_b16 v[234:235], v48 offset:36352
  v_mul_f32 v2, v245, v2
  v_mul_f32 v3, v245, v3
  v_cvt_pk_bf16_f32 v1, v2, v3
  v_mul_f32 v4, v245, v4
  v_mfma_f32_32x32x16_bf16 v[112:127], v[224:227], v[44:47], v[112:127]
  ds_read_b64_tr_b16 v[236:237], v52 offset:24064
  ds_read_b64_tr_b16 v[238:239], v52 offset:25088
  s_waitcnt lgkmcnt(6)
  v_mul_f32 v5, v245, v5
  v_cvt_pk_bf16_f32 v2, v4, v5
  v_mul_f32 v6, v245, v6
  v_mfma_f32_32x32x16_bf16 v[112:127], v[228:231], v[96:99], v[112:127]
  ds_read_b64_tr_b16 v[224:225], v52 offset:26112
  ds_read_b64_tr_b16 v[226:227], v52 offset:27136
  v_mul_f32 v7, v245, v7
  v_cvt_pk_bf16_f32 v3, v6, v7
  v_mul_f32 v8, v245, v8
  v_mul_f32 v9, v245, v9
  v_mfma_f32_32x32x16_bf16 v[112:127], v[84:87], v[100:103], v[112:127]
  ds_read_b64_tr_b16 v[228:229], v52 offset:28160
  ds_read_b64_tr_b16 v[230:231], v52 offset:29184
  buffer_store_dwordx4 v[0:3], v255, s[24:27], s53 offen offset:2048 sc1
  s_waitcnt lgkmcnt(6)
  v_cvt_pk_bf16_f32 v8, v8, v9
  v_mfma_f32_32x32x16_bf16 v[112:127], v[80:83], v[104:107], v[112:127]
  ds_read_b64_tr_b16 v[84:85], v52 offset:30208
  ds_read_b64_tr_b16 v[86:87], v52 offset:31232
  v_mul_f32 v10, v245, v10
  v_mul_f32 v11, v245, v11
  v_cvt_pk_bf16_f32 v9, v10, v11
  v_mul_f32 v12, v245, v12
  v_mfma_f32_32x32x16_bf16 v[112:127], v[232:235], v[108:111], v[112:127]
  ds_read_b64_tr_b16 v[80:81], v52 offset:32256
  ds_read_b64_tr_b16 v[82:83], v52 offset:33280
  s_waitcnt lgkmcnt(6)
  v_mul_f32 v13, v245, v13
  v_cvt_pk_bf16_f32 v10, v12, v13
  v_mul_f32 v14, v245, v14
  v_mfma_f32_32x32x16_bf16 v[112:127], v[236:239], v[128:131], v[112:127]
  ds_read_b64_tr_b16 v[232:233], v52 offset:34304
  ds_read_b64_tr_b16 v[234:235], v52 offset:35328
  v_mul_f32 v15, v245, v15
  v_cvt_pk_bf16_f32 v11, v14, v15
  v_mfma_f32_32x32x16_bf16 v[112:127], v[224:227], v[132:135], v[112:127]
  ds_read_b64_tr_b16 v[236:237], v52 offset:36352
  ds_read_b64_tr_b16 v[238:239], v52 offset:37376
  buffer_store_dwordx4 v[8:11], v255, s[24:27], s53 offen offset:3072 sc1
  s_waitcnt lgkmcnt(6)
  v_mfma_f32_32x32x16_bf16 v[112:127], v[228:231], v[136:139], v[112:127]
  ds_read_b64_tr_b16 v[224:225], v52 offset:38400
  ds_read_b64_tr_b16 v[226:227], v52 offset:39424
  v_mfma_f32_32x32x16_bf16 v[112:127], v[84:87], v[140:143], v[112:127]
  ds_read_b64_tr_b16 v[228:229], v49 offset:20992
  ds_read_b64_tr_b16 v[230:231], v49 offset:22016
  s_waitcnt lgkmcnt(6)
  v_mfma_f32_32x32x16_bf16 v[112:127], v[80:83], v[16:19], v[112:127]
  ds_read_b64_tr_b16 v[84:85], v49 offset:23040
  ds_read_b64_tr_b16 v[86:87], v49 offset:24064
  v_mfma_f32_32x32x16_bf16 v[112:127], v[232:235], v[20:23], v[112:127]
  ds_read_b64_tr_b16 v[80:81], v49 offset:25088
  ds_read_b64_tr_b16 v[82:83], v49 offset:26112
  s_waitcnt lgkmcnt(6)
  v_mfma_f32_32x32x16_bf16 v[112:127], v[236:239], v[24:27], v[112:127]
  ds_read_b64_tr_b16 v[232:233], v49 offset:27136
  ds_read_b64_tr_b16 v[234:235], v49 offset:28160
  v_mfma_f32_32x32x16_bf16 v[112:127], v[224:227], v[28:31], v[112:127]
  ds_read_b64_tr_b16 v[236:237], v49 offset:29184
  ds_read_b64_tr_b16 v[238:239], v49 offset:30208
  s_waitcnt lgkmcnt(6)
  v_mfma_f32_32x32x16_bf16 v[0:15], v[228:231], v[32:35], 0
  ds_read_b64_tr_b16 v[224:225], v49 offset:31232
  ds_read_b64_tr_b16 v[226:227], v49 offset:32256
  v_mfma_f32_32x32x16_bf16 v[0:15], v[84:87], v[36:39], v[0:15]
  ds_read_b64_tr_b16 v[228:229], v49 offset:33280
  ds_read_b64_tr_b16 v[230:231], v49 offset:34304
  s_waitcnt lgkmcnt(6)
  s_nop 1
  v_mul_f32 v112, v245, v112
  v_mul_f32 v113, v245, v113
  v_cvt_pk_bf16_f32 v112, v112, v113
  v_mfma_f32_32x32x16_bf16 v[0:15], v[80:83], v[40:43], v[0:15]
  ds_read_b64_tr_b16 v[84:85], v49 offset:35328
  ds_read_b64_tr_b16 v[86:87], v49 offset:36352
  v_mul_f32 v114, v245, v114
  v_mul_f32 v115, v245, v115
  v_cvt_pk_bf16_f32 v113, v114, v115
  v_mul_f32 v116, v245, v116
  v_mfma_f32_32x32x16_bf16 v[0:15], v[232:235], v[44:47], v[0:15]
  ds_read_b64_tr_b16 v[80:81], v53 offset:24064
  ds_read_b64_tr_b16 v[82:83], v53 offset:25088
  s_waitcnt lgkmcnt(6)
  v_mul_f32 v117, v245, v117
  v_cvt_pk_bf16_f32 v114, v116, v117
  v_mul_f32 v118, v245, v118
  v_mfma_f32_32x32x16_bf16 v[0:15], v[236:239], v[96:99], v[0:15]
  ds_read_b64_tr_b16 v[232:233], v53 offset:26112
  ds_read_b64_tr_b16 v[234:235], v53 offset:27136
  v_mul_f32 v119, v245, v119
  v_cvt_pk_bf16_f32 v115, v118, v119
  v_mul_f32 v120, v245, v120
  v_mul_f32 v121, v245, v121
  v_mfma_f32_32x32x16_bf16 v[0:15], v[224:227], v[100:103], v[0:15]
  ds_read_b64_tr_b16 v[236:237], v53 offset:28160
  ds_read_b64_tr_b16 v[238:239], v53 offset:29184
  s_cbranch_vccz L_ow12_0a
  ds_write_b128 v54, v[112:115] offset:6144
L_ow12_0a:
  s_cbranch_vccnz L_ow12_0b
  buffer_store_dwordx4 v[112:115], v255, s[24:27], s54 offen offset:0 sc1
L_ow12_0b:
  s_waitcnt lgkmcnt(6)
  v_cvt_pk_bf16_f32 v120, v120, v121
  v_mfma_f32_32x32x16_bf16 v[0:15], v[228:231], v[104:107], v[0:15]
  ds_read_b64_tr_b16 v[224:225], v53 offset:30208
  ds_read_b64_tr_b16 v[226:227], v53 offset:31232
  v_mov_b32 v250, 1
  s_waitcnt vmcnt(6)
  s_mov_b64 exec, 1
  buffer_atomic_umax v250, off, s[28:31], s46 sc1
  s_mov_b64 exec, -1
  v_mul_f32 v122, v245, v122
  v_mul_f32 v123, v245, v123
  v_cvt_pk_bf16_f32 v121, v122, v123
  v_mul_f32 v124, v245, v124
  v_mfma_f32_32x32x16_bf16 v[0:15], v[84:87], v[108:111], v[0:15]
  ds_read_b64_tr_b16 v[228:229], v53 offset:32256
  ds_read_b64_tr_b16 v[230:231], v53 offset:33280
  s_waitcnt lgkmcnt(6)
  v_mul_f32 v125, v245, v125
  v_cvt_pk_bf16_f32 v122, v124, v125
  v_mul_f32 v126, v245, v126
  v_mfma_f32_32x32x16_bf16 v[0:15], v[80:83], v[128:131], v[0:15]
  ds_read_b64_tr_b16 v[84:85], v53 offset:34304
  ds_read_b64_tr_b16 v[86:87], v53 offset:35328
  v_mul_f32 v127, v245, v127
  v_cvt_pk_bf16_f32 v123, v126, v127
  v_mfma_f32_32x32x16_bf16 v[0:15], v[232:235], v[132:135], v[0:15]
  ds_read_b64_tr_b16 v[80:81], v53 offset:36352
  ds_read_b64_tr_b16 v[82:83], v53 offset:37376
  buffer_store_dwordx4 v[120:123], v255, s[24:27], s54 offen offset:1024 sc1
  s_waitcnt lgkmcnt(6)
  v_mfma_f32_32x32x16_bf16 v[0:15], v[236:239], v[136:139], v[0:15]
  ds_read_b64_tr_b16 v[232:233], v53 offset:38400
  ds_read_b64_tr_b16 v[234:235], v53 offset:39424
  v_mfma_f32_32x32x16_bf16 v[0:15], v[224:227], v[140:143], v[0:15]
  s_waitcnt lgkmcnt(4)
  v_mfma_f32_32x32x16_bf16 v[0:15], v[228:231], v[16:19], v[0:15]
  v_mfma_f32_32x32x16_bf16 v[0:15], v[84:87], v[20:23], v[0:15]
  s_waitcnt lgkmcnt(0)
  v_mfma_f32_32x32x16_bf16 v[0:15], v[80:83], v[24:27], v[0:15]
  v_mfma_f32_32x32x16_bf16 v[0:15], v[232:235], v[28:31], v[0:15]
  s_nop 11
  v_mul_f32 v0, v245, v0
  v_mul_f32 v1, v245, v1
  v_cvt_pk_bf16_f32 v0, v0, v1
  v_mul_f32 v2, v245, v2
  v_mul_f32 v3, v245, v3
  v_cvt_pk_bf16_f32 v1, v2, v3
  v_mul_f32 v4, v245, v4
  v_mul_f32 v5, v245, v5
  v_cvt_pk_bf16_f32 v2, v4, v5
  v_mul_f32 v6, v245, v6
  v_mul_f32 v7, v245, v7
  v_cvt_pk_bf16_f32 v3, v6, v7
  buffer_store_dwordx4 v[0:3], v255, s[24:27], s54 offen offset:2048 sc1
  v_mul_f32 v8, v245, v8
  v_mul_f32 v9, v245, v9
  v_cvt_pk_bf16_f32 v8, v8, v9
  v_mul_f32 v10, v245, v10
  v_mul_f32 v11, v245, v11
  v_cvt_pk_bf16_f32 v9, v10, v11
  v_mul_f32 v12, v245, v12
  v_mul_f32 v13, v245, v13
  v_cvt_pk_bf16_f32 v10, v12, v13
  v_mul_f32 v14, v245, v14
  v_mul_f32 v15, v245, v15
  v_cvt_pk_bf16_f32 v11, v14, v15
  buffer_store_dwordx4 v[8:11], v255, s[24:27], s54 offen offset:3072 sc1
  v_mbcnt_lo_u32_b32 v247, -1, 0
  v_mbcnt_hi_u32_b32 v247, -1, v247
  v_and_b32 v247, 31, v247
  v_and_b32 v248, 16, v247
  v_add_lshl_u32 v247, v247, v248, 2
  v_mov_b32 v250, 2
  s_waitcnt vmcnt(0) lgkmcnt(0)
  s_mov_b64 exec, 1
  buffer_atomic_umax v250, off, s[28:31], s46 sc1
  s_mov_b64 exec, -1
  s_waitcnt vmcnt(0)
  s_mov_b64 exec, 0xf0000
  buffer_load_dword v250, v247, s[28:31], s47 offen sc1
  s_mov_b64 exec, -1
  s_waitcnt vmcnt(0)
  v_cmp_ne_u32 vcc, 0, v250
  s_and_b32 s8, vcc_lo, 0xf0000
  s_cbranch_scc1 L_slow
L_done:
  s_endpgm
L_slow:
  v_mov_b32 v73, s88
  v_lshlrev_b32 v73, 4, v73
  global_load_dword v70, v73, s[58:59] sc1
  s_waitcnt vmcnt(0)
  v_readfirstlane_b32 s83, v70
  s_cmp_lt_u32 s83, 16
  s_cbranch_scc1 L_done
  buffer_load_dword v250, v247, s[28:31], s47 offen sc1
  s_waitcnt vmcnt(0)
  v_cmp_ne_u32 vcc, 2, v250
  s_and_b32 s8, vcc_lo, 0xffff
  s_cbranch_scc1 L_done
  v_cmp_ne_u32 vcc, 0, v250
  s_bfe_u32 s87, vcc_lo, 0x40010
  s_mov_b32 s78, 0
L_rescue:
  s_cmp_ge_u32 s78, 16
  s_cbranch_scc1 L_done
  s_lshr_b32 s76, s78, 2
  s_and_b32 s77, s78, 3
  s_add_u32 s78, s78, 1
  s_bitcmp1_b32 s87, s76
  s_cbranch_scc0 L_rescue
  s_lshl_b32 s3, s14, 2
  s_add_u32 s76, s76, s3
  s_mov_b32 s80, 1
  s_mov_b32 s79, 8
  s_mov_b32 s91, 0
  s_waitcnt vmcnt(0)
  s_mov_b32 s73, 0
  s_mov_b32 s74, 0
  s_lshl_b32 s88, s5, 3
  s_add_u32 s88, s88, s7
  s_mul_i32 s8, s88, 17408
  s_add_u32 s8, s8, 33554432
  s_add_u32 s28, s12, s8
  s_addc_u32 s29, s13, 0
  s_mov_b32 s30, 17408
  s_mov_b32 s31, 0x20000
  s_mul_i32 s8, s88, 1835008
  s_add_u32 s16, s12, s8
  s_addc_u32 s17, s13, 0
  s_mov_b32 s18, 1835008
  s_mov_b32 s19, 0x20000
  s_mov_b32 s20, s56
  s_mov_b32 s21, s57
  s_mov_b32 s22, 1835008
  s_mov_b32 s23, 0x20000
  v_mbcnt_lo_u32_b32 v71, -1, 0
  v_mbcnt_hi_u32_b32 v71, -1, v71
  s_and_b32 s4, s76, 3
  s_lshr_b32 s3, s76, 2
  s_add_u32 s60, s10, s77
  s_sub_u32 s61, s60, 7
  s_min_u32 s60, s60, s61
  s_min_u32 s61, s77, 2
  s_add_u32 s61, s61, s10
  s_add_u32 s61, s61, 4
  s_sub_u32 s8, s61, 7
  s_min_u32 s61, s61, s8
  s_mul_i32 s8, s3, 28672
  v_lshl_add_u32 v75, v71, 4, s8
  v_lshl_add_u32 v64, s60, 12, v75
  v_lshl_add_u32 v65, s61, 12, v75
  s_lshl_b32 s32, s4, 10
  s_xor_b32 s33, s32, 1024
  s_xor_b32 s34, s32, 2048
  s_xor_b32 s35, s32, 3072
  s_add_u32 s47, s35, 1720320
  s_add_u32 s46, s34, 1605632
  s_add_u32 s45, s33, 1490944
  s_add_u32 s44, s32, 1376256
  s_add_u32 s43, s35, 1261568
  s_add_u32 s42, s34, 1146880
  s_add_u32 s41, s33, 1032192
  s_add_u32 s40, s32, 917504
  s_add_u32 s39, s35, 802816
  s_add_u32 s38, s34, 688128
  s_add_u32 s37, s33, 573440
  s_add_u32 s36, s32, 458752
  s_add_u32 s35, s35, 344064
  s_add_u32 s34, s34, 229376
  s_add_u32 s33, s33, 114688
  s_lshl_b32 s60, s60, 2
  s_add_u32 s60, s60, s4
  s_lshl_b32 s61, s61, 2
  s_add_u32 s61, s61, s4
  s_lshl_b32 s8, s7, 2
  s_add_u32 s8, s8, s3
  s_mul_i32 s8, s8, 57344
  s_mul_i32 s4, s5, 896
  s_add_u32 s8, s8, s4
  v_and_b32 v72, 31, v71
  v_lshrrev_b32 v73, 5, v71
  v_mul_u32_u24 v75, 1792, v72
  v_lshl_add_u32 v75, v73, 4, v75
  v_add_u32 v75, s8, v75
  v_lshl_add_u32 v66, s60, 5, v75
  v_lshl_add_u32 v67, s61, 5, v75
  v_and_b32 v75, 15, v71
  v_lshlrev_b32 v75, 2, v75
  s_mul_i32 s3, s3, 4352
  v_add_u32 v69, s3, v75
  s_mov_b32 s90, 0
  s_mov_b32 s89, 0xffff0000
  s_mov_b64 s[94:95], -1
  s_cmp_eq_u32 s77, 3
  s_cselect_b32 s81, s89, 0
  s_cselect_b32 s84, 0x11110000, 0
  s_cselect_b64 s[92:93], 0, -1
  s_lshl_b32 s72, s76, 2
  s_lshl_b32 s3, s77, 10
  s_add_u32 s3, s3, 156160
  v_lshl_add_u32 v68, v71, 4, s3
  v_and_b32 v72, 1, v71
  v_lshlrev_b32 v72, 4, v72
  v_mov_b32 v73, 0x3f80
  v_lshlrev_b32 v72, v72, v73
  v_lshrrev_b32 v73, 3, v71
  v_xor_b32 v73, v73, v71
  v_and_b32 v73, 4, v73
  v_and_b32 v74, 0x1a, v71
  v_or_b32 v73, v73, v74
  v_cmp_eq_u32 vcc, 0, v73
  v_cndmask_b32 v120, 0, v72, vcc
  v_cmp_eq_u32 vcc, 2, v73
  v_cndmask_b32 v121, 0, v72, vcc
  v_cmp_eq_u32 vcc, 8, v73
  v_cndmask_b32 v122, 0, v72, vcc
  v_cmp_eq_u32 vcc, 10, v73
  v_cndmask_b32 v123, 0, v72, vcc
  v_mov_b32 v80, 0
  v_mov_b32 v81, 0
  v_mov_b32 v82, 0
  v_mov_b32 v83, 0
  v_mov_b32 v84, 0
  v_mov_b32 v85, 0
  v_mov_b32 v86, 0
  v_mov_b32 v87, 0
  v_mov_b32 v88, 0
  v_mov_b32 v89, 0
  v_mov_b32 v90, 0
  v_mov_b32 v91, 0
  v_mov_b32 v92, 0
  v_mov_b32 v93, 0
  v_mov_b32 v94, 0
  v_mov_b32 v95, 0
  v_mov_b32 v96, 0
  v_mov_b32 v97, 0
  v_mov_b32 v98, 0
  v_mov_b32 v99, 0
  v_mov_b32 v100, 0
  v_mov_b32 v101, 0
  v_mov_b32 v102, 0
  v_mov_b32 v103, 0
  v_mov_b32 v104, 0
  v_mov_b32 v105, 0
  v_mov_b32 v106, 0
  v_mov_b32 v107, 0
  v_mov_b32 v108, 0
  v_mov_b32 v109, 0
  v_mov_b32 v110, 0
  v_mov_b32 v111, 0
  s_branch L_rgo
L_aband:
  s_lshr_b32 s3, s76, 2
  s_mul_i32 s3, s3, 4352
  s_add_u32 s3, s3, s72
  s_movk_i32 s4, 4000
L_ab1:
  v_mov_b32 v72, 0
  s_mov_b64 exec, 1
  buffer_atomic_or v72, off, s[28:31], s3 sc0 sc1
  s_mov_b64 exec, -1
  s_waitcnt vmcnt(0)
  v_readfirstlane_b32 s8, v72
  s_cmp_eq_u32 s8, 2
  s_cbranch_scc1 L_ab1g
  s_sub_u32 s4, s4, 1
  s_cbranch_scc0 L_ab1
  s_endpgm
L_ab1g:
  s_lshr_b32 s3, s76, 2
  s_mul_i32 s3, s3, 28672
  s_mul_i32 s4, s76, 114688
  s_add_u32 s3, s3, s4
  v_lshl_add_u32 v72, v71, 4, s3
  v_lshlrev_b32 v73, 4, v71
  v_add_u32 v73, 156160, v73
  s_lshl_b32 s4, s10, 12
  ds_read_b128 v[76:79], v73 offset:0
  s_waitcnt lgkmcnt(0)
  buffer_store_dwordx4 v[76:79], v72, s[16:19], s4 offen sc1
  s_waitcnt vmcnt(0)
  s_add_u32 s4, s4, 4096
  s_cmp_eq_u32 s4, 28672
  s_cselect_b32 s4, 0, s4
  ds_read_b128 v[76:79], v73 offset:1024
  s_waitcnt lgkmcnt(0)
  buffer_store_dwordx4 v[76:79], v72, s[16:19], s4 offen sc1
  s_waitcnt vmcnt(0)
  s_add_u32 s4, s4, 4096
  s_cmp_eq_u32 s4, 28672
  s_cselect_b32 s4, 0, s4
  ds_read_b128 v[76:79], v73 offset:2048
  s_waitcnt lgkmcnt(0)
  buffer_store_dwordx4 v[76:79], v72, s[16:19], s4 offen sc1
  s_waitcnt vmcnt(0)
  s_add_u32 s4, s4, 4096
  s_cmp_eq_u32 s4, 28672
  s_cselect_b32 s4, 0, s4
  ds_read_b128 v[76:79], v73 offset:3072
  s_waitcnt lgkmcnt(0)
  buffer_store_dwordx4 v[76:79], v72, s[16:19], s4 offen sc1
  s_waitcnt vmcnt(0)
  s_add_u32 s4, s4, 4096
  s_cmp_eq_u32 s4, 28672
  s_cselect_b32 s4, 0, s4
  ds_read_b128 v[76:79], v73 offset:4096
  s_waitcnt lgkmcnt(0)
  buffer_store_dwordx4 v[76:79], v72, s[16:19], s4 offen sc1
  s_waitcnt vmcnt(0)
  s_add_u32 s4, s4, 4096
  s_cmp_eq_u32 s4, 28672
  s_cselect_b32 s4, 0, s4
  ds_read_b128 v[76:79], v73 offset:5120
  s_waitcnt lgkmcnt(0)
  buffer_store_dwordx4 v[76:79], v72, s[16:19], s4 offen sc1
  s_waitcnt vmcnt(0)
  s_add_u32 s4, s4, 4096
  s_cmp_eq_u32 s4, 28672
  s_cselect_b32 s4, 0, s4
  ds_read_b128 v[76:79], v73 offset:6144
  s_waitcnt lgkmcnt(0)
  buffer_store_dwordx4 v[76:79], v72, s[16:19], s4 offen sc1
  s_waitcnt vmcnt(0)
  s_lshr_b32 s3, s76, 2
  s_mul_i32 s3, s3, 4352
  s_and_b32 s4, s76, 3
  s_lshl_b32 s4, s4, 2
  s_add_u32 s3, s3, s4
  v_mov_b32 v72, 15
  s_mov_b64 exec, 1
  buffer_store_dword v72, off, s[28:31], s3 offset:128 sc1
  s_mov_b64 exec, -1
  s_waitcnt vmcnt(0)
  s_mov_b32 s80, 1
  s_mov_b32 s79, 4
  s_cmp_lg_u32 s75, 0
  s_cbranch_scc1 L_rloop
  s_branch L_rcnt1
L_rdone:
  s_endpgm
.section .rodata,"a"
.p2align 6
.amdhsa_kernel attn_kernel
  .amdhsa_next_free_vgpr 256
  .amdhsa_next_free_sgpr 96
  .amdhsa_accum_offset 256
  .amdhsa_group_segment_fixed_size 0
  .amdhsa_kernarg_size 104
  .amdhsa_user_sgpr_count 2
  .amdhsa_user_sgpr_kernarg_segment_ptr 1
  .amdhsa_system_sgpr_workgroup_id_x 1
.end_amdhsa_kernel
```
